```python
import torch

def _softmax(x, axis=-1):
    return torch.softmax(x, dim=axis)
def _gelu(x):
    return torch.nn.functional.gelu(x, approximate="tanh")
def _silu(x):
    return torch.nn.functional.silu(x)
def _sigmoid(x):
    return torch.sigmoid(x)
def _layernorm(x, axis=-1, eps=1e-5):
    m = x.mean(dim=axis, keepdim=True)
    v = x.var(dim=axis, keepdim=True, unbiased=False)
    return (x - m) / torch.sqrt(v + eps)
def _scatter_add(tgt, idx, src, axis=0):
    return tgt.clone().index_add_(axis, idx, src)
def _segment_sum(src, seg, n):
    out = torch.zeros((n,) + src.shape[1:], dtype=src.dtype)
    return out.index_add_(0, seg, src)
def _pad(x, pw):
    flat = tuple(v for pair in reversed(pw) for v in pair)
    return torch.nn.functional.pad(x, flat)

kernel_name = 'sequential_preLN__softmax_full_mha__glu_gated_bilinear__prompt'

def setup_inputs():

    _w = (lambda a: (lambda t: t.to(torch.bfloat16) if t.is_floating_point() else t)(torch.as_tensor(a)))
    def _A_setup():
        B, S, D = 1, 2048, 576
        return {
            "x": _w((lambda *s: torch.randn(*s, dtype=torch.bfloat16) * 0.05)(B, S, D)),
            "wqkv": _w((lambda *s: torch.randn(*s, dtype=torch.bfloat16) * 0.05)(D, 3 * D)),
            "wo": _w((lambda *s: torch.randn(*s, dtype=torch.bfloat16) * 0.05)(D, D)),
        }
    _A_in = _A_setup()

    def _B_setup():
        B, S, D, F = 1, 2048, 576, 4608
        return {
            "x": _w((lambda *s: torch.randn(*s, dtype=torch.bfloat16) * 0.05)(B, S, D)),
            "w_gate": _w((lambda *s: torch.randn(*s, dtype=torch.bfloat16) * 0.4)(D, F) * (D ** -0.5)),
            "w_up": _w((lambda *s: torch.randn(*s, dtype=torch.bfloat16) * 0.4)(D, F) * (D ** -0.5)),
            "w_down": _w((lambda *s: torch.randn(*s, dtype=torch.bfloat16) * 0.4)(F, D) * (F ** -0.5)),
        }
    _B_in = _B_setup()

    return {
        "A_x": _A_in["x"],
        "A_wqkv": _A_in["wqkv"],
        "A_wo": _A_in["wo"],
        "B_x": _B_in["x"],
        "B_w_gate": _B_in["w_gate"],
        "B_w_up": _B_in["w_up"],
        "B_w_down": _B_in["w_down"],
    }

def reference(A_x, A_wqkv, A_wo, B_x, B_w_gate, B_w_up, B_w_down):
    def _A_ref(x, wqkv, wo):
        B, S, D = x.shape
        H = 32; Dh = D // H
        qkv = (lambda x, *d: x.permute(*d))((x @ wqkv).reshape(B, S, 3, H, Dh), 2, 0, 3, 1, 4)
        q, k, v = qkv[0], qkv[1], qkv[2]
        scale = Dh ** -0.5
        scores = torch.einsum("bhqd,bhkd->bhqk", q, k) * scale
        p = _softmax(scores, axis=-1)
        o = torch.einsum("bhqk,bhkd->bhqd", p, v)
        return (lambda x, *d: x.permute(*d))(o, 0, 2, 1, 3).reshape(B, S, D) @ wo

    def _B_ref(x, w_gate, w_up, w_down):
        g = torch.einsum("bsd,df->bsf", x, w_gate)
        u = torch.einsum("bsd,df->bsf", x, w_up)
        h = g * u
        return torch.einsum("bsf,fd->bsd", h, w_down)

    x = A_x
    h = x + _A_ref(_layernorm(x, axis=-1), A_wqkv, A_wo)
    h2 = h + _B_ref(_layernorm(h, axis=-1), B_w_gate, B_w_up, B_w_down)
    return h2
```

```asm
; @launch grid=(256,1,1) block=(512,1,1) lds=163840
.amdgcn_target "amdgcn-amd-amdhsa--gfx950"
.text
.globl sequential_preLN__softmax_full_mha__glu_gated_bilinear__prompt_kernel
.p2align 8
.type sequential_preLN__softmax_full_mha__glu_gated_bilinear__prompt_kernel,@function
sequential_preLN__softmax_full_mha__glu_gated_bilinear__prompt_kernel:
  s_cmp_ge_u32 s2, 256
  s_cbranch_scc1 Lse_end
  s_load_dwordx4 s[28:31], s[0:1], 0
  s_load_dwordx2 s[32:33], s[0:1], 16
  s_load_dwordx2 s[34:35], s[0:1], 72
  s_load_dwordx2 s[38:39], s[0:1], 64
  s_load_dwordx8 s[40:47], s[0:1], 32
  v_lshrrev_b32 v1, 6, v0
  v_and_b32 v0, 63, v0
  v_readfirstlane_b32 s16, v1
  v_lshlrev_b32 v1, 4, v0
  s_mov_b32 s95, s16
  v_and_b32 v22, 15, v0
  v_lshrrev_b32 v23, 4, v0
  s_and_b32 s3, s16, 3
  s_and_b32 s26, s2, 7
  s_lshr_b32 s27, s2, 3
  s_lshr_b32 s17, s26, 1
  s_lshl_b32 s17, s17, 2
  s_and_b32 s50, s27, 3
  s_add_u32 s17, s17, s50
  s_and_b32 s18, s26, 1
  s_mul_i32 s18, s18, 6
  s_lshr_b32 s51, s27, 2
  s_add_u32 s18, s18, s51
  s_lshl_b32 s48, s17, 2
  s_add_u32 s48, s48, s3
  s_lshl_b32 s49, s3, 12
  s_cmp_ge_u32 s2, 192
  s_cbranch_scc1 Lse_aux
  s_cmp_lt_u32 s16, 4
  s_cbranch_scc1 Lse_acons
  s_add_u32 s61, s51, s50
  s_mul_i32 s50, s61, 32769
  s_lshr_b32 s50, s50, 16
  s_mul_i32 s50, s50, 2
  s_sub_u32 s61, s61, s50
  s_mul_i32 s61, s61, 640
  s_add_u32 s61, s61, 128
  s_lshr_b32 s61, s61, 8
  s_add_u32 s61, s61, 4
  s_mov_b32 s25, 0
  s_mul_i32 s19, s48, 36864
  s_mul_i32 s20, s18, 288
  v_lshrrev_b32 v216, 3, v0
  v_mul_u32_u24 v216, 1152, v216
  v_and_b32 v217, 7, v0
  v_xor_b32 v217, v217, v23
  v_lshl_add_u32 v2, v217, 4, v216
  v_xor_b32 v217, 4, v217
  v_lshl_add_u32 v3, v217, 4, v216
  s_add_u32 s52, s3, 0
  s_lshl_b32 s50, s52, 6
  v_add_u32 v216, s50, v0
  v_mul_u32_u24 v217, 3641, v216
  v_lshrrev_b32 v217, 16, v217
  v_mul_u32_u24 v218, 18, v217
  v_sub_u32 v218, v216, v218
  v_and_b32 v219, 0x33, v217
  v_and_b32 v220, 4, v217
  v_lshl_or_b32 v219, v220, 1, v219
  v_bfe_u32 v220, v217, 3, 1
  v_lshl_or_b32 v219, v220, 2, v219
  v_mul_u32_u24 v219, 3456, v219
  v_lshl_add_u32 v4, v218, 4, v219
  s_lshl_b32 s52, s52, 10
  s_add_u32 s52, s52, 16384
  s_add_u32 s53, s3, 4
  s_lshl_b32 s50, s53, 6
  v_add_u32 v216, s50, v0
  v_mul_u32_u24 v217, 3641, v216
  v_lshrrev_b32 v217, 16, v217
  v_mul_u32_u24 v218, 18, v217
  v_sub_u32 v218, v216, v218
  v_and_b32 v219, 0x33, v217
  v_and_b32 v220, 4, v217
  v_lshl_or_b32 v219, v220, 1, v219
  v_bfe_u32 v220, v217, 3, 1
  v_lshl_or_b32 v219, v220, 2, v219
  v_mul_u32_u24 v219, 3456, v219
  v_lshl_add_u32 v5, v218, 4, v219
  s_lshl_b32 s53, s53, 10
  s_add_u32 s53, s53, 16384
  s_add_u32 s54, s3, 8
  s_lshl_b32 s50, s54, 6
  v_add_u32 v216, s50, v0
  v_mul_u32_u24 v217, 3641, v216
  v_lshrrev_b32 v217, 16, v217
  v_mul_u32_u24 v218, 18, v217
  v_sub_u32 v218, v216, v218
  v_and_b32 v219, 0x33, v217
  v_and_b32 v220, 4, v217
  v_lshl_or_b32 v219, v220, 1, v219
  v_bfe_u32 v220, v217, 3, 1
  v_lshl_or_b32 v219, v220, 2, v219
  v_mul_u32_u24 v219, 3456, v219
  v_lshl_add_u32 v6, v218, 4, v219
  s_lshl_b32 s54, s54, 10
  s_add_u32 s54, s54, 16384
  s_add_u32 s55, s3, 12
  s_lshl_b32 s50, s55, 6
  v_add_u32 v216, s50, v0
  v_mul_u32_u24 v217, 3641, v216
  v_lshrrev_b32 v217, 16, v217
  v_mul_u32_u24 v218, 18, v217
  v_sub_u32 v218, v216, v218
  v_and_b32 v219, 0x33, v217
  v_and_b32 v220, 4, v217
  v_lshl_or_b32 v219, v220, 1, v219
  v_bfe_u32 v220, v217, 3, 1
  v_lshl_or_b32 v219, v220, 2, v219
  v_mul_u32_u24 v219, 3456, v219
  v_lshl_add_u32 v7, v218, 4, v219
  s_lshl_b32 s55, s55, 10
  s_add_u32 s55, s55, 16384
  s_add_u32 s56, s3, 16
  s_add_u32 s50, s3, 12
  s_cmp_ge_u32 s56, 18
  s_cselect_b32 s56, s50, s56
  s_lshl_b32 s50, s56, 6
  v_add_u32 v216, s50, v0
  v_mul_u32_u24 v217, 3641, v216
  v_lshrrev_b32 v217, 16, v217
  v_mul_u32_u24 v218, 18, v217
  v_sub_u32 v218, v216, v218
  v_and_b32 v219, 0x33, v217
  v_and_b32 v220, 4, v217
  v_lshl_or_b32 v219, v220, 1, v219
  v_bfe_u32 v220, v217, 3, 1
  v_lshl_or_b32 v219, v220, 2, v219
  v_mul_u32_u24 v219, 3456, v219
  v_lshl_add_u32 v8, v218, 4, v219
  s_lshl_b32 s56, s56, 10
  s_add_u32 s56, s56, 16384
  s_cmp_ge_u32 s3, 2
  s_cselect_b64 vcc, -1, 0
  v_mov_b32 v216, 1073741824
  s_cselect_b32 s59, 0, -1
  s_cselect_b32 s56, 142336, s56
  v_cndmask_b32 v8, v8, v216, vcc
  s_waitcnt lgkmcnt(0)
  s_mov_b32 s4, s28
  s_mov_b32 s5, s29
  s_mov_b32 s6, 0x240000
  s_mov_b32 s7, 0x20000
  s_mov_b32 s8, s30
  s_mov_b32 s9, s31
  s_mov_b32 s10, 0x1e6000
  s_mov_b32 s11, 0x20000
  s_mov_b32 s12, s34
  s_mov_b32 s13, s35
  s_mov_b32 s14, 0x10000000
  s_mov_b32 s15, 0x20000
  s_mov_b32 s23, 0
  s_mov_b32 s24, 0
  s_mov_b32 s57, 0
  v_mov_b32 v12, 0
  v_mov_b32 v13, 0
Lse_ploop:
  s_lshl_b32 s21, s25, 7
  s_add_u32 s21, s21, s19
  s_mul_i32 s22, s25, 221184
  s_add_u32 s22, s22, s20
  s_add_u32 s50, s49, s23
  s_add_u32 m0, s50, 0
  s_add_u32 s51, s21, 0
  buffer_load_dwordx4 v2, s[4:7], s51 offen lds
  s_add_u32 m0, s50, 1024
  s_add_u32 s51, s21, 9216
  buffer_load_dwordx4 v3, s[4:7], s51 offen lds
  s_add_u32 m0, s50, 2048
  s_add_u32 s51, s21, 18432
  buffer_load_dwordx4 v2, s[4:7], s51 offen lds
  s_add_u32 m0, s50, 3072
  s_add_u32 s51, s21, 27648
  buffer_load_dwordx4 v3, s[4:7], s51 offen lds
  s_add_u32 m0, s52, s23
  s_nop 0
  buffer_load_dwordx4 v4, s[8:11], s22 offen lds
  s_add_u32 m0, s53, s23
  s_nop 0
  buffer_load_dwordx4 v5, s[8:11], s22 offen lds
  s_add_u32 m0, s54, s23
  s_nop 0
  buffer_load_dwordx4 v6, s[8:11], s22 offen lds
  s_add_u32 m0, s55, s23
  s_nop 0
  buffer_load_dwordx4 v7, s[8:11], s22 offen lds
  s_and_b32 s51, s23, s59
  s_add_u32 m0, s56, s51
  s_nop 0
  buffer_load_dwordx4 v8, s[8:11], s22 offen lds
  s_add_u32 s25, s25, 1
  s_cmp_ge_u32 s25, 9
  s_cselect_b32 s25, 4, s25
  s_cmp_eq_u32 s24, 3
  s_cselect_b32 s25, s61, s25
  s_add_u32 s23, s23, 34816
  s_cmp_ge_u32 s23, 139264
  s_cselect_b32 s23, 0, s23
  s_add_u32 s24, s24, 1
  s_cmp_eq_u32 s24, 1
  s_cbranch_scc1 Lse_ploop
  s_waitcnt vmcnt(9)
  s_barrier
  s_cmp_eq_u32 s16, 4
  s_cbranch_scc1 Lse_pside
Lse_pback:
  s_cmp_lt_u32 s24, 9
  s_cbranch_scc1 Lse_ploop
  s_cmp_lg_u32 s16, 4
  s_cbranch_scc1 Lse_pfin
  buffer_load_dwordx2 v[10:11], v13, s[12:15], s58 offen sc1
  s_waitcnt vmcnt(0)
  v_subrev_u32 v10, s0, v10
  v_xor_b32 v11, s1, v11
  v_subrev_u32 v10, 1, v10
  v_and_or_b32 v10, v10, -4, v11
  v_cmp_ne_u32 vcc, 0, v10
  s_nop 0
  s_cbranch_vccz Lse_pax
  s_barrier
  s_mov_b32 s57, 1
  s_mov_b32 s60, 0
Lse_pa:
  buffer_load_dwordx2 v[10:11], v13, s[12:15], s58 offen sc1
  s_add_u32 s60, s60, 1
  s_waitcnt vmcnt(0)
  v_subrev_u32 v10, s0, v10
  v_xor_b32 v11, s1, v11
  v_subrev_u32 v10, 1, v10
  v_and_or_b32 v10, v10, -4, v11
  v_cmp_ne_u32 vcc, 0, v10
  s_cmp_ge_u32 s60, 400000
  s_cbranch_scc1 Lse_pax
  s_cbranch_vccz Lse_pax
  s_sleep 2
  s_branch Lse_pa
Lse_pax:
  s_mov_b32 m0, 139264
  s_lshl_b32 s50, s17, 10
  s_add_u32 s50, s50, 15007744
  buffer_load_dwordx4 v1, s[12:15], s50 offen sc1 lds
  s_mov_b32 m0, 140288
  s_mul_i32 s50, s18, 576
  s_add_u32 s50, s50, 15040512
  buffer_load_dwordx4 v1, s[12:15], s50 offen sc1 lds
  s_cmp_eq_u32 s57, 1
  s_cbranch_scc1 Lse_pf2
  s_barrier
  s_branch Lse_pf2
Lse_pfin:
  s_waitcnt vmcnt(0)
  s_barrier
Lse_pf2:
  s_waitcnt vmcnt(0)
  s_barrier
  s_branch Lse_ajoin
Lse_pside:
  s_cmp_eq_u32 s24, 5
  s_cbranch_scc1 Lse_ps5
  s_cmp_lg_u32 s24, 4
  s_cbranch_scc1 Lse_pback
  global_load_dwordx2 v[10:11], v12, s[38:39] sc1
  s_branch Lse_pback
Lse_ps5:
  s_mov_b32 s60, 0
  s_branch Lse_gnc
Lse_gn:
  s_sleep 2
  global_load_dwordx2 v[10:11], v12, s[38:39] sc1
  s_add_u32 s60, s60, 1
  s_waitcnt vmcnt(0)
Lse_gnc:
  v_readfirstlane_b32 s0, v10
  v_readfirstlane_b32 s1, v11
  s_cmp_ge_u32 s60, 400000
  s_cbranch_scc1 Lse_gnx
  s_cmp_eq_u32 s0, 0
  s_cbranch_scc1 Lse_gn
Lse_gnx:
  v_mov_b32 v14, 141312
  ds_write_b64 v14, v[10:11]
  s_lshl_b32 s50, s17, 3
  v_and_b32 v13, 7, v0
  v_add_u32 v13, s50, v13
  s_mul_i32 s50, s18, 144
  s_add_u32 s51, s50, 143
  s_lshr_b32 s50, s50, 6
  s_lshr_b32 s51, s51, 6
  v_and_b32 v14, 3, v0
  v_add_u32 v14, s50, v14
  v_min_u32 v14, s51, v14
  v_add_u32 v14, 209, v14
  v_cmp_gt_u32 vcc, 8, v0
  s_mov_b32 s58, 56254464
  s_waitcnt lgkmcnt(0)
  v_cndmask_b32 v13, v14, v13, vcc
  v_mul_u32_u24 v13, 128, v13
  s_branch Lse_pback
Lse_acons:
  s_cmp_lg_u32 s2, 0
  s_cbranch_scc1 Lse_an
  s_cmp_lg_u32 s16, 0
  s_cbranch_scc1 Lse_an
  s_memrealtime s[50:51]
  s_waitcnt lgkmcnt(0)
  s_lshr_b64 s[52:53], s[50:51], 29
  s_xor_b32 s52, s52, 0x9e3779b9
  s_lshl_b32 s50, s50, 2
  s_or_b32 s50, s50, 0x80000000
  v_mov_b32 v4, s50
  v_mov_b32 v5, s52
  v_mov_b32 v6, 0
  s_mov_b64 exec, 1
  global_store_dwordx2 v6, v[4:5], s[38:39] sc1
  s_mov_b64 exec, -1
Lse_an:
  s_waitcnt lgkmcnt(0)
  s_mov_b32 s12, s34
  s_mov_b32 s13, s35
  s_mov_b32 s14, 0x10000000
  s_mov_b32 s15, 0x20000
  s_lshr_b32 s19, s18, 2
  s_and_b32 s20, s18, 3
  v_lshrrev_b32 v216, 1, v22
  v_xor_b32 v216, v216, v23
  v_lshlrev_b32 v216, 4, v216
  v_lshl_add_u32 v216, v22, 7, v216
  v_add_u32 v8, s49, v216
  v_xor_b32 v9, 64, v8
  v_lshrrev_b32 v216, 5, v0
  v_lshlrev_b32 v216, 4, v216
  v_bfe_u32 v217, v0, 2, 3
  v_add_u32 v216, v216, v217
  v_mul_u32_u24 v216, 288, v216
  v_add_u32 v216, 16384, v216
  v_bfe_u32 v217, v0, 1, 1
  v_mul_u32_u24 v217, 40, v217
  v_and_b32 v218, 1, v0
  v_lshl_add_u32 v217, v218, 4, v217
  v_add_u32 v10, v216, v217
  v_and_b32 v218, 3, v0
  v_mul_u32_u24 v218, 72, v218
  v_add3_u32 v11, v216, v218, 32
  s_mov_b32 s55, 155648
  s_mov_b32 s56, 2432
  s_mov_b32 s60, 1536
  s_mov_b32 s59, 512
  s_cmp_eq_u32 s19, 0
  s_cselect_b32 s55, 73728, s55
  s_cselect_b32 s56, 1152, s56
  s_cselect_b32 s57, 4980736, 0
  s_cselect_b32 s60, 1024, s60
  s_cselect_b32 s62, 0x3eae1a93, 1.0
  s_cmp_eq_u32 s19, 2
  s_cselect_b32 s58, 1024, 0
  s_cselect_b32 s59, 640, s59
  s_cselect_b32 s60, 2176, s60
  s_cselect_b32 s61, 3, 2
  s_mul_i32 s52, s48, s56
  s_add_u32 s57, s57, s52
  s_lshl_b32 s52, s20, 3
  s_mul_i32 s52, s52, s55
  s_add_u32 s57, s57, s52
  s_add_u32 s60, s60, s57
  s_add_u32 s57, s57, s58
  v_lshrrev_b32 v218, 1, v23
  v_mul_lo_u32 v20, v218, s55
  v_lshlrev_b32 v21, 2, v20
  v_and_b32 v219, 1, v23
  v_mul_lo_u32 v220, v219, s59
  v_lshlrev_b32 v221, 4, v22
  v_add3_u32 v20, v20, v220, v221
  v_and_b32 v220, 31, v0
  v_lshlrev_b32 v220, s61, v220
  v_add_u32 v21, v21, v220
  v_mul_u32_u24 v18, 80, v218
  v_lshl_add_u32 v18, v219, 5, v18
  v_add_u32 v18, 140288, v18
  v_mul_u32_u24 v19, 144, v23
  v_add_u32 v19, 140352, v19
  s_lshl_b32 s52, s3, 8
  s_add_u32 s52, s52, 139264
  v_lshl_add_u32 v17, v22, 3, s52
  v_mov_b32 v16, 0
  v_pk_mul_f32 v[116:117], v[16:17], v[16:17] op_sel_hi:[0,0]
  v_pk_mul_f32 v[118:119], v[16:17], v[16:17] op_sel_hi:[0,0]
  v_pk_mul_f32 v[120:121], v[16:17], v[16:17] op_sel_hi:[0,0]
  v_pk_mul_f32 v[122:123], v[16:17], v[16:17] op_sel_hi:[0,0]
  v_pk_mul_f32 v[124:125], v[16:17], v[16:17] op_sel_hi:[0,0]
  v_pk_mul_f32 v[126:127], v[16:17], v[16:17] op_sel_hi:[0,0]
  v_pk_mul_f32 v[128:129], v[16:17], v[16:17] op_sel_hi:[0,0]
  v_pk_mul_f32 v[130:131], v[16:17], v[16:17] op_sel_hi:[0,0]
  v_pk_mul_f32 v[132:133], v[16:17], v[16:17] op_sel_hi:[0,0]
  v_pk_mul_f32 v[134:135], v[16:17], v[16:17] op_sel_hi:[0,0]
  v_pk_mul_f32 v[136:137], v[16:17], v[16:17] op_sel_hi:[0,0]
  v_pk_mul_f32 v[138:139], v[16:17], v[16:17] op_sel_hi:[0,0]
  v_pk_mul_f32 v[140:141], v[16:17], v[16:17] op_sel_hi:[0,0]
  v_pk_mul_f32 v[142:143], v[16:17], v[16:17] op_sel_hi:[0,0]
  v_pk_mul_f32 v[144:145], v[16:17], v[16:17] op_sel_hi:[0,0]
  v_pk_mul_f32 v[146:147], v[16:17], v[16:17] op_sel_hi:[0,0]
  v_pk_mul_f32 v[148:149], v[16:17], v[16:17] op_sel_hi:[0,0]
  v_pk_mul_f32 v[150:151], v[16:17], v[16:17] op_sel_hi:[0,0]
  v_pk_mul_f32 v[152:153], v[16:17], v[16:17] op_sel_hi:[0,0]
  v_pk_mul_f32 v[154:155], v[16:17], v[16:17] op_sel_hi:[0,0]
  v_pk_mul_f32 v[156:157], v[16:17], v[16:17] op_sel_hi:[0,0]
  v_pk_mul_f32 v[158:159], v[16:17], v[16:17] op_sel_hi:[0,0]
  v_pk_mul_f32 v[160:161], v[16:17], v[16:17] op_sel_hi:[0,0]
  v_pk_mul_f32 v[162:163], v[16:17], v[16:17] op_sel_hi:[0,0]
  v_pk_mul_f32 v[164:165], v[16:17], v[16:17] op_sel_hi:[0,0]
  v_pk_mul_f32 v[166:167], v[16:17], v[16:17] op_sel_hi:[0,0]
  v_pk_mul_f32 v[168:169], v[16:17], v[16:17] op_sel_hi:[0,0]
  v_pk_mul_f32 v[170:171], v[16:17], v[16:17] op_sel_hi:[0,0]
  v_pk_mul_f32 v[172:173], v[16:17], v[16:17] op_sel_hi:[0,0]
  v_pk_mul_f32 v[174:175], v[16:17], v[16:17] op_sel_hi:[0,0]
  v_pk_mul_f32 v[176:177], v[16:17], v[16:17] op_sel_hi:[0,0]
  v_pk_mul_f32 v[178:179], v[16:17], v[16:17] op_sel_hi:[0,0]
  v_pk_mul_f32 v[180:181], v[16:17], v[16:17] op_sel_hi:[0,0]
  v_pk_mul_f32 v[182:183], v[16:17], v[16:17] op_sel_hi:[0,0]
  v_pk_mul_f32 v[184:185], v[16:17], v[16:17] op_sel_hi:[0,0]
  v_pk_mul_f32 v[186:187], v[16:17], v[16:17] op_sel_hi:[0,0]
  v_mov_b32 v12, v8
  v_mov_b32 v14, v10
  v_mov_b32 v13, v9
  v_mov_b32 v15, v11
  s_barrier
  ds_read_b128 v[100:103], v12 offset:0
  ds_read_b128 v[104:107], v12 offset:2048
  ds_read_b64_tr_b16 v[28:29], v14 offset:0
  ds_read_b64_tr_b16 v[30:31], v14 offset:2304
  ds_read_b64_tr_b16 v[32:33], v14 offset:8
  ds_read_b64_tr_b16 v[34:35], v14 offset:2312
  ds_read_b64_tr_b16 v[36:37], v14 offset:72
  ds_read_b64_tr_b16 v[38:39], v14 offset:2376
  ds_read_b64_tr_b16 v[40:41], v14 offset:80
  ds_read_b64_tr_b16 v[42:43], v14 offset:2384
  ds_read_b64_tr_b16 v[44:45], v14 offset:144
  ds_read_b64_tr_b16 v[46:47], v14 offset:2448
  ds_read_b64_tr_b16 v[48:49], v14 offset:152
  ds_read_b64_tr_b16 v[50:51], v14 offset:2456
  ds_read_b64_tr_b16 v[52:53], v14 offset:216
  ds_read_b64_tr_b16 v[54:55], v14 offset:2520
  ds_read_b64_tr_b16 v[56:57], v14 offset:224
  ds_read_b64_tr_b16 v[58:59], v14 offset:2528
  ds_read_b64_tr_b16 v[60:61], v15 offset:0
  ds_read_b64_tr_b16 v[62:63], v15 offset:2304
  s_mov_b32 s24, 0
  s_mov_b32 s25, 0
.p2align 6
Lse_aloop:
  s_waitcnt lgkmcnt(15)
  v_mfma_f32_16x16x32_bf16 v[116:119], v[28:31], v[100:103], v[116:119]
  ds_read_b128 v[108:111], v13 offset:0
  ds_read_b128 v[112:115], v13 offset:2048
  v_mfma_f32_16x16x32_bf16 v[120:123], v[28:31], v[104:107], v[120:123]
  ds_read_b64_tr_b16 v[64:65], v14 offset:9216
  ds_read_b64_tr_b16 v[66:67], v14 offset:11520
  s_waitcnt lgkmcnt(15)
  v_mfma_f32_16x16x32_bf16 v[124:127], v[32:35], v[100:103], v[124:127]
  ds_read_b64_tr_b16 v[68:69], v14 offset:9224
  v_mfma_f32_16x16x32_bf16 v[128:131], v[32:35], v[104:107], v[128:131]
  ds_read_b64_tr_b16 v[70:71], v14 offset:11528
  s_waitcnt lgkmcnt(15)
  v_mfma_f32_16x16x32_bf16 v[132:135], v[36:39], v[100:103], v[132:135]
  ds_read_b64_tr_b16 v[72:73], v14 offset:9288
  v_mfma_f32_16x16x32_bf16 v[136:139], v[36:39], v[104:107], v[136:139]
  ds_read_b64_tr_b16 v[74:75], v14 offset:11592
  s_waitcnt lgkmcnt(15)
  v_mfma_f32_16x16x32_bf16 v[140:143], v[40:43], v[100:103], v[140:143]
  ds_read_b64_tr_b16 v[76:77], v14 offset:9296
  v_mfma_f32_16x16x32_bf16 v[144:147], v[40:43], v[104:107], v[144:147]
  ds_read_b64_tr_b16 v[78:79], v14 offset:11600
  s_waitcnt lgkmcnt(15)
  v_mfma_f32_16x16x32_bf16 v[148:151], v[44:47], v[100:103], v[148:151]
  ds_read_b64_tr_b16 v[80:81], v14 offset:9360
  v_mfma_f32_16x16x32_bf16 v[152:155], v[44:47], v[104:107], v[152:155]
  ds_read_b64_tr_b16 v[82:83], v14 offset:11664
  s_waitcnt lgkmcnt(15)
  v_mfma_f32_16x16x32_bf16 v[156:159], v[48:51], v[100:103], v[156:159]
  ds_read_b64_tr_b16 v[84:85], v14 offset:9368
  v_mfma_f32_16x16x32_bf16 v[160:163], v[48:51], v[104:107], v[160:163]
  ds_read_b64_tr_b16 v[86:87], v14 offset:11672
  s_waitcnt lgkmcnt(15)
  v_mfma_f32_16x16x32_bf16 v[164:167], v[52:55], v[100:103], v[164:167]
  ds_read_b64_tr_b16 v[88:89], v14 offset:9432
  v_mfma_f32_16x16x32_bf16 v[168:171], v[52:55], v[104:107], v[168:171]
  ds_read_b64_tr_b16 v[90:91], v14 offset:11736
  s_waitcnt lgkmcnt(15)
  v_mfma_f32_16x16x32_bf16 v[172:175], v[56:59], v[100:103], v[172:175]
  ds_read_b64_tr_b16 v[92:93], v14 offset:9440
  v_mfma_f32_16x16x32_bf16 v[176:179], v[56:59], v[104:107], v[176:179]
  ds_read_b64_tr_b16 v[94:95], v14 offset:11744
  s_waitcnt lgkmcnt(15)
  v_mfma_f32_16x16x32_bf16 v[180:183], v[60:63], v[100:103], v[180:183]
  ds_read_b64_tr_b16 v[96:97], v15 offset:9216
  v_mfma_f32_16x16x32_bf16 v[184:187], v[60:63], v[104:107], v[184:187]
  ds_read_b64_tr_b16 v[98:99], v15 offset:11520
  s_add_u32 s24, s24, 34816
  s_cmp_ge_u32 s24, 139264
  s_cselect_b32 s24, 0, s24
  s_add_u32 s25, s25, 1
  v_add_u32 v12, s24, v8
  v_add_u32 v14, s24, v10
  v_add_u32 v13, s24, v9
  v_add_u32 v15, s24, v11
  s_barrier
  s_waitcnt lgkmcnt(15)
  v_mfma_f32_16x16x32_bf16 v[116:119], v[64:67], v[108:111], v[116:119]
  ds_read_b128 v[100:103], v12 offset:0
  ds_read_b128 v[104:107], v12 offset:2048
  v_mfma_f32_16x16x32_bf16 v[120:123], v[64:67], v[112:115], v[120:123]
  ds_read_b64_tr_b16 v[28:29], v14 offset:0
  ds_read_b64_tr_b16 v[30:31], v14 offset:2304
  s_waitcnt lgkmcnt(15)
  v_mfma_f32_16x16x32_bf16 v[124:127], v[68:71], v[108:111], v[124:127]
  ds_read_b64_tr_b16 v[32:33], v14 offset:8
  v_mfma_f32_16x16x32_bf16 v[128:131], v[68:71], v[112:115], v[128:131]
  ds_read_b64_tr_b16 v[34:35], v14 offset:2312
  s_waitcnt lgkmcnt(15)
  v_mfma_f32_16x16x32_bf16 v[132:135], v[72:75], v[108:111], v[132:135]
  ds_read_b64_tr_b16 v[36:37], v14 offset:72
  v_mfma_f32_16x16x32_bf16 v[136:139], v[72:75], v[112:115], v[136:139]
  ds_read_b64_tr_b16 v[38:39], v14 offset:2376
  s_waitcnt lgkmcnt(15)
  v_mfma_f32_16x16x32_bf16 v[140:143], v[76:79], v[108:111], v[140:143]
  ds_read_b64_tr_b16 v[40:41], v14 offset:80
  v_mfma_f32_16x16x32_bf16 v[144:147], v[76:79], v[112:115], v[144:147]
  ds_read_b64_tr_b16 v[42:43], v14 offset:2384
  s_waitcnt lgkmcnt(15)
  v_mfma_f32_16x16x32_bf16 v[148:151], v[80:83], v[108:111], v[148:151]
  ds_read_b64_tr_b16 v[44:45], v14 offset:144
  v_mfma_f32_16x16x32_bf16 v[152:155], v[80:83], v[112:115], v[152:155]
  ds_read_b64_tr_b16 v[46:47], v14 offset:2448
  s_waitcnt lgkmcnt(15)
  v_mfma_f32_16x16x32_bf16 v[156:159], v[84:87], v[108:111], v[156:159]
  ds_read_b64_tr_b16 v[48:49], v14 offset:152
  v_mfma_f32_16x16x32_bf16 v[160:163], v[84:87], v[112:115], v[160:163]
  ds_read_b64_tr_b16 v[50:51], v14 offset:2456
  s_waitcnt lgkmcnt(15)
  v_mfma_f32_16x16x32_bf16 v[164:167], v[88:91], v[108:111], v[164:167]
  ds_read_b64_tr_b16 v[52:53], v14 offset:216
  v_mfma_f32_16x16x32_bf16 v[168:171], v[88:91], v[112:115], v[168:171]
  ds_read_b64_tr_b16 v[54:55], v14 offset:2520
  s_waitcnt lgkmcnt(15)
  v_mfma_f32_16x16x32_bf16 v[172:175], v[92:95], v[108:111], v[172:175]
  ds_read_b64_tr_b16 v[56:57], v14 offset:224
  v_mfma_f32_16x16x32_bf16 v[176:179], v[92:95], v[112:115], v[176:179]
  ds_read_b64_tr_b16 v[58:59], v14 offset:2528
  s_waitcnt lgkmcnt(15)
  v_mfma_f32_16x16x32_bf16 v[180:183], v[96:99], v[108:111], v[180:183]
  ds_read_b64_tr_b16 v[60:61], v15 offset:0
  v_mfma_f32_16x16x32_bf16 v[184:187], v[96:99], v[112:115], v[184:187]
  ds_read_b64_tr_b16 v[62:63], v15 offset:2304
  s_cmp_lt_u32 s25, 9
  s_cbranch_scc1 Lse_aloop
  ds_read_b64 v[188:189], v17 offset:0
  ds_read_b64 v[190:191], v17 offset:128
  ds_read_b128 v[64:67], v18 offset:0
  ds_read_b128 v[68:71], v18 offset:16
  ds_read_b128 v[72:75], v18 offset:144
  ds_read_b128 v[76:79], v18 offset:160
  ds_read_b128 v[80:83], v18 offset:288
  ds_read_b128 v[84:87], v18 offset:304
  ds_read_b128 v[88:91], v18 offset:432
  ds_read_b128 v[92:95], v18 offset:448
  ds_read_b128 v[96:99], v19
  s_lshl_b32 s56, s55, 1
  s_waitcnt lgkmcnt(7)
  v_mul_f32 v188, s62, v188
  v_mul_f32 v189, v188, -v189
  v_mul_f32 v190, s62, v190
  v_mul_f32 v191, v190, -v191
  v_pk_mul_f32 v[192:193], v[64:65], v[188:189] op_sel:[0,1] op_sel_hi:[1,1]
  v_pk_mul_f32 v[194:195], v[66:67], v[188:189] op_sel:[0,1] op_sel_hi:[1,1]
  v_pk_fma_f32 v[192:193], v[116:117], v[188:189], v[192:193] op_sel:[0,0,0] op_sel_hi:[1,0,1]
  v_pk_fma_f32 v[194:195], v[118:119], v[188:189], v[194:195] op_sel:[0,0,0] op_sel_hi:[1,0,1]
  v_cvt_pk_bf16_f32 v28, v192, v193
  v_cvt_pk_bf16_f32 v29, v194, v195
  v_pk_mul_f32 v[196:197], v[68:69], v[188:189] op_sel:[0,1] op_sel_hi:[1,1]
  v_pk_mul_f32 v[198:199], v[70:71], v[188:189] op_sel:[0,1] op_sel_hi:[1,1]
  v_pk_fma_f32 v[196:197], v[124:125], v[188:189], v[196:197] op_sel:[0,0,0] op_sel_hi:[1,0,1]
  v_pk_fma_f32 v[198:199], v[126:127], v[188:189], v[198:199] op_sel:[0,0,0] op_sel_hi:[1,0,1]
  v_cvt_pk_bf16_f32 v30, v196, v197
  v_cvt_pk_bf16_f32 v31, v198, v199
  buffer_store_dwordx4 v[28:31], v20, s[12:15], s57 offen offset:0 sc1
  v_pk_mul_f32 v[192:193], v[64:65], v[190:191] op_sel:[0,1] op_sel_hi:[1,1]
  v_pk_mul_f32 v[194:195], v[66:67], v[190:191] op_sel:[0,1] op_sel_hi:[1,1]
  v_pk_fma_f32 v[192:193], v[120:121], v[190:191], v[192:193] op_sel:[0,0,0] op_sel_hi:[1,0,1]
  v_pk_fma_f32 v[194:195], v[122:123], v[190:191], v[194:195] op_sel:[0,0,0] op_sel_hi:[1,0,1]
  v_cvt_pk_bf16_f32 v32, v192, v193
  v_cvt_pk_bf16_f32 v33, v194, v195
  v_pk_mul_f32 v[196:197], v[68:69], v[190:191] op_sel:[0,1] op_sel_hi:[1,1]
  v_pk_mul_f32 v[198:199], v[70:71], v[190:191] op_sel:[0,1] op_sel_hi:[1,1]
  v_pk_fma_f32 v[196:197], v[128:129], v[190:191], v[196:197] op_sel:[0,0,0] op_sel_hi:[1,0,1]
  v_pk_fma_f32 v[198:199], v[130:131], v[190:191], v[198:199] op_sel:[0,0,0] op_sel_hi:[1,0,1]
  v_cvt_pk_bf16_f32 v34, v196, v197
  v_cvt_pk_bf16_f32 v35, v198, v199
  buffer_store_dwordx4 v[32:35], v20, s[12:15], s57 offen offset:256 sc1
  s_add_u32 s57, s57, s56
  s_waitcnt lgkmcnt(0)
  v_pk_mul_f32 v[192:193], v[72:73], v[188:189] op_sel:[0,1] op_sel_hi:[1,1]
  v_pk_mul_f32 v[194:195], v[74:75], v[188:189] op_sel:[0,1] op_sel_hi:[1,1]
  v_pk_fma_f32 v[192:193], v[132:133], v[188:189], v[192:193] op_sel:[0,0,0] op_sel_hi:[1,0,1]
  v_pk_fma_f32 v[194:195], v[134:135], v[188:189], v[194:195] op_sel:[0,0,0] op_sel_hi:[1,0,1]
  v_cvt_pk_bf16_f32 v36, v192, v193
  v_cvt_pk_bf16_f32 v37, v194, v195
  v_pk_mul_f32 v[196:197], v[76:77], v[188:189] op_sel:[0,1] op_sel_hi:[1,1]
  v_pk_mul_f32 v[198:199], v[78:79], v[188:189] op_sel:[0,1] op_sel_hi:[1,1]
  v_pk_fma_f32 v[196:197], v[140:141], v[188:189], v[196:197] op_sel:[0,0,0] op_sel_hi:[1,0,1]
  v_pk_fma_f32 v[198:199], v[142:143], v[188:189], v[198:199] op_sel:[0,0,0] op_sel_hi:[1,0,1]
  v_cvt_pk_bf16_f32 v38, v196, v197
  v_cvt_pk_bf16_f32 v39, v198, v199
  buffer_store_dwordx4 v[36:39], v20, s[12:15], s57 offen offset:0 sc1
  v_pk_mul_f32 v[192:193], v[72:73], v[190:191] op_sel:[0,1] op_sel_hi:[1,1]
  v_pk_mul_f32 v[194:195], v[74:75], v[190:191] op_sel:[0,1] op_sel_hi:[1,1]
  v_pk_fma_f32 v[192:193], v[136:137], v[190:191], v[192:193] op_sel:[0,0,0] op_sel_hi:[1,0,1]
  v_pk_fma_f32 v[194:195], v[138:139], v[190:191], v[194:195] op_sel:[0,0,0] op_sel_hi:[1,0,1]
  v_cvt_pk_bf16_f32 v40, v192, v193
  v_cvt_pk_bf16_f32 v41, v194, v195
  v_pk_mul_f32 v[196:197], v[76:77], v[190:191] op_sel:[0,1] op_sel_hi:[1,1]
  v_pk_mul_f32 v[198:199], v[78:79], v[190:191] op_sel:[0,1] op_sel_hi:[1,1]
  v_pk_fma_f32 v[196:197], v[144:145], v[190:191], v[196:197] op_sel:[0,0,0] op_sel_hi:[1,0,1]
  v_pk_fma_f32 v[198:199], v[146:147], v[190:191], v[198:199] op_sel:[0,0,0] op_sel_hi:[1,0,1]
  v_cvt_pk_bf16_f32 v42, v196, v197
  v_cvt_pk_bf16_f32 v43, v198, v199
  buffer_store_dwordx4 v[40:43], v20, s[12:15], s57 offen offset:256 sc1
  s_add_u32 s57, s57, s56
  v_pk_mul_f32 v[192:193], v[80:81], v[188:189] op_sel:[0,1] op_sel_hi:[1,1]
  v_pk_mul_f32 v[194:195], v[82:83], v[188:189] op_sel:[0,1] op_sel_hi:[1,1]
  v_pk_fma_f32 v[192:193], v[148:149], v[188:189], v[192:193] op_sel:[0,0,0] op_sel_hi:[1,0,1]
  v_pk_fma_f32 v[194:195], v[150:151], v[188:189], v[194:195] op_sel:[0,0,0] op_sel_hi:[1,0,1]
  v_cvt_pk_bf16_f32 v44, v192, v193
  v_cvt_pk_bf16_f32 v45, v194, v195
  v_pk_mul_f32 v[196:197], v[84:85], v[188:189] op_sel:[0,1] op_sel_hi:[1,1]
  v_pk_mul_f32 v[198:199], v[86:87], v[188:189] op_sel:[0,1] op_sel_hi:[1,1]
  v_pk_fma_f32 v[196:197], v[156:157], v[188:189], v[196:197] op_sel:[0,0,0] op_sel_hi:[1,0,1]
  v_pk_fma_f32 v[198:199], v[158:159], v[188:189], v[198:199] op_sel:[0,0,0] op_sel_hi:[1,0,1]
  v_cvt_pk_bf16_f32 v46, v196, v197
  v_cvt_pk_bf16_f32 v47, v198, v199
  buffer_store_dwordx4 v[44:47], v20, s[12:15], s57 offen offset:0 sc1
  v_pk_mul_f32 v[192:193], v[80:81], v[190:191] op_sel:[0,1] op_sel_hi:[1,1]
  v_pk_mul_f32 v[194:195], v[82:83], v[190:191] op_sel:[0,1] op_sel_hi:[1,1]
  v_pk_fma_f32 v[192:193], v[152:153], v[190:191], v[192:193] op_sel:[0,0,0] op_sel_hi:[1,0,1]
  v_pk_fma_f32 v[194:195], v[154:155], v[190:191], v[194:195] op_sel:[0,0,0] op_sel_hi:[1,0,1]
  v_cvt_pk_bf16_f32 v48, v192, v193
  v_cvt_pk_bf16_f32 v49, v194, v195
  v_pk_mul_f32 v[196:197], v[84:85], v[190:191] op_sel:[0,1] op_sel_hi:[1,1]
  v_pk_mul_f32 v[198:199], v[86:87], v[190:191] op_sel:[0,1] op_sel_hi:[1,1]
  v_pk_fma_f32 v[196:197], v[160:161], v[190:191], v[196:197] op_sel:[0,0,0] op_sel_hi:[1,0,1]
  v_pk_fma_f32 v[198:199], v[162:163], v[190:191], v[198:199] op_sel:[0,0,0] op_sel_hi:[1,0,1]
  v_cvt_pk_bf16_f32 v50, v196, v197
  v_cvt_pk_bf16_f32 v51, v198, v199
  buffer_store_dwordx4 v[48:51], v20, s[12:15], s57 offen offset:256 sc1
  s_add_u32 s57, s57, s56
  v_pk_mul_f32 v[192:193], v[88:89], v[188:189] op_sel:[0,1] op_sel_hi:[1,1]
  v_pk_mul_f32 v[194:195], v[90:91], v[188:189] op_sel:[0,1] op_sel_hi:[1,1]
  v_pk_fma_f32 v[192:193], v[164:165], v[188:189], v[192:193] op_sel:[0,0,0] op_sel_hi:[1,0,1]
  v_pk_fma_f32 v[194:195], v[166:167], v[188:189], v[194:195] op_sel:[0,0,0] op_sel_hi:[1,0,1]
  v_cvt_pk_bf16_f32 v52, v192, v193
  v_cvt_pk_bf16_f32 v53, v194, v195
  v_pk_mul_f32 v[196:197], v[92:93], v[188:189] op_sel:[0,1] op_sel_hi:[1,1]
  v_pk_mul_f32 v[198:199], v[94:95], v[188:189] op_sel:[0,1] op_sel_hi:[1,1]
  v_pk_fma_f32 v[196:197], v[172:173], v[188:189], v[196:197] op_sel:[0,0,0] op_sel_hi:[1,0,1]
  v_pk_fma_f32 v[198:199], v[174:175], v[188:189], v[198:199] op_sel:[0,0,0] op_sel_hi:[1,0,1]
  v_cvt_pk_bf16_f32 v54, v196, v197
  v_cvt_pk_bf16_f32 v55, v198, v199
  buffer_store_dwordx4 v[52:55], v20, s[12:15], s57 offen offset:0 sc1
  v_pk_mul_f32 v[192:193], v[88:89], v[190:191] op_sel:[0,1] op_sel_hi:[1,1]
  v_pk_mul_f32 v[194:195], v[90:91], v[190:191] op_sel:[0,1] op_sel_hi:[1,1]
  v_pk_fma_f32 v[192:193], v[168:169], v[190:191], v[192:193] op_sel:[0,0,0] op_sel_hi:[1,0,1]
  v_pk_fma_f32 v[194:195], v[170:171], v[190:191], v[194:195] op_sel:[0,0,0] op_sel_hi:[1,0,1]
  v_cvt_pk_bf16_f32 v56, v192, v193
  v_cvt_pk_bf16_f32 v57, v194, v195
  v_pk_mul_f32 v[196:197], v[92:93], v[190:191] op_sel:[0,1] op_sel_hi:[1,1]
  v_pk_mul_f32 v[198:199], v[94:95], v[190:191] op_sel:[0,1] op_sel_hi:[1,1]
  v_pk_fma_f32 v[196:197], v[176:177], v[190:191], v[196:197] op_sel:[0,0,0] op_sel_hi:[1,0,1]
  v_pk_fma_f32 v[198:199], v[178:179], v[190:191], v[198:199] op_sel:[0,0,0] op_sel_hi:[1,0,1]
  v_cvt_pk_bf16_f32 v58, v196, v197
  v_cvt_pk_bf16_f32 v59, v198, v199
  buffer_store_dwordx4 v[56:59], v20, s[12:15], s57 offen offset:256 sc1
  s_add_u32 s57, s57, s56
  v_pk_mul_f32 v[192:193], v[96:97], v[188:189] op_sel:[0,1] op_sel_hi:[1,1]
  v_pk_mul_f32 v[194:195], v[98:99], v[188:189] op_sel:[0,1] op_sel_hi:[1,1]
  v_pk_fma_f32 v[192:193], v[180:181], v[188:189], v[192:193] op_sel:[0,0,0] op_sel_hi:[1,0,1]
  v_pk_fma_f32 v[194:195], v[182:183], v[188:189], v[194:195] op_sel:[0,0,0] op_sel_hi:[1,0,1]
  v_cvt_pk_bf16_f32 v200, v192, v193
  v_cvt_pk_bf16_f32 v202, v194, v195
  v_pk_mul_f32 v[196:197], v[96:97], v[190:191] op_sel:[0,1] op_sel_hi:[1,1]
  v_pk_mul_f32 v[198:199], v[98:99], v[190:191] op_sel:[0,1] op_sel_hi:[1,1]
  v_pk_fma_f32 v[196:197], v[184:185], v[190:191], v[196:197] op_sel:[0,0,0] op_sel_hi:[1,0,1]
  v_pk_fma_f32 v[198:199], v[186:187], v[190:191], v[198:199] op_sel:[0,0,0] op_sel_hi:[1,0,1]
  v_cvt_pk_bf16_f32 v204, v196, v197
  v_cvt_pk_bf16_f32 v206, v198, v199
  v_mov_b32 v201, 0x3f80
  v_mov_b32 v203, 0x3f80
  v_mov_b32 v205, 0x3f80
  v_mov_b32 v207, 0x3f80
  v_permlane16_swap_b32 v200, v204
  v_permlane16_swap_b32 v202, v206
  s_cmp_eq_u32 s19, 2
  s_cbranch_scc1 Lse_xv
  buffer_store_dword v200, v21, s[12:15], s60 offen sc1
  s_add_u32 s60, s60, s55
  buffer_store_dword v202, v21, s[12:15], s60 offen sc1
  s_add_u32 s60, s60, s55
  buffer_store_dword v204, v21, s[12:15], s60 offen sc1
  s_add_u32 s60, s60, s55
  buffer_store_dword v206, v21, s[12:15], s60 offen sc1
  s_add_u32 s60, s60, s55
  s_branch Lse_ajoin
Lse_xv:
  buffer_store_dwordx2 v[200:201], v21, s[12:15], s60 offen sc1
  s_add_u32 s60, s60, s55
  buffer_store_dwordx2 v[202:203], v21, s[12:15], s60 offen sc1
  s_add_u32 s60, s60, s55
  buffer_store_dwordx2 v[204:205], v21, s[12:15], s60 offen sc1
  s_add_u32 s60, s60, s55
  buffer_store_dwordx2 v[206:207], v21, s[12:15], s60 offen sc1
  s_add_u32 s60, s60, s55
Lse_ajoin:
  v_mov_b32 v4, 141312
  ds_read_b64 v[4:5], v4
  s_lshl_b32 s50, s18, 4
  s_add_u32 s50, s50, s17
  s_mul_i32 s50, s50, 128
  s_add_u32 s50, s50, 56229888
  s_cmp_lg_u32 s16, 0
  s_cselect_b32 s50, 1073741824, s50
  s_waitcnt lgkmcnt(0)
  v_readfirstlane_b32 s0, v4
  v_readfirstlane_b32 s1, v5
  s_waitcnt vmcnt(0)
  s_barrier
  v_mov_b32 v4, 1
  v_mov_b32 v5, s1
  v_add_u32 v4, s0, v4
  v_lshlrev_b32 v6, 3, v0
  s_mov_b64 exec, 65535
  buffer_store_dwordx2 v[4:5], v6, s[12:15], s50 offen sc1
  s_mov_b64 exec, -1
  s_branch Lse_aend
Lse_aux:
  s_cmp_lg_u32 s16, 7
  s_cbranch_scc1 Lse_aux2
  s_sub_u32 s53, s27, 24
  s_getpc_b64 s[50:51]
Lpcse748:
  s_add_u32 s50, s50, sequential_preLN__softmax_full_mha__glu_gated_bilinear__prompt_kernel-Lpcse748
  s_addc_u32 s51, s51, (sequential_preLN__softmax_full_mha__glu_gated_bilinear__prompt_kernel-Lpcse748)>>32
  s_lshl_b32 s52, s53, 13
  v_lshl_add_u32 v18, v0, 7, s52
  v_min_u32 v18, Lse_end-sequential_preLN__softmax_full_mha__glu_gated_bilinear__prompt_kernel-4, v18
  global_load_dword v19, v18, s[50:51]
Lse_aux2:
  v_mov_b32 v24, 0x3f803f80
  v_mov_b32 v25, 0x3f803f80
  v_mov_b32 v26, 0x3f803f80
  v_mov_b32 v27, 0x3f803f80
  v_mov_b32 v14, 0
  v_mov_b32 v15, 0
  v_mov_b32 v16, 0
  s_waitcnt lgkmcnt(0)
  s_mov_b32 s12, s34
  s_mov_b32 s13, s35
  s_mov_b32 s14, 0x10000000
  s_mov_b32 s15, 0x20000
  s_sub_u32 s17, s2, 192
  s_mov_b32 s63, 1073741824
  s_cmp_lt_u32 s17, 27
  s_cbranch_scc1 Lse_acs
  s_sub_u32 s17, s17, 27
  s_mul_i32 s18, s16, 26
  s_add_u32 s18, s18, s17
  s_cmp_ge_u32 s18, 128
  s_cselect_b32 s18, 999, s18
  s_mul_i32 s19, s16, 11
  s_add_u32 s19, s19, s17
  s_add_u32 s19, s19, 102
  s_cmp_lt_u32 s17, 26
  s_cselect_b32 s17, s18, s19
  s_sub_u32 s17, s2, 219
  s_mul_i32 s18, s16, 37
  s_add_u32 s17, s17, s18
  s_cmp_ge_u32 s17, 209
  s_cbranch_scc1 Lse_aidle
  s_mul_i32 s63, s17, 128
  s_add_u32 s63, s63, 56254464
  s_cmp_lt_u32 s17, 128
  s_cbranch_scc1 Lse_ast
  s_mov_b32 s24, s32
  s_mov_b32 s25, s33
  s_mov_b32 s26, 0xa2000
  s_mov_b32 s27, 0x20000
  s_barrier
  s_cmp_ge_u32 s17, 173
  s_cbranch_scc1 Lse_awb
  s_sub_u32 s18, s17, 128
  s_mov_b32 s50, 1152
  s_mov_b32 s54, 36864
  s_mov_b32 s55, 1024
  s_mov_b32 s52, 41472
  s_mov_b32 s56, 8
  s_mov_b32 s57, 20
  s_mov_b32 s58, 4
  s_mul_i32 s19, s18, 7282
  s_lshr_b32 s19, s19, 16
  s_mul_i32 s20, s19, 9
  s_sub_u32 s20, s18, s20
  s_mul_i32 s51, s19, 165888
  s_mul_i32 s53, s19, 147456
  s_add_u32 s53, s53, 15728640
  s_lshl_b32 s21, s20, 12
  s_add_u32 s53, s53, s21
  s_cmp_ge_u32 s18, 36
  s_cselect_b32 s51, 18432, s51
  s_cselect_b32 s52, 331776, s52
  s_cselect_b32 s56, 72, s56
  s_cselect_b32 s57, 144, s57
  s_cselect_b32 s58, 36, s58
  s_lshl_b32 s21, s20, 7
  s_add_u32 s51, s51, s21
  s_lshl_b32 s21, s16, 11
  s_mul_i32 s57, s57, s50
  s_mul_i32 s58, s58, s50
  v_lshrrev_b32 v2, 5, v0
  v_mul_lo_u32 v2, v2, s56
  v_bfe_u32 v12, v0, 3, 2
  v_add_u32 v2, v2, v12
  v_mul_lo_u32 v2, v2, s50
  v_and_b32 v12, 7, v0
  v_lshl_add_u32 v2, v12, 4, v2
  v_add_u32 v3, s21, v1
  v_lshrrev_b32 v4, 2, v0
  v_lshlrev_b32 v4, 7, v4
  v_and_b32 v12, 3, v0
  v_lshl_add_u32 v4, v12, 3, v4
  v_add_u32 v4, s21, v4
  buffer_load_dwordx4 v[28:31], v2, s[24:27], s51 offen
  s_add_u32 s59, s51, s57
  buffer_load_dwordx4 v[32:35], v2, s[24:27], s59 offen
  s_add_u32 s59, s51, s58
  buffer_load_dwordx4 v[36:39], v2, s[24:27], s59 offen
  s_add_u32 s59, s59, s57
  buffer_load_dwordx4 v[40:43], v2, s[24:27], s59 offen
  s_add_u32 s51, s51, s52
  buffer_load_dwordx4 v[44:47], v2, s[24:27], s51 offen
  s_add_u32 s59, s51, s57
  buffer_load_dwordx4 v[48:51], v2, s[24:27], s59 offen
  s_add_u32 s59, s51, s58
  buffer_load_dwordx4 v[52:55], v2, s[24:27], s59 offen
  s_add_u32 s59, s59, s57
  buffer_load_dwordx4 v[56:59], v2, s[24:27], s59 offen
  s_add_u32 s51, s51, s52
  buffer_load_dwordx4 v[60:63], v2, s[24:27], s51 offen
  s_add_u32 s59, s51, s57
  buffer_load_dwordx4 v[64:67], v2, s[24:27], s59 offen
  s_add_u32 s59, s51, s58
  buffer_load_dwordx4 v[68:71], v2, s[24:27], s59 offen
  s_add_u32 s59, s59, s57
  buffer_load_dwordx4 v[72:75], v2, s[24:27], s59 offen
  s_add_u32 s51, s51, s52
  buffer_load_dwordx4 v[76:79], v2, s[24:27], s51 offen
  s_add_u32 s59, s51, s57
  buffer_load_dwordx4 v[80:83], v2, s[24:27], s59 offen
  s_add_u32 s59, s51, s58
  buffer_load_dwordx4 v[84:87], v2, s[24:27], s59 offen
  s_add_u32 s59, s59, s57
  buffer_load_dwordx4 v[88:91], v2, s[24:27], s59 offen
  s_add_u32 s51, s51, s52
  global_load_dwordx2 v[14:15], v16, s[38:39] sc1
  s_waitcnt vmcnt(15)
  ds_write_b128 v3, v[28:31] offset:0
  ds_write_b128 v3, v[32:35] offset:1024
  ds_read_b64_tr_b16 v[92:93], v4 offset:0
  ds_read_b64_tr_b16 v[96:97], v4 offset:32
  ds_read_b64_tr_b16 v[100:101], v4 offset:64
  ds_read_b64_tr_b16 v[104:105], v4 offset:96
  s_waitcnt vmcnt(13)
  ds_write_b128 v3, v[36:39] offset:0
  ds_write_b128 v3, v[40:43] offset:1024
  ds_read_b64_tr_b16 v[94:95], v4 offset:0
  ds_read_b64_tr_b16 v[98:99], v4 offset:32
  ds_read_b64_tr_b16 v[102:103], v4 offset:64
  ds_read_b64_tr_b16 v[106:107], v4 offset:96
  s_waitcnt lgkmcnt(0)
  s_mov_b32 s59, s53
  buffer_store_dwordx4 v[92:95], v1, s[12:15], s59 offen sc1
  s_add_u32 s59, s59, s55
  buffer_store_dwordx4 v[96:99], v1, s[12:15], s59 offen sc1
  s_add_u32 s59, s59, s55
  buffer_store_dwordx4 v[100:103], v1, s[12:15], s59 offen sc1
  s_add_u32 s59, s59, s55
  buffer_store_dwordx4 v[104:107], v1, s[12:15], s59 offen sc1
  s_add_u32 s53, s53, s54
  s_waitcnt vmcnt(15)
  ds_write_b128 v3, v[44:47] offset:0
  ds_write_b128 v3, v[48:51] offset:1024
  ds_read_b64_tr_b16 v[108:109], v4 offset:0
  ds_read_b64_tr_b16 v[112:113], v4 offset:32
  ds_read_b64_tr_b16 v[116:117], v4 offset:64
  ds_read_b64_tr_b16 v[120:121], v4 offset:96
  s_waitcnt vmcnt(13)
  ds_write_b128 v3, v[52:55] offset:0
  ds_write_b128 v3, v[56:59] offset:1024
  ds_read_b64_tr_b16 v[110:111], v4 offset:0
  ds_read_b64_tr_b16 v[114:115], v4 offset:32
  ds_read_b64_tr_b16 v[118:119], v4 offset:64
  ds_read_b64_tr_b16 v[122:123], v4 offset:96
  s_waitcnt lgkmcnt(0)
  s_mov_b32 s59, s53
  buffer_store_dwordx4 v[108:111], v1, s[12:15], s59 offen sc1
  s_add_u32 s59, s59, s55
  buffer_store_dwordx4 v[112:115], v1, s[12:15], s59 offen sc1
  s_add_u32 s59, s59, s55
  buffer_store_dwordx4 v[116:119], v1, s[12:15], s59 offen sc1
  s_add_u32 s59, s59, s55
  buffer_store_dwordx4 v[120:123], v1, s[12:15], s59 offen sc1
  s_add_u32 s53, s53, s54
  s_waitcnt vmcnt(15)
  ds_write_b128 v3, v[60:63] offset:0
  ds_write_b128 v3, v[64:67] offset:1024
  ds_read_b64_tr_b16 v[92:93], v4 offset:0
  ds_read_b64_tr_b16 v[96:97], v4 offset:32
  ds_read_b64_tr_b16 v[100:101], v4 offset:64
  ds_read_b64_tr_b16 v[104:105], v4 offset:96
  s_waitcnt vmcnt(13)
  ds_write_b128 v3, v[68:71] offset:0
  ds_write_b128 v3, v[72:75] offset:1024
  ds_read_b64_tr_b16 v[94:95], v4 offset:0
  ds_read_b64_tr_b16 v[98:99], v4 offset:32
  ds_read_b64_tr_b16 v[102:103], v4 offset:64
  ds_read_b64_tr_b16 v[106:107], v4 offset:96
  s_waitcnt lgkmcnt(0)
  s_mov_b32 s59, s53
  buffer_store_dwordx4 v[92:95], v1, s[12:15], s59 offen sc1
  s_add_u32 s59, s59, s55
  buffer_store_dwordx4 v[96:99], v1, s[12:15], s59 offen sc1
  s_add_u32 s59, s59, s55
  buffer_store_dwordx4 v[100:103], v1, s[12:15], s59 offen sc1
  s_add_u32 s59, s59, s55
  buffer_store_dwordx4 v[104:107], v1, s[12:15], s59 offen sc1
  s_add_u32 s53, s53, s54
  s_waitcnt vmcnt(15)
  ds_write_b128 v3, v[76:79] offset:0
  ds_write_b128 v3, v[80:83] offset:1024
  ds_read_b64_tr_b16 v[108:109], v4 offset:0
  ds_read_b64_tr_b16 v[112:113], v4 offset:32
  ds_read_b64_tr_b16 v[116:117], v4 offset:64
  ds_read_b64_tr_b16 v[120:121], v4 offset:96
  s_waitcnt vmcnt(13)
  ds_write_b128 v3, v[84:87] offset:0
  ds_write_b128 v3, v[88:91] offset:1024
  ds_read_b64_tr_b16 v[110:111], v4 offset:0
  ds_read_b64_tr_b16 v[114:115], v4 offset:32
  ds_read_b64_tr_b16 v[118:119], v4 offset:64
  ds_read_b64_tr_b16 v[122:123], v4 offset:96
  s_waitcnt lgkmcnt(0)
  s_mov_b32 s59, s53
  buffer_store_dwordx4 v[108:111], v1, s[12:15], s59 offen sc1
  s_add_u32 s59, s59, s55
  buffer_store_dwordx4 v[112:115], v1, s[12:15], s59 offen sc1
  s_add_u32 s59, s59, s55
  buffer_store_dwordx4 v[116:119], v1, s[12:15], s59 offen sc1
  s_add_u32 s59, s59, s55
  buffer_store_dwordx4 v[120:123], v1, s[12:15], s59 offen sc1
  s_add_u32 s53, s53, s54
  s_branch Lse_asyn
Lse_awb:
  s_sub_u32 s17, s17, 173
  s_lshr_b32 s18, s17, 1
  s_and_b32 s19, s17, 1
  s_mul_i32 s20, s18, 36
  s_mul_i32 s21, s19, 20
  s_add_u32 s20, s20, s21
  v_add_u32 v2, s20, v22
  s_sub_u32 s20, s17, 32
  s_mul_i32 s20, s20, 144
  s_add_u32 s20, s20, 16
  v_lshrrev_b32 v3, 2, v22
  v_mul_u32_u24 v3, 36, v3
  v_and_b32 v4, 3, v22
  v_add3_u32 v3, v3, v4, s20
  s_cmp_ge_u32 s17, 32
  s_cselect_b64 vcc, -1, 0
  s_mov_b32 s22, 1
  v_cndmask_b32 v2, v2, v3, vcc
  s_branch Lse_arow
Lse_ast:
  s_mov_b32 s24, s28
  s_mov_b32 s25, s29
  s_mov_b32 s26, 0x240000
  s_mov_b32 s27, 0x20000
  s_lshl_b32 s20, s17, 4
  v_add_u32 v2, s20, v22
  s_mov_b32 s22, 0
Lse_arow:
  v_mul_u32_u24 v2, 1152, v2
  v_lshl_add_u32 v2, v23, 4, v2
  buffer_load_dwordx4 v[28:31], v2, s[24:27], 0 offen offset:0
  buffer_load_dwordx4 v[32:35], v2, s[24:27], 0 offen offset:64
  buffer_load_dwordx4 v[36:39], v2, s[24:27], 0 offen offset:128
  buffer_load_dwordx4 v[40:43], v2, s[24:27], 0 offen offset:192
  buffer_load_dwordx4 v[44:47], v2, s[24:27], 0 offen offset:256
  buffer_load_dwordx4 v[48:51], v2, s[24:27], 0 offen offset:320
  buffer_load_dwordx4 v[52:55], v2, s[24:27], 0 offen offset:384
  buffer_load_dwordx4 v[56:59], v2, s[24:27], 0 offen offset:448
  buffer_load_dwordx4 v[60:63], v2, s[24:27], 0 offen offset:512
  buffer_load_dwordx4 v[64:67], v2, s[24:27], 0 offen offset:576
  buffer_load_dwordx4 v[68:71], v2, s[24:27], 0 offen offset:640
  buffer_load_dwordx4 v[72:75], v2, s[24:27], 0 offen offset:704
  buffer_load_dwordx4 v[76:79], v2, s[24:27], 0 offen offset:768
  buffer_load_dwordx4 v[80:83], v2, s[24:27], 0 offen offset:832
  buffer_load_dwordx4 v[84:87], v2, s[24:27], 0 offen offset:896
  buffer_load_dwordx4 v[88:91], v2, s[24:27], 0 offen offset:960
  buffer_load_dwordx4 v[92:95], v2, s[24:27], 0 offen offset:1024
  buffer_load_dwordx4 v[96:99], v2, s[24:27], 0 offen offset:1088
  global_load_dwordx2 v[14:15], v16, s[38:39] sc1
  s_waitcnt vmcnt(18)
  v_mfma_f32_16x16x32_bf16 v[4:7], v[24:27], v[28:31], 0
  v_mfma_f32_16x16x32_bf16 v[8:11], v[28:31], v[28:31], 0
  s_waitcnt vmcnt(17)
  v_mfma_f32_16x16x32_bf16 v[4:7], v[24:27], v[32:35], v[4:7]
  v_mfma_f32_16x16x32_bf16 v[8:11], v[32:35], v[32:35], v[8:11]
  s_waitcnt vmcnt(16)
  v_mfma_f32_16x16x32_bf16 v[4:7], v[24:27], v[36:39], v[4:7]
  v_mfma_f32_16x16x32_bf16 v[8:11], v[36:39], v[36:39], v[8:11]
  s_waitcnt vmcnt(15)
  v_mfma_f32_16x16x32_bf16 v[4:7], v[24:27], v[40:43], v[4:7]
  v_mfma_f32_16x16x32_bf16 v[8:11], v[40:43], v[40:43], v[8:11]
  s_waitcnt vmcnt(14)
  v_mfma_f32_16x16x32_bf16 v[4:7], v[24:27], v[44:47], v[4:7]
  v_mfma_f32_16x16x32_bf16 v[8:11], v[44:47], v[44:47], v[8:11]
  s_waitcnt vmcnt(13)
  v_mfma_f32_16x16x32_bf16 v[4:7], v[24:27], v[48:51], v[4:7]
  v_mfma_f32_16x16x32_bf16 v[8:11], v[48:51], v[48:51], v[8:11]
  s_waitcnt vmcnt(12)
  v_mfma_f32_16x16x32_bf16 v[4:7], v[24:27], v[52:55], v[4:7]
  v_mfma_f32_16x16x32_bf16 v[8:11], v[52:55], v[52:55], v[8:11]
  s_waitcnt vmcnt(11)
  v_mfma_f32_16x16x32_bf16 v[4:7], v[24:27], v[56:59], v[4:7]
  v_mfma_f32_16x16x32_bf16 v[8:11], v[56:59], v[56:59], v[8:11]
  s_waitcnt vmcnt(10)
  v_mfma_f32_16x16x32_bf16 v[4:7], v[24:27], v[60:63], v[4:7]
  v_mfma_f32_16x16x32_bf16 v[8:11], v[60:63], v[60:63], v[8:11]
  s_waitcnt vmcnt(9)
  v_mfma_f32_16x16x32_bf16 v[4:7], v[24:27], v[64:67], v[4:7]
  v_mfma_f32_16x16x32_bf16 v[8:11], v[64:67], v[64:67], v[8:11]
  s_waitcnt vmcnt(8)
  v_mfma_f32_16x16x32_bf16 v[4:7], v[24:27], v[68:71], v[4:7]
  v_mfma_f32_16x16x32_bf16 v[8:11], v[68:71], v[68:71], v[8:11]
  s_waitcnt vmcnt(7)
  v_mfma_f32_16x16x32_bf16 v[4:7], v[24:27], v[72:75], v[4:7]
  v_mfma_f32_16x16x32_bf16 v[8:11], v[72:75], v[72:75], v[8:11]
  s_waitcnt vmcnt(6)
  v_mfma_f32_16x16x32_bf16 v[4:7], v[24:27], v[76:79], v[4:7]
  v_mfma_f32_16x16x32_bf16 v[8:11], v[76:79], v[76:79], v[8:11]
  s_waitcnt vmcnt(5)
  v_mfma_f32_16x16x32_bf16 v[4:7], v[24:27], v[80:83], v[4:7]
  v_mfma_f32_16x16x32_bf16 v[8:11], v[80:83], v[80:83], v[8:11]
  s_waitcnt vmcnt(4)
  v_mfma_f32_16x16x32_bf16 v[4:7], v[24:27], v[84:87], v[4:7]
  v_mfma_f32_16x16x32_bf16 v[8:11], v[84:87], v[84:87], v[8:11]
  s_waitcnt vmcnt(3)
  v_mfma_f32_16x16x32_bf16 v[4:7], v[24:27], v[88:91], v[4:7]
  v_mfma_f32_16x16x32_bf16 v[8:11], v[88:91], v[88:91], v[8:11]
  s_waitcnt vmcnt(2)
  v_mfma_f32_16x16x32_bf16 v[4:7], v[24:27], v[92:95], v[4:7]
  v_mfma_f32_16x16x32_bf16 v[8:11], v[92:95], v[92:95], v[8:11]
  s_waitcnt vmcnt(1)
  v_mfma_f32_16x16x32_bf16 v[4:7], v[24:27], v[96:99], v[4:7]
  v_mfma_f32_16x16x32_bf16 v[8:11], v[96:99], v[96:99], v[8:11]
  s_mov_b32 s50, 0x3ae38e39
  v_and_b32 v12, 1, v0
  v_cmp_eq_u32 s[52:53], 1, v12
  v_and_b32 v12, 2, v0
  v_cmp_eq_u32 s[54:55], 2, v12
  v_lshrrev_b32 v12, 2, v22
  v_cmp_eq_u32 s[56:57], v12, v23
  s_cmp_eq_u32 s22, 0
  s_nop 0
  v_mul_f32 v5, s50, v4
  s_cbranch_scc1 Lse_ast2
  s_lshl_b32 s51, s17, 5
  s_add_u32 s51, s51, 14942208
  v_lshlrev_b32 v2, 1, v22
  v_cvt_pk_bf16_f32 v6, v5, v5
  v_and_b32 v7, 0xffff0000, v6
  v_sub_f32 v7, v5, v7
  v_cvt_pk_bf16_f32 v7, v7, v7
  s_mov_b64 exec, 0xffff
  buffer_store_short v6, v2, s[12:15], s51 offen sc1
  buffer_store_short v7, v2, s[12:15], s51 offen offset:1152 sc1
  s_mov_b64 exec, -1
  s_branch Lse_asyn
Lse_ast2:
  v_cndmask_b32 v8, v8, v9, s[52:53]
  v_cndmask_b32 v10, v10, v11, s[52:53]
  v_cndmask_b32 v8, v8, v10, s[54:55]
  v_mul_f32 v9, v5, v5
  v_fma_f32 v8, v8, s50, -v9
  v_max_f32 v8, 0, v8
  v_add_f32 v8, 0x3727c5ac, v8
  v_rsq_f32 v4, v8
  s_lshl_b32 s51, s17, 7
  s_add_u32 s51, s51, 15007744
  v_lshlrev_b32 v2, 3, v22
  s_mov_b64 exec, s[56:57]
  buffer_store_dwordx2 v[4:5], v2, s[12:15], s51 offen sc1
  s_mov_b64 exec, -1
  s_barrier
  s_branch Lse_asyn
Lse_acs:
  s_mov_b32 s24, s30
  s_mov_b32 s25, s31
  s_mov_b32 s26, 0x1e6000
  s_mov_b32 s27, 0x20000
  v_lshrrev_b32 v2, 3, v0
  v_mul_u32_u24 v2, 3456, v2
  v_and_b32 v3, 7, v0
  v_lshl_add_u32 v2, v3, 4, v2
  s_mul_i32 s18, s16, 248832
  s_lshl_b32 s19, s17, 7
  s_add_u32 s18, s18, s19
  buffer_load_dwordx4 v[28:31], v2, s[24:27], s18 offen
  s_add_u32 s18, s18, 27648
  buffer_load_dwordx4 v[32:35], v2, s[24:27], s18 offen
  s_add_u32 s18, s18, 27648
  buffer_load_dwordx4 v[36:39], v2, s[24:27], s18 offen
  s_add_u32 s18, s18, 27648
  buffer_load_dwordx4 v[40:43], v2, s[24:27], s18 offen
  s_add_u32 s18, s18, 27648
  buffer_load_dwordx4 v[44:47], v2, s[24:27], s18 offen
  s_add_u32 s18, s18, 27648
  buffer_load_dwordx4 v[48:51], v2, s[24:27], s18 offen
  s_add_u32 s18, s18, 27648
  buffer_load_dwordx4 v[52:55], v2, s[24:27], s18 offen
  s_add_u32 s18, s18, 27648
  buffer_load_dwordx4 v[56:59], v2, s[24:27], s18 offen
  s_add_u32 s18, s18, 27648
  buffer_load_dwordx4 v[60:63], v2, s[24:27], s18 offen
  s_add_u32 s18, s18, 27648
  s_waitcnt vmcnt(8)
  global_load_dwordx2 v[14:15], v16, s[38:39] sc1
  v_lshlrev_b32 v4, 16, v28
  v_and_b32 v5, 0xffff0000, v28
  v_lshlrev_b32 v6, 16, v29
  v_and_b32 v7, 0xffff0000, v29
  v_lshlrev_b32 v8, 16, v30
  v_and_b32 v9, 0xffff0000, v30
  v_lshlrev_b32 v10, 16, v31
  v_and_b32 v11, 0xffff0000, v31
  s_waitcnt vmcnt(8)
  v_lshlrev_b32 v12, 16, v32
  v_and_b32 v13, 0xffff0000, v32
  v_pk_add_f32 v[4:5], v[4:5], v[12:13]
  v_lshlrev_b32 v12, 16, v33
  v_and_b32 v13, 0xffff0000, v33
  v_pk_add_f32 v[6:7], v[6:7], v[12:13]
  v_lshlrev_b32 v12, 16, v34
  v_and_b32 v13, 0xffff0000, v34
  v_pk_add_f32 v[8:9], v[8:9], v[12:13]
  v_lshlrev_b32 v12, 16, v35
  v_and_b32 v13, 0xffff0000, v35
  v_pk_add_f32 v[10:11], v[10:11], v[12:13]
  s_waitcnt vmcnt(7)
  v_lshlrev_b32 v12, 16, v36
  v_and_b32 v13, 0xffff0000, v36
  v_pk_add_f32 v[4:5], v[4:5], v[12:13]
  v_lshlrev_b32 v12, 16, v37
  v_and_b32 v13, 0xffff0000, v37
  v_pk_add_f32 v[6:7], v[6:7], v[12:13]
  v_lshlrev_b32 v12, 16, v38
  v_and_b32 v13, 0xffff0000, v38
  v_pk_add_f32 v[8:9], v[8:9], v[12:13]
  v_lshlrev_b32 v12, 16, v39
  v_and_b32 v13, 0xffff0000, v39
  v_pk_add_f32 v[10:11], v[10:11], v[12:13]
  s_waitcnt vmcnt(6)
  v_lshlrev_b32 v12, 16, v40
  v_and_b32 v13, 0xffff0000, v40
  v_pk_add_f32 v[4:5], v[4:5], v[12:13]
  v_lshlrev_b32 v12, 16, v41
  v_and_b32 v13, 0xffff0000, v41
  v_pk_add_f32 v[6:7], v[6:7], v[12:13]
  v_lshlrev_b32 v12, 16, v42
  v_and_b32 v13, 0xffff0000, v42
  v_pk_add_f32 v[8:9], v[8:9], v[12:13]
  v_lshlrev_b32 v12, 16, v43
  v_and_b32 v13, 0xffff0000, v43
  v_pk_add_f32 v[10:11], v[10:11], v[12:13]
  s_waitcnt vmcnt(5)
  v_lshlrev_b32 v12, 16, v44
  v_and_b32 v13, 0xffff0000, v44
  v_pk_add_f32 v[4:5], v[4:5], v[12:13]
  v_lshlrev_b32 v12, 16, v45
  v_and_b32 v13, 0xffff0000, v45
  v_pk_add_f32 v[6:7], v[6:7], v[12:13]
  v_lshlrev_b32 v12, 16, v46
  v_and_b32 v13, 0xffff0000, v46
  v_pk_add_f32 v[8:9], v[8:9], v[12:13]
  v_lshlrev_b32 v12, 16, v47
  v_and_b32 v13, 0xffff0000, v47
  v_pk_add_f32 v[10:11], v[10:11], v[12:13]
  s_waitcnt vmcnt(4)
  v_lshlrev_b32 v12, 16, v48
  v_and_b32 v13, 0xffff0000, v48
  v_pk_add_f32 v[4:5], v[4:5], v[12:13]
  v_lshlrev_b32 v12, 16, v49
  v_and_b32 v13, 0xffff0000, v49
  v_pk_add_f32 v[6:7], v[6:7], v[12:13]
  v_lshlrev_b32 v12, 16, v50
  v_and_b32 v13, 0xffff0000, v50
  v_pk_add_f32 v[8:9], v[8:9], v[12:13]
  v_lshlrev_b32 v12, 16, v51
  v_and_b32 v13, 0xffff0000, v51
  v_pk_add_f32 v[10:11], v[10:11], v[12:13]
  s_waitcnt vmcnt(3)
  v_lshlrev_b32 v12, 16, v52
  v_and_b32 v13, 0xffff0000, v52
  v_pk_add_f32 v[4:5], v[4:5], v[12:13]
  v_lshlrev_b32 v12, 16, v53
  v_and_b32 v13, 0xffff0000, v53
  v_pk_add_f32 v[6:7], v[6:7], v[12:13]
  v_lshlrev_b32 v12, 16, v54
  v_and_b32 v13, 0xffff0000, v54
  v_pk_add_f32 v[8:9], v[8:9], v[12:13]
  v_lshlrev_b32 v12, 16, v55
  v_and_b32 v13, 0xffff0000, v55
  v_pk_add_f32 v[10:11], v[10:11], v[12:13]
  s_waitcnt vmcnt(2)
  v_lshlrev_b32 v12, 16, v56
  v_and_b32 v13, 0xffff0000, v56
  v_pk_add_f32 v[4:5], v[4:5], v[12:13]
  v_lshlrev_b32 v12, 16, v57
  v_and_b32 v13, 0xffff0000, v57
  v_pk_add_f32 v[6:7], v[6:7], v[12:13]
  v_lshlrev_b32 v12, 16, v58
  v_and_b32 v13, 0xffff0000, v58
  v_pk_add_f32 v[8:9], v[8:9], v[12:13]
  v_lshlrev_b32 v12, 16, v59
  v_and_b32 v13, 0xffff0000, v59
  v_pk_add_f32 v[10:11], v[10:11], v[12:13]
  s_waitcnt vmcnt(1)
  v_lshlrev_b32 v12, 16, v60
  v_and_b32 v13, 0xffff0000, v60
  v_pk_add_f32 v[4:5], v[4:5], v[12:13]
  v_lshlrev_b32 v12, 16, v61
  v_and_b32 v13, 0xffff0000, v61
  v_pk_add_f32 v[6:7], v[6:7], v[12:13]
  v_lshlrev_b32 v12, 16, v62
  v_and_b32 v13, 0xffff0000, v62
  v_pk_add_f32 v[8:9], v[8:9], v[12:13]
  v_lshlrev_b32 v12, 16, v63
  v_and_b32 v13, 0xffff0000, v63
  v_pk_add_f32 v[10:11], v[10:11], v[12:13]
  s_lshl_b32 s18, s16, 11
  v_lshl_add_u32 v2, v0, 5, s18
  ds_write_b128 v2, v[4:7]
  ds_write_b128 v2, v[8:11] offset:16
  s_waitcnt lgkmcnt(0)
  s_barrier
  s_cmp_lg_u32 s16, 0
  s_cbranch_scc1 Lse_asyn
  v_lshlrev_b32 v2, 2, v0
  ds_read2st64_b32 v[28:29], v2 offset0:0 offset1:1
  ds_read2st64_b32 v[30:31], v2 offset0:2 offset1:3
  ds_read2st64_b32 v[32:33], v2 offset0:4 offset1:5
  ds_read2st64_b32 v[34:35], v2 offset0:6 offset1:7
  ds_read2st64_b32 v[36:37], v2 offset0:8 offset1:9
  ds_read2st64_b32 v[38:39], v2 offset0:10 offset1:11
  ds_read2st64_b32 v[40:41], v2 offset0:12 offset1:13
  ds_read2st64_b32 v[42:43], v2 offset0:14 offset1:15
  ds_read2st64_b32 v[44:45], v2 offset0:16 offset1:17
  ds_read2st64_b32 v[46:47], v2 offset0:18 offset1:19
  ds_read2st64_b32 v[48:49], v2 offset0:20 offset1:21
  ds_read2st64_b32 v[50:51], v2 offset0:22 offset1:23
  ds_read2st64_b32 v[52:53], v2 offset0:24 offset1:25
  ds_read2st64_b32 v[54:55], v2 offset0:26 offset1:27
  ds_read2st64_b32 v[56:57], v2 offset0:28 offset1:29
  ds_read2st64_b32 v[58:59], v2 offset0:30 offset1:31
  ds_read2st64_b32 v[60:61], v2 offset0:32 offset1:33
  ds_read2st64_b32 v[62:63], v2 offset0:34 offset1:35
  ds_read2st64_b32 v[64:65], v2 offset0:36 offset1:37
  ds_read2st64_b32 v[66:67], v2 offset0:38 offset1:39
  ds_read2st64_b32 v[68:69], v2 offset0:40 offset1:41
  ds_read2st64_b32 v[70:71], v2 offset0:42 offset1:43
  ds_read2st64_b32 v[72:73], v2 offset0:44 offset1:45
  ds_read2st64_b32 v[74:75], v2 offset0:46 offset1:47
  ds_read2st64_b32 v[76:77], v2 offset0:48 offset1:49
  ds_read2st64_b32 v[78:79], v2 offset0:50 offset1:51
  ds_read2st64_b32 v[80:81], v2 offset0:52 offset1:53
  ds_read2st64_b32 v[82:83], v2 offset0:54 offset1:55
  ds_read2st64_b32 v[84:85], v2 offset0:56 offset1:57
  ds_read2st64_b32 v[86:87], v2 offset0:58 offset1:59
  ds_read2st64_b32 v[88:89], v2 offset0:60 offset1:61
  ds_read2st64_b32 v[90:91], v2 offset0:62 offset1:63
  s_waitcnt lgkmcnt(15)
  v_pk_add_f32 v[28:29], v[28:29], v[32:33]
  v_pk_add_f32 v[30:31], v[30:31], v[34:35]
  v_pk_add_f32 v[28:29], v[28:29], v[36:37]
  v_pk_add_f32 v[30:31], v[30:31], v[38:39]
  v_pk_add_f32 v[28:29], v[28:29], v[40:41]
  v_pk_add_f32 v[30:31], v[30:31], v[42:43]
  v_pk_add_f32 v[28:29], v[28:29], v[44:45]
  v_pk_add_f32 v[30:31], v[30:31], v[46:47]
  v_pk_add_f32 v[28:29], v[28:29], v[48:49]
  v_pk_add_f32 v[30:31], v[30:31], v[50:51]
  v_pk_add_f32 v[28:29], v[28:29], v[52:53]
  v_pk_add_f32 v[30:31], v[30:31], v[54:55]
  v_pk_add_f32 v[28:29], v[28:29], v[56:57]
  v_pk_add_f32 v[30:31], v[30:31], v[58:59]
  v_pk_add_f32 v[28:29], v[28:29], v[60:61]
  s_waitcnt lgkmcnt(7)
  v_pk_add_f32 v[30:31], v[30:31], v[62:63]
  v_pk_add_f32 v[28:29], v[28:29], v[64:65]
  v_pk_add_f32 v[30:31], v[30:31], v[66:67]
  v_pk_add_f32 v[28:29], v[28:29], v[68:69]
  v_pk_add_f32 v[30:31], v[30:31], v[70:71]
  v_pk_add_f32 v[28:29], v[28:29], v[72:73]
  v_pk_add_f32 v[30:31], v[30:31], v[74:75]
  v_pk_add_f32 v[28:29], v[28:29], v[76:77]
  s_waitcnt lgkmcnt(0)
  v_pk_add_f32 v[30:31], v[30:31], v[78:79]
  v_pk_add_f32 v[28:29], v[28:29], v[80:81]
  v_pk_add_f32 v[30:31], v[30:31], v[82:83]
  v_pk_add_f32 v[28:29], v[28:29], v[84:85]
  v_pk_add_f32 v[30:31], v[30:31], v[86:87]
  v_pk_add_f32 v[28:29], v[28:29], v[88:89]
  v_pk_add_f32 v[30:31], v[30:31], v[90:91]
  v_pk_add_f32 v[8:9], v[28:29], v[30:31]
  v_add_f32 v8, v8, v9
  s_lshl_b32 s18, s17, 8
  s_add_u32 s18, s18, 15040512
  buffer_store_dword v8, v2, s[12:15], s18 offen sc1
  s_add_u32 s63, s17, 209
  s_mul_i32 s63, s63, 128
  s_add_u32 s63, s63, 56254464
  s_branch Lse_asyn
Lse_aidle:
  s_barrier
Lse_asyn:
  s_waitcnt vmcnt(0)
  s_mov_b32 s60, 0
  s_branch Lse_gac
Lse_ga:
  s_sleep 2
  global_load_dwordx2 v[14:15], v16, s[38:39] sc1
  s_add_u32 s60, s60, 1
  s_waitcnt vmcnt(0)
Lse_gac:
  v_readfirstlane_b32 s0, v14
  v_readfirstlane_b32 s1, v15
  s_cmp_ge_u32 s60, 400000
  s_cbranch_scc1 Lse_gax
  s_cmp_eq_u32 s0, 0
  s_cbranch_scc1 Lse_ga
Lse_gax:
  s_nop 0
  v_mov_b32 v4, 1
  v_mov_b32 v5, s1
  v_add_u32 v4, s0, v4
  v_lshlrev_b32 v6, 3, v0
  s_mov_b64 exec, 65535
  buffer_store_dwordx2 v[4:5], v6, s[12:15], s63 offen sc1
  s_mov_b64 exec, -1
  s_barrier
Lse_aend:
  s_and_b32 s17, s2, 7
  s_lshl_b32 s17, s17, 2
  s_bfe_u32 s18, s2, 0x20003
  s_add_u32 s17, s17, s18
  s_lshr_b32 s18, s2, 5
  s_lshl_b32 s18, s18, 3
  s_and_b32 s19, s16, 3
  s_lshl_b32 s19, s19, 1
  s_add_u32 s18, s18, s19
  s_lshr_b32 s33, s16, 2
  s_mul_i32 s63, s17, 73728
  s_mul_i32 s22, s18, 1152
  s_add_u32 s63, s63, s22
  s_add_u32 s63, s63, 4980736
  s_mul_i32 s22, s17, 155648
  s_lshl_b32 s23, s16, 10
  v_and_b32 v118, 31, v0
  v_lshrrev_b32 v126, 5, v0
  v_mul_u32_u24 v126, 1152, v126
  v_lshl_add_u32 v126, v118, 2, v126
  v_and_b32 v119, 0x13, v118
  v_and_b32 v120, 4, v118
  v_lshl_or_b32 v119, v120, 1, v119
  v_bfe_u32 v120, v118, 3, 1
  v_lshl_or_b32 v119, v120, 2, v119
  v_lshrrev_b32 v120, 5, v0
  v_lshlrev_b32 v121, 9, v120
  v_lshl_add_u32 v8, v119, 4, v121
  v_lshlrev_b32 v9, 2, v119
  v_add_u32 v9, 1536, v9
  v_bfe_u32 v121, v0, 2, 2
  v_lshl_add_u32 v121, v120, 3, v121
  v_and_b32 v122, 1, v0
  v_mul_u32_u24 v122, 640, v122
  v_bfe_u32 v123, v0, 1, 1
  v_lshl_add_u32 v122, v123, 3, v122
  v_add_u32 v122, 1024, v122
  v_and_b32 v123, 16, v0
  v_cmp_eq_u32 vcc, 16, v123
  v_add_u32 v123, 0, v121
  v_lshl_add_u32 v124, v123, 4, v122
  v_lshlrev_b32 v123, 3, v123
  v_add_u32 v123, 2176, v123
  v_cndmask_b32 v10, v124, v123, vcc
  v_add_u32 v123, 4, v121
  v_lshl_add_u32 v124, v123, 4, v122
  v_lshlrev_b32 v123, 3, v123
  v_add_u32 v123, 2176, v123
  v_cndmask_b32 v11, v124, v123, vcc
  v_add_u32 v123, 16, v121
  v_lshl_add_u32 v124, v123, 4, v122
  v_lshlrev_b32 v123, 3, v123
  v_add_u32 v123, 2176, v123
  v_cndmask_b32 v12, v124, v123, vcc
  v_add_u32 v123, 20, v121
  v_lshl_add_u32 v124, v123, 4, v122
  v_lshlrev_b32 v123, 3, v123
  v_add_u32 v123, 2176, v123
  v_cndmask_b32 v13, v124, v123, vcc
  v_mov_b32 v77, 0x3f803f80
  v_cmp_gt_u32 s[30:31], 32, v0
  s_mul_i32 s32, s33, 97280
  s_mul_i32 s3, s33, 4294967292
  s_add_u32 s3, s3, 10
  s_mov_b32 s48, 1
  s_mov_b32 s21, 2
  s_mov_b32 s36, s46
  s_mov_b32 s37, s47
  s_and_b32 s38, s2, 7
  s_lshl_b32 s38, s38, 3
  s_bfe_u32 s39, s2, 0x30003
  s_add_u32 s38, s38, s39
  s_lshr_b32 s39, s2, 6
  s_xor_b32 s11, s16, 4
  s_mul_i32 s49, s39, 9
  s_lshl_b32 s19, s11, 1
  s_add_u32 s49, s49, s19
  s_lshl_b32 s62, s49, 10
  s_add_u32 s62, s62, 15728640
  s_bfe_u32 s8, s2, 0x10002
  s_lshl_b32 s8, s8, 2
  s_bfe_u32 s9, s2, 0x20003
  s_add_u32 s8, s8, s9
  s_and_b32 s9, s2, 3
  s_lshl_b32 s9, s9, 3
  s_lshr_b32 s10, s2, 5
  s_add_u32 s9, s9, s10
  s_mul_i32 s10, s9, 331776
  s_add_u32 s10, s10, 16777216
  s_lshl_b32 s61, s2, 2
  s_add_u32 s61, s61, s16
  s_mov_b32 s7, 0x20000
  s_mov_b32 s56, 8
  s_mov_b32 s57, 16
  s_mov_b32 s58, 4
  s_mov_b32 s6, 5308416
  s_cmp_ge_u32 s61, 648
  s_cbranch_scc1 Lse_p1
  s_cmp_ge_u32 s61, 324
  s_cselect_b32 s4, s42, s40
  s_cselect_b32 s5, s43, s41
  s_cselect_b32 s60, 324, 0
  s_cselect_b32 s53, 1024, 0
  s_sub_u32 s60, s61, s60
  s_mul_i32 s19, s60, 3641
  s_lshr_b32 s19, s19, 16
  s_mul_i32 s59, s19, 18
  s_sub_u32 s60, s60, s59
  s_mov_b32 s50, 9216
  s_mul_i32 s51, s19, 294912
  s_lshl_b32 s59, s60, 9
  s_add_u32 s51, s51, s59
  s_mov_b32 s52, 128
  s_mul_i32 s59, s60, 589824
  s_add_u32 s53, s53, s59
  s_lshl_b32 s59, s19, 11
  s_add_u32 s53, s53, s59
  s_add_u32 s53, s53, 16777216
  s_mov_b32 s54, 147456
  s_mov_b32 s55, 36864
  s_add_u32 s40, s51, 0
  s_add_u32 s41, s51, 147456
  s_add_u32 s42, s51, 128
  s_add_u32 s43, s51, 147584
  s_add_u32 s44, s51, 256
  s_add_u32 s45, s51, 147712
  s_add_u32 s46, s51, 384
  s_add_u32 s47, s51, 147840
  s_branch Lse_pgo
Lse_p1:
  s_mov_b32 s50, 1152
  s_mov_b32 s54, 36864
  s_mov_b32 s55, 1024
  s_mov_b32 s4, s44
  s_mov_b32 s5, s45
  s_mov_b32 s52, 36864
  s_sub_u32 s60, s61, 648
  s_mul_i32 s19, s60, 7282
  s_lshr_b32 s19, s19, 16
  s_mul_i32 s59, s19, 9
  s_sub_u32 s60, s60, s59
  s_mul_i32 s53, s19, 147456
  s_add_u32 s53, s53, 29360128
  s_lshl_b32 s59, s60, 12
  s_add_u32 s53, s53, s59
  s_lshl_b32 s51, s60, 7
  s_mul_i32 s59, s19, 7282
  s_lshr_b32 s59, s59, 16
  s_mul_i32 s60, s59, 9
  s_sub_u32 s19, s19, s60
  s_mul_i32 s59, s59, 1327104
  s_add_u32 s51, s51, s59
  s_mul_i32 s59, s19, 86
  s_lshr_b32 s59, s59, 8
  s_mul_i32 s60, s59, 3
  s_sub_u32 s19, s19, s60
  s_lshl_b32 s19, s19, 3
  s_mul_i32 s60, s60, 18432
  s_add_u32 s51, s51, s60
  s_add_u32 s59, s19, 0
  s_mul_i32 s60, s59, 86
  s_lshr_b32 s60, s60, 8
  s_mul_i32 s60, s60, 6
  s_add_u32 s59, s59, s60
  s_mul_i32 s59, s59, 18432
  s_add_u32 s40, s51, s59
  s_add_u32 s59, s19, 1
  s_mul_i32 s60, s59, 86
  s_lshr_b32 s60, s60, 8
  s_mul_i32 s60, s60, 6
  s_add_u32 s59, s59, s60
  s_mul_i32 s59, s59, 18432
  s_add_u32 s41, s51, s59
  s_add_u32 s59, s19, 2
  s_mul_i32 s60, s59, 86
  s_lshr_b32 s60, s60, 8
  s_mul_i32 s60, s60, 6
  s_add_u32 s59, s59, s60
  s_mul_i32 s59, s59, 18432
  s_add_u32 s42, s51, s59
  s_add_u32 s59, s19, 3
  s_mul_i32 s60, s59, 86
  s_lshr_b32 s60, s60, 8
  s_mul_i32 s60, s60, 6
  s_add_u32 s59, s59, s60
  s_mul_i32 s59, s59, 18432
  s_add_u32 s43, s51, s59
  s_add_u32 s59, s19, 4
  s_mul_i32 s60, s59, 86
  s_lshr_b32 s60, s60, 8
  s_mul_i32 s60, s60, 6
  s_add_u32 s59, s59, s60
  s_mul_i32 s59, s59, 18432
  s_add_u32 s44, s51, s59
  s_add_u32 s59, s19, 5
  s_mul_i32 s60, s59, 86
  s_lshr_b32 s60, s60, 8
  s_mul_i32 s60, s60, 6
  s_add_u32 s59, s59, s60
  s_mul_i32 s59, s59, 18432
  s_add_u32 s45, s51, s59
  s_add_u32 s59, s19, 6
  s_mul_i32 s60, s59, 86
  s_lshr_b32 s60, s60, 8
  s_mul_i32 s60, s60, 6
  s_add_u32 s59, s59, s60
  s_mul_i32 s59, s59, 18432
  s_add_u32 s46, s51, s59
  s_add_u32 s59, s19, 7
  s_mul_i32 s60, s59, 86
  s_lshr_b32 s60, s60, 8
  s_mul_i32 s60, s60, 6
  s_add_u32 s59, s59, s60
  s_mul_i32 s59, s59, 18432
  s_add_u32 s47, s51, s59
Lse_pgo:
  s_lshl_b32 s19, s16, 11
  s_add_u32 s19, s19, 155648
  s_mul_i32 s57, s57, s50
  s_mul_i32 s58, s58, s50
  v_lshrrev_b32 v240, 5, v0
  v_mul_lo_u32 v240, v240, s56
  v_bfe_u32 v243, v0, 3, 2
  v_add_u32 v240, v240, v243
  v_mul_lo_u32 v240, v240, s50
  v_and_b32 v243, 7, v0
  v_lshl_add_u32 v240, v243, 4, v240
  v_add_u32 v241, s19, v1
  v_lshrrev_b32 v242, 2, v0
  v_lshlrev_b32 v242, 7, v242
  v_and_b32 v243, 3, v0
  v_lshl_add_u32 v242, v243, 3, v242
  v_add_u32 v242, s19, v242
  v_mov_b32 v68, 0
  v_pk_mul_f32 v[48:49], v[68:69], v[68:69] op_sel_hi:[0,0]
  v_pk_mul_f32 v[50:51], v[68:69], v[68:69] op_sel_hi:[0,0]
  v_pk_mul_f32 v[52:53], v[68:69], v[68:69] op_sel_hi:[0,0]
  v_pk_mul_f32 v[54:55], v[68:69], v[68:69] op_sel_hi:[0,0]
  v_pk_mul_f32 v[56:57], v[68:69], v[68:69] op_sel_hi:[0,0]
  v_pk_mul_f32 v[58:59], v[68:69], v[68:69] op_sel_hi:[0,0]
  v_pk_mul_f32 v[60:61], v[68:69], v[68:69] op_sel_hi:[0,0]
  v_pk_mul_f32 v[62:63], v[68:69], v[68:69] op_sel_hi:[0,0]
  v_pk_mul_f32 v[96:97], v[68:69], v[68:69] op_sel_hi:[0,0]
  v_pk_mul_f32 v[98:99], v[68:69], v[68:69] op_sel_hi:[0,0]
  v_pk_mul_f32 v[100:101], v[68:69], v[68:69] op_sel_hi:[0,0]
  v_pk_mul_f32 v[102:103], v[68:69], v[68:69] op_sel_hi:[0,0]
  v_pk_mul_f32 v[104:105], v[68:69], v[68:69] op_sel_hi:[0,0]
  v_pk_mul_f32 v[106:107], v[68:69], v[68:69] op_sel_hi:[0,0]
  v_pk_mul_f32 v[108:109], v[68:69], v[68:69] op_sel_hi:[0,0]
  v_pk_mul_f32 v[110:111], v[68:69], v[68:69] op_sel_hi:[0,0]
  v_pk_mul_f32 v[68:69], v[68:69], v[68:69] op_sel_hi:[0,0]
  v_pk_mul_f32 v[70:71], v[68:69], v[68:69] op_sel_hi:[0,0]
  v_pk_mul_f32 v[84:85], v[68:69], v[68:69] op_sel_hi:[0,0]
  v_pk_mul_f32 v[86:87], v[68:69], v[68:69] op_sel_hi:[0,0]
  s_cmp_eq_u32 s16, 5
  s_cbranch_scc1 Lse_q5
  s_cmp_lg_u32 s16, 4
  s_cbranch_scc1 Lse_pqx
  s_lshr_b32 s59, s17, 3
  s_lshl_b32 s59, s59, 4
  v_and_b32 v118, 15, v0
  v_bfe_u32 v119, v0, 4, 1
  v_lshl_add_u32 v118, v119, 6, v118
  v_add_u32 v118, 64, v118
  s_lshr_b32 s60, s2, 5
  s_lshl_b32 s60, s60, 1
  v_and_b32 v119, 1, v0
  v_add_u32 v119, s60, v119
  s_mul_i32 s59, s59, 128
  s_add_u32 s59, s59, 56229888
  v_cndmask_b32 v118, v119, v118, s[30:31]
  s_branch Lse_q6
Lse_q5:
  s_mul_i32 s60, s39, 9
  s_lshr_b32 s60, s60, 2
  s_add_u32 s60, s60, 128
  v_mul_u32_u24 v118, 21846, v0
  v_lshrrev_b32 v118, 16, v118
  v_mad_u32_u24 v118, v118, 6, v0
  v_add_u32 v118, s60, v118
  v_add_u32 v119, 158, v0
  v_cmp_gt_u32 vcc, 15, v0
  s_lshl_b32 s60, s38, 1
  v_and_b32 v120, 1, v0
  v_cndmask_b32 v118, v119, v118, vcc
  v_cmp_gt_u32 vcc, 51, v0
  v_add_u32 v120, s60, v120
  s_mov_b32 s59, 56254464
  v_cndmask_b32 v118, v120, v118, vcc
Lse_q6:
  v_mul_u32_u24 v118, 128, v118
  s_mov_b32 s60, 0
Lse_pq:
  buffer_load_dwordx2 v[120:121], v118, s[12:15], s59 offen sc1
  s_add_u32 s60, s60, 1
  s_waitcnt vmcnt(0)
  v_subrev_u32 v120, s0, v120
  v_xor_b32 v121, s1, v121
  v_subrev_u32 v120, 1, v120
  v_and_or_b32 v120, v120, -4, v121
  v_cmp_ne_u32 vcc, 0, v120
  s_cmp_ge_u32 s60, 400000
  s_cbranch_scc1 Lse_pqx
  s_cbranch_vccz Lse_pqx
  s_sleep 2
  s_branch Lse_pq
Lse_pqx:
  s_barrier
  s_add_u32 m0, s23, 0
  s_add_u32 s24, s22, m0
  buffer_load_dwordx4 v1, s[12:15], s24 offen sc1 lds
  buffer_load_dwordx4 v[88:91], v1, s[12:15], s63 offen sc1
  buffer_load_dword v92, v126, s[12:15], s63 offen offset:1024 sc1
  buffer_load_dwordx4 v[112:115], v1, s[12:15], s63 offen offset:1152 sc1
Lse_nq:
  s_add_u32 m0, s23, 8192
  s_add_u32 s24, s22, m0
  buffer_load_dwordx4 v1, s[12:15], s24 offen sc1 lds
  s_add_u32 m0, s23, 16384
  s_add_u32 s24, s22, m0
  buffer_load_dwordx4 v1, s[12:15], s24 offen sc1 lds
  s_waitcnt vmcnt(0)
  s_barrier
  s_setprio 1
  s_cmp_eq_u32 s33, 0
  s_cbranch_scc1 Lse_restart
  s_setprio 0
  s_mov_b32 s21, 99
  s_add_u32 s23, s23, 20480
  s_add_u32 m0, s23, 0
  s_add_u32 s24, s22, m0
  buffer_load_dwordx4 v1, s[12:15], s24 offen sc1 lds
  s_add_u32 m0, s23, 4096
  s_add_u32 s24, s22, m0
  buffer_load_dwordx4 v1, s[12:15], s24 offen sc1 lds
  s_add_u32 m0, s23, 8192
  s_add_u32 s24, s22, m0
  buffer_load_dwordx4 v1, s[12:15], s24 offen sc1 lds
  s_add_u32 m0, s23, 12288
  s_add_u32 s24, s22, m0
  buffer_load_dwordx4 v1, s[12:15], s24 offen sc1 lds
  s_add_u32 m0, s23, 16384
  s_add_u32 s24, s22, m0
  buffer_load_dwordx4 v1, s[12:15], s24 offen sc1 lds
  s_add_u32 m0, s23, 20480
  s_add_u32 s24, s22, m0
  buffer_load_dwordx4 v1, s[12:15], s24 offen sc1 lds
  s_add_u32 m0, s23, 24576
  s_add_u32 s24, s22, m0
  buffer_load_dwordx4 v1, s[12:15], s24 offen sc1 lds
  s_add_u32 m0, s23, 28672
  s_add_u32 s24, s22, m0
  buffer_load_dwordx4 v1, s[12:15], s24 offen sc1 lds
  s_add_u32 s23, s23, 32768
Lse_restart:
  v_mov_b32 v93, 0
  v_mov_b32 v118, 0xff800000
  v_mov_b32 v119, 0xff800000
  v_mov_b32 v2, v8
  v_mov_b32 v3, v9
  s_mov_b32 s20, s48
Lse_mx:
  ds_read_b128 v[72:75], v2
  ds_read_b32 v76, v3
  v_add_u32 v2, 2432, v2
  v_add_u32 v3, 2432, v3
  s_waitcnt lgkmcnt(0)
  v_mfma_f32_32x32x16_bf16 v[16:31], v[72:75], v[88:91], 0
  v_mfma_f32_32x32x16_bf16 v[32:47], v[72:75], v[112:115], 0
  s_sub_u32 s20, s20, 1
  s_nop 8
  v_mfma_f32_32x32x4_2b_bf16 v[16:47], v[76:77], v[92:93], v[16:47]
  s_nop 15
  s_nop 3
  v_max3_f32 v118, v118, v16, v17
  v_max3_f32 v118, v118, v18, v19
  v_max3_f32 v118, v118, v20, v21
  v_max3_f32 v118, v118, v22, v23
  v_max3_f32 v118, v118, v24, v25
  v_max3_f32 v118, v118, v26, v27
  v_max3_f32 v118, v118, v28, v29
  v_max3_f32 v118, v118, v30, v31
  v_max3_f32 v119, v119, v32, v33
  v_max3_f32 v119, v119, v34, v35
  v_max3_f32 v119, v119, v36, v37
  v_max3_f32 v119, v119, v38, v39
  v_max3_f32 v119, v119, v40, v41
  v_max3_f32 v119, v119, v42, v43
  v_max3_f32 v119, v119, v44, v45
  v_max3_f32 v119, v119, v46, v47
  s_cmp_lg_u32 s20, 0
  s_cbranch_scc1 Lse_mx
  v_mov_b32 v120, v118
  v_mov_b32 v121, v119
  v_add_u32 v2, s32, v8
  v_add_u32 v3, s32, v9
  v_add_u32 v4, s32, v10
  v_add_u32 v5, s32, v11
  v_add_u32 v6, s32, v12
  v_add_u32 v7, s32, v13
  v_permlane32_swap_b32 v118, v120
  v_permlane32_swap_b32 v119, v121
  s_and_b32 s19, s33, s48
  s_cbranch_scc0 Lse_kvx
Lse_kv:
  s_add_u32 m0, s23, 0
  s_add_u32 s24, s22, m0
  buffer_load_dwordx4 v1, s[12:15], s24 offen sc1 lds
  s_add_u32 s23, s23, 4096
  s_cmp_lt_u32 s23, 155648
  s_cbranch_scc1 Lse_kv
  s_waitcnt vmcnt(0)
  s_barrier
  buffer_load_dwordx4 v[160:163], v1, s[12:15], s62 offen offset:0 sc1
  buffer_load_dwordx4 v[164:167], v1, s[12:15], s62 offen offset:1024 sc1
  s_add_u32 s62, s62, 36864
  buffer_load_dwordx4 v[168:171], v1, s[12:15], s62 offen offset:0 sc1
  buffer_load_dwordx4 v[172:175], v1, s[12:15], s62 offen offset:1024 sc1
  s_add_u32 s62, s62, 36864
  buffer_load_dwordx4 v[176:179], v1, s[12:15], s62 offen offset:0 sc1
  buffer_load_dwordx4 v[180:183], v1, s[12:15], s62 offen offset:1024 sc1
  s_add_u32 s62, s62, 36864
  buffer_load_dwordx4 v[184:187], v1, s[12:15], s62 offen offset:0 sc1
  buffer_load_dwordx4 v[188:191], v1, s[12:15], s62 offen offset:1024 sc1
  s_add_u32 s62, s62, 36864
  buffer_load_dwordx4 v[192:195], v1, s[12:15], s62 offen offset:0 sc1
  buffer_load_dwordx4 v[196:199], v1, s[12:15], s62 offen offset:1024 sc1
  s_add_u32 s62, s62, 36864
  buffer_load_dwordx4 v[200:203], v1, s[12:15], s62 offen offset:0 sc1
  buffer_load_dwordx4 v[204:207], v1, s[12:15], s62 offen offset:1024 sc1
  s_add_u32 s62, s62, 36864
  buffer_load_dwordx4 v[208:211], v1, s[12:15], s62 offen offset:0 sc1
  buffer_load_dwordx4 v[212:215], v1, s[12:15], s62 offen offset:1024 sc1
  s_add_u32 s62, s62, 36864
  buffer_load_dwordx4 v[216:219], v1, s[12:15], s62 offen offset:0 sc1
  buffer_load_dwordx4 v[220:223], v1, s[12:15], s62 offen offset:1024 sc1
  s_add_u32 s62, s62, 36864
  buffer_load_dwordx4 v[224:227], v1, s[12:15], s62 offen offset:0 sc1
  buffer_load_dwordx4 v[228:231], v1, s[12:15], s62 offen offset:1024 sc1
  s_add_u32 s62, s62, 36864
  buffer_load_dwordx4 v[232:235], v1, s[12:15], s62 offen offset:0 sc1
  buffer_load_dwordx4 v[236:239], v1, s[12:15], s62 offen offset:1024 sc1
  s_add_u32 s62, s62, 36864
  buffer_load_dwordx4 v[240:243], v1, s[12:15], s62 offen offset:0 sc1
  buffer_load_dwordx4 v[244:247], v1, s[12:15], s62 offen offset:1024 sc1
  s_add_u32 s62, s62, 36864
  buffer_load_dwordx4 v[248:251], v1, s[12:15], s62 offen offset:0 sc1
  buffer_load_dwordx4 v[252:255], v1, s[12:15], s62 offen offset:1024 sc1
  s_add_u32 s62, s62, 36864
  s_mov_b32 s24, s36
  s_mov_b32 s25, s37
  s_mov_b32 s26, 0x240000
  s_mov_b32 s27, 0x20000
  s_lshl_b32 s59, s11, 8
  s_add_u32 s59, s59, s2
  s_lshl_b32 s59, s59, 13
  v_lshlrev_b32 v14, 7, v0
  buffer_load_dword v15, v14, s[24:27], s59 offen
Lse_kvx:
  ds_read_b128 v[72:75], v2
  ds_read_b32 v76, v3
  ds_read_b64_tr_b16 v[80:81], v4
  ds_read_b64_tr_b16 v[124:125], v6
  ds_read_b64_tr_b16 v[126:127], v7
  v_max_f32 v118, v118, v120
  v_max_f32 v119, v119, v121
  v_cndmask_b32 v118, v119, v118, s[30:31]
  s_waitcnt lgkmcnt(4)
  v_mfma_f32_32x32x16_bf16 v[16:31], v[72:75], v[88:91], 0
  v_mfma_f32_32x32x16_bf16 v[32:47], v[72:75], v[112:115], 0
  ds_read_b128 v[72:75], v2 offset:2432
  v_sub_f32 v118, 0, v118
  v_cvt_pk_bf16_f32 v122, v118, v118
  v_and_b32 v122, 0xffff0000, v122
  v_sub_f32 v123, v118, v122
  v_cvt_pk_bf16_f32 v93, v122, v123
  s_waitcnt lgkmcnt(4)
  s_nop 2
  v_mfma_f32_32x32x4_2b_bf16 v[16:47], v[76:77], v[92:93], v[16:47]
  ds_read_b32 v76, v3 offset:2432
  s_nop 15
  s_nop 1
  s_waitcnt lgkmcnt(0)
.p2align 6
Lse_loop:
  v_exp_f32 v16, v16
  v_exp_f32 v17, v17
  v_mfma_f32_32x32x16_bf16 v[96:111], v[84:87], v[68:71], v[96:111]
  ds_read_b64_tr_b16 v[82:83], v5 offset:0
  v_exp_f32 v18, v18
  v_exp_f32 v19, v19
  v_cvt_pk_bf16_f32 v64, v16, v17
  v_cvt_pk_bf16_f32 v65, v18, v19
  v_exp_f32 v20, v20
  v_exp_f32 v21, v21
  v_mfma_f32_32x32x4_2b_bf16 v[128:159], v[76:77], v[92:93], 0
  ds_read_b32 v76, v3 offset:4864
  v_exp_f32 v22, v22
  v_exp_f32 v23, v23
  v_cvt_pk_bf16_f32 v66, v20, v21
  v_cvt_pk_bf16_f32 v67, v22, v23
  v_exp_f32 v24, v24
  v_exp_f32 v25, v25
  v_exp_f32 v26, v26
  v_exp_f32 v27, v27
  v_cvt_pk_bf16_f32 v68, v24, v25
  v_cvt_pk_bf16_f32 v69, v26, v27
  v_exp_f32 v28, v28
  v_exp_f32 v29, v29
  s_waitcnt lgkmcnt(0)
  v_mfma_f32_32x32x16_bf16 v[48:63], v[80:83], v[64:67], v[48:63]
  v_exp_f32 v30, v30
  v_exp_f32 v31, v31
  v_cvt_pk_bf16_f32 v70, v28, v29
  v_cvt_pk_bf16_f32 v71, v30, v31
  v_exp_f32 v32, v32
  v_exp_f32 v33, v33
  v_mfma_f32_32x32x16_bf16 v[48:63], v[124:127], v[68:71], v[48:63]
  ds_read_b64_tr_b16 v[84:85], v6 offset:2432
  v_exp_f32 v34, v34
  v_exp_f32 v35, v35
  v_cvt_pk_bf16_f32 v64, v32, v33
  v_cvt_pk_bf16_f32 v65, v34, v35
  v_exp_f32 v36, v36
  v_exp_f32 v37, v37
  v_mfma_f32_32x32x16_bf16 v[128:143], v[72:75], v[88:91], v[128:143]
  ds_read_b64_tr_b16 v[86:87], v7 offset:2432
  v_exp_f32 v38, v38
  v_exp_f32 v39, v39
  v_cvt_pk_bf16_f32 v66, v36, v37
  v_cvt_pk_bf16_f32 v67, v38, v39
  v_exp_f32 v40, v40
  v_exp_f32 v41, v41
  v_mfma_f32_32x32x16_bf16 v[144:159], v[72:75], v[112:115], v[144:159]
  ds_read_b128 v[72:75], v2 offset:4864
  v_exp_f32 v42, v42
  v_exp_f32 v43, v43
  v_cvt_pk_bf16_f32 v68, v40, v41
  v_cvt_pk_bf16_f32 v69, v42, v43
  v_exp_f32 v44, v44
  v_exp_f32 v45, v45
  v_mfma_f32_32x32x16_bf16 v[96:111], v[80:83], v[64:67], v[96:111]
  ds_read_b64_tr_b16 v[80:81], v4 offset:2432
  v_exp_f32 v46, v46
  v_exp_f32 v47, v47
  v_cvt_pk_bf16_f32 v70, v44, v45
  v_cvt_pk_bf16_f32 v71, v46, v47
  v_exp_f32 v128, v128
  v_exp_f32 v129, v129
  v_mfma_f32_32x32x16_bf16 v[96:111], v[124:127], v[68:71], v[96:111]
  ds_read_b64_tr_b16 v[82:83], v5 offset:2432
  v_exp_f32 v130, v130
  v_exp_f32 v131, v131
  v_cvt_pk_bf16_f32 v64, v128, v129
  v_cvt_pk_bf16_f32 v65, v130, v131
  v_exp_f32 v132, v132
  v_exp_f32 v133, v133
  v_mfma_f32_32x32x4_2b_bf16 v[16:47], v[76:77], v[92:93], 0
  ds_read_b32 v76, v3 offset:7296
  v_exp_f32 v134, v134
  v_exp_f32 v135, v135
  v_cvt_pk_bf16_f32 v66, v132, v133
  v_cvt_pk_bf16_f32 v67, v134, v135
  v_exp_f32 v136, v136
  v_exp_f32 v137, v137
  v_exp_f32 v138, v138
  v_exp_f32 v139, v139
  v_cvt_pk_bf16_f32 v68, v136, v137
  v_cvt_pk_bf16_f32 v69, v138, v139
  v_exp_f32 v140, v140
  v_exp_f32 v141, v141
  s_waitcnt lgkmcnt(0)
  v_mfma_f32_32x32x16_bf16 v[48:63], v[80:83], v[64:67], v[48:63]
  v_exp_f32 v142, v142
  v_exp_f32 v143, v143
  v_cvt_pk_bf16_f32 v70, v140, v141
  v_cvt_pk_bf16_f32 v71, v142, v143
  v_exp_f32 v144, v144
  v_exp_f32 v145, v145
  v_mfma_f32_32x32x16_bf16 v[48:63], v[84:87], v[68:71], v[48:63]
  ds_read_b64_tr_b16 v[124:125], v6 offset:4864
  v_exp_f32 v146, v146
  v_exp_f32 v147, v147
  v_cvt_pk_bf16_f32 v64, v144, v145
  v_cvt_pk_bf16_f32 v65, v146, v147
  v_exp_f32 v148, v148
  v_exp_f32 v149, v149
  v_mfma_f32_32x32x16_bf16 v[16:31], v[72:75], v[88:91], v[16:31]
  ds_read_b64_tr_b16 v[126:127], v7 offset:4864
  v_exp_f32 v150, v150
  v_exp_f32 v151, v151
  v_cvt_pk_bf16_f32 v66, v148, v149
  v_cvt_pk_bf16_f32 v67, v150, v151
  v_exp_f32 v152, v152
  v_exp_f32 v153, v153
  v_mfma_f32_32x32x16_bf16 v[32:47], v[72:75], v[112:115], v[32:47]
  ds_read_b128 v[72:75], v2 offset:7296
  v_exp_f32 v154, v154
  v_exp_f32 v155, v155
  v_cvt_pk_bf16_f32 v68, v152, v153
  v_cvt_pk_bf16_f32 v69, v154, v155
  v_exp_f32 v156, v156
  v_exp_f32 v157, v157
  v_mfma_f32_32x32x16_bf16 v[96:111], v[80:83], v[64:67], v[96:111]
  ds_read_b64_tr_b16 v[80:81], v4 offset:4864
  v_exp_f32 v158, v158
  v_exp_f32 v159, v159
  v_cvt_pk_bf16_f32 v70, v156, v157
  v_cvt_pk_bf16_f32 v71, v158, v159
  v_exp_f32 v16, v16
  v_exp_f32 v17, v17
  v_mfma_f32_32x32x16_bf16 v[96:111], v[84:87], v[68:71], v[96:111]
  ds_read_b64_tr_b16 v[82:83], v5 offset:4864
  v_exp_f32 v18, v18
  v_exp_f32 v19, v19
  v_cvt_pk_bf16_f32 v64, v16, v17
  v_cvt_pk_bf16_f32 v65, v18, v19
  v_exp_f32 v20, v20
  v_exp_f32 v21, v21
  v_mfma_f32_32x32x4_2b_bf16 v[128:159], v[76:77], v[92:93], 0
  ds_read_b32 v76, v3 offset:9728
  v_exp_f32 v22, v22
  v_exp_f32 v23, v23
  v_cvt_pk_bf16_f32 v66, v20, v21
  v_cvt_pk_bf16_f32 v67, v22, v23
  v_exp_f32 v24, v24
  v_exp_f32 v25, v25
  v_exp_f32 v26, v26
  v_exp_f32 v27, v27
  v_cvt_pk_bf16_f32 v68, v24, v25
  v_cvt_pk_bf16_f32 v69, v26, v27
  v_exp_f32 v28, v28
  v_exp_f32 v29, v29
  s_waitcnt lgkmcnt(0)
  v_mfma_f32_32x32x16_bf16 v[48:63], v[80:83], v[64:67], v[48:63]
  v_exp_f32 v30, v30
  v_exp_f32 v31, v31
  v_cvt_pk_bf16_f32 v70, v28, v29
  v_cvt_pk_bf16_f32 v71, v30, v31
  v_exp_f32 v32, v32
  v_exp_f32 v33, v33
  v_mfma_f32_32x32x16_bf16 v[48:63], v[124:127], v[68:71], v[48:63]
  ds_read_b64_tr_b16 v[84:85], v6 offset:7296
  v_exp_f32 v34, v34
  v_exp_f32 v35, v35
  v_cvt_pk_bf16_f32 v64, v32, v33
  v_cvt_pk_bf16_f32 v65, v34, v35
  v_exp_f32 v36, v36
  v_exp_f32 v37, v37
  v_mfma_f32_32x32x16_bf16 v[128:143], v[72:75], v[88:91], v[128:143]
  ds_read_b64_tr_b16 v[86:87], v7 offset:7296
  v_exp_f32 v38, v38
  v_exp_f32 v39, v39
  v_cvt_pk_bf16_f32 v66, v36, v37
  v_cvt_pk_bf16_f32 v67, v38, v39
  v_exp_f32 v40, v40
  v_exp_f32 v41, v41
  v_mfma_f32_32x32x16_bf16 v[144:159], v[72:75], v[112:115], v[144:159]
  ds_read_b128 v[72:75], v2 offset:9728
  v_exp_f32 v42, v42
  v_exp_f32 v43, v43
  v_cvt_pk_bf16_f32 v68, v40, v41
  v_cvt_pk_bf16_f32 v69, v42, v43
  v_exp_f32 v44, v44
  v_exp_f32 v45, v45
  v_mfma_f32_32x32x16_bf16 v[96:111], v[80:83], v[64:67], v[96:111]
  ds_read_b64_tr_b16 v[80:81], v4 offset:7296
  v_exp_f32 v46, v46
  v_exp_f32 v47, v47
  v_cvt_pk_bf16_f32 v70, v44, v45
  v_cvt_pk_bf16_f32 v71, v46, v47
  v_exp_f32 v128, v128
  v_exp_f32 v129, v129
  v_mfma_f32_32x32x16_bf16 v[96:111], v[124:127], v[68:71], v[96:111]
  ds_read_b64_tr_b16 v[82:83], v5 offset:7296
  v_exp_f32 v130, v130
  v_exp_f32 v131, v131
  v_cvt_pk_bf16_f32 v64, v128, v129
  v_cvt_pk_bf16_f32 v65, v130, v131
  v_exp_f32 v132, v132
  v_exp_f32 v133, v133
  v_mfma_f32_32x32x4_2b_bf16 v[16:47], v[76:77], v[92:93], 0
  ds_read_b32 v76, v3 offset:12160
  v_exp_f32 v134, v134
  v_exp_f32 v135, v135
  v_cvt_pk_bf16_f32 v66, v132, v133
  v_cvt_pk_bf16_f32 v67, v134, v135
  v_exp_f32 v136, v136
  v_exp_f32 v137, v137
  v_exp_f32 v138, v138
  v_exp_f32 v139, v139
  v_cvt_pk_bf16_f32 v68, v136, v137
  v_cvt_pk_bf16_f32 v69, v138, v139
  v_exp_f32 v140, v140
  v_exp_f32 v141, v141
  s_waitcnt lgkmcnt(0)
  v_mfma_f32_32x32x16_bf16 v[48:63], v[80:83], v[64:67], v[48:63]
  s_add_u32 s20, s20, 1
  s_cmp_eq_u32 s20, s21
  v_exp_f32 v142, v142
  v_exp_f32 v143, v143
  v_cvt_pk_bf16_f32 v70, v140, v141
  v_cvt_pk_bf16_f32 v71, v142, v143
  v_exp_f32 v144, v144
  v_exp_f32 v145, v145
  v_mfma_f32_32x32x16_bf16 v[48:63], v[84:87], v[68:71], v[48:63]
  ds_read_b64_tr_b16 v[124:125], v6 offset:9728
  v_exp_f32 v146, v146
  v_exp_f32 v147, v147
  v_cvt_pk_bf16_f32 v64, v144, v145
  v_cvt_pk_bf16_f32 v65, v146, v147
  v_exp_f32 v148, v148
  v_exp_f32 v149, v149
  v_mfma_f32_32x32x16_bf16 v[16:31], v[72:75], v[88:91], v[16:31]
  ds_read_b64_tr_b16 v[126:127], v7 offset:9728
  v_exp_f32 v150, v150
  v_exp_f32 v151, v151
  v_cvt_pk_bf16_f32 v66, v148, v149
  v_cvt_pk_bf16_f32 v67, v150, v151
  v_exp_f32 v152, v152
  v_exp_f32 v153, v153
  v_mfma_f32_32x32x16_bf16 v[32:47], v[72:75], v[112:115], v[32:47]
  ds_read_b128 v[72:75], v2 offset:12160
  v_exp_f32 v154, v154
  v_exp_f32 v155, v155
  v_cvt_pk_bf16_f32 v68, v152, v153
  v_cvt_pk_bf16_f32 v69, v154, v155
  v_exp_f32 v156, v156
  v_exp_f32 v157, v157
  v_mfma_f32_32x32x16_bf16 v[96:111], v[80:83], v[64:67], v[96:111]
  ds_read_b64_tr_b16 v[80:81], v4 offset:9728
  v_exp_f32 v158, v158
  v_exp_f32 v159, v159
  v_cvt_pk_bf16_f32 v70, v156, v157
  v_cvt_pk_bf16_f32 v71, v158, v159
  s_cbranch_scc1 Lse_stub
Lse_mid:
  v_exp_f32 v16, v16
  v_exp_f32 v17, v17
  v_mfma_f32_32x32x16_bf16 v[96:111], v[84:87], v[68:71], v[96:111]
  ds_read_b64_tr_b16 v[82:83], v5 offset:9728
  v_exp_f32 v18, v18
  v_exp_f32 v19, v19
  v_cvt_pk_bf16_f32 v64, v16, v17
  v_cvt_pk_bf16_f32 v65, v18, v19
  v_exp_f32 v20, v20
  v_exp_f32 v21, v21
  v_mfma_f32_32x32x4_2b_bf16 v[128:159], v[76:77], v[92:93], 0
  ds_read_b32 v76, v3 offset:14592
  v_exp_f32 v22, v22
  v_exp_f32 v23, v23
  v_cvt_pk_bf16_f32 v66, v20, v21
  v_cvt_pk_bf16_f32 v67, v22, v23
  v_exp_f32 v24, v24
  v_exp_f32 v25, v25
  v_exp_f32 v26, v26
  v_exp_f32 v27, v27
  v_cvt_pk_bf16_f32 v68, v24, v25
  v_cvt_pk_bf16_f32 v69, v26, v27
  v_exp_f32 v28, v28
  v_exp_f32 v29, v29
  s_waitcnt lgkmcnt(0)
  v_mfma_f32_32x32x16_bf16 v[48:63], v[80:83], v[64:67], v[48:63]
  v_exp_f32 v30, v30
  v_exp_f32 v31, v31
  v_cvt_pk_bf16_f32 v70, v28, v29
  v_cvt_pk_bf16_f32 v71, v30, v31
  v_exp_f32 v32, v32
  v_exp_f32 v33, v33
  v_mfma_f32_32x32x16_bf16 v[48:63], v[124:127], v[68:71], v[48:63]
  ds_read_b64_tr_b16 v[84:85], v6 offset:12160
  v_exp_f32 v34, v34
  v_exp_f32 v35, v35
  v_cvt_pk_bf16_f32 v64, v32, v33
  v_cvt_pk_bf16_f32 v65, v34, v35
  v_exp_f32 v36, v36
  v_exp_f32 v37, v37
  v_mfma_f32_32x32x16_bf16 v[128:143], v[72:75], v[88:91], v[128:143]
  ds_read_b64_tr_b16 v[86:87], v7 offset:12160
  v_exp_f32 v38, v38
  v_exp_f32 v39, v39
  v_cvt_pk_bf16_f32 v66, v36, v37
  v_cvt_pk_bf16_f32 v67, v38, v39
  v_exp_f32 v40, v40
  v_exp_f32 v41, v41
  v_mfma_f32_32x32x16_bf16 v[144:159], v[72:75], v[112:115], v[144:159]
  ds_read_b128 v[72:75], v2 offset:14592
  v_exp_f32 v42, v42
  v_exp_f32 v43, v43
  v_cvt_pk_bf16_f32 v68, v40, v41
  v_cvt_pk_bf16_f32 v69, v42, v43
  v_exp_f32 v44, v44
  v_exp_f32 v45, v45
  v_mfma_f32_32x32x16_bf16 v[96:111], v[80:83], v[64:67], v[96:111]
  ds_read_b64_tr_b16 v[80:81], v4 offset:12160
  v_exp_f32 v46, v46
  v_exp_f32 v47, v47
  v_cvt_pk_bf16_f32 v70, v44, v45
  v_cvt_pk_bf16_f32 v71, v46, v47
  v_exp_f32 v128, v128
  v_exp_f32 v129, v129
  v_mfma_f32_32x32x16_bf16 v[96:111], v[124:127], v[68:71], v[96:111]
  ds_read_b64_tr_b16 v[82:83], v5 offset:12160
  v_exp_f32 v130, v130
  v_exp_f32 v131, v131
  v_cvt_pk_bf16_f32 v64, v128, v129
  v_cvt_pk_bf16_f32 v65, v130, v131
  v_exp_f32 v132, v132
  v_exp_f32 v133, v133
  v_mfma_f32_32x32x4_2b_bf16 v[16:47], v[76:77], v[92:93], 0
  ds_read_b32 v76, v3 offset:17024
  v_exp_f32 v134, v134
  v_exp_f32 v135, v135
  v_cvt_pk_bf16_f32 v66, v132, v133
  v_cvt_pk_bf16_f32 v67, v134, v135
  v_exp_f32 v136, v136
  v_exp_f32 v137, v137
  v_exp_f32 v138, v138
  v_exp_f32 v139, v139
  v_cvt_pk_bf16_f32 v68, v136, v137
  v_cvt_pk_bf16_f32 v69, v138, v139
  v_exp_f32 v140, v140
  v_exp_f32 v141, v141
  s_waitcnt lgkmcnt(0)
  v_mfma_f32_32x32x16_bf16 v[48:63], v[80:83], v[64:67], v[48:63]
  v_exp_f32 v142, v142
  v_exp_f32 v143, v143
  v_cvt_pk_bf16_f32 v70, v140, v141
  v_cvt_pk_bf16_f32 v71, v142, v143
  v_exp_f32 v144, v144
  v_exp_f32 v145, v145
  v_mfma_f32_32x32x16_bf16 v[48:63], v[84:87], v[68:71], v[48:63]
  ds_read_b64_tr_b16 v[124:125], v6 offset:14592
  v_exp_f32 v146, v146
  v_exp_f32 v147, v147
  v_cvt_pk_bf16_f32 v64, v144, v145
  v_cvt_pk_bf16_f32 v65, v146, v147
  v_exp_f32 v148, v148
  v_exp_f32 v149, v149
  v_mfma_f32_32x32x16_bf16 v[16:31], v[72:75], v[88:91], v[16:31]
  ds_read_b64_tr_b16 v[126:127], v7 offset:14592
  v_exp_f32 v150, v150
  v_exp_f32 v151, v151
  v_cvt_pk_bf16_f32 v66, v148, v149
  v_cvt_pk_bf16_f32 v67, v150, v151
  v_exp_f32 v152, v152
  v_exp_f32 v153, v153
  v_mfma_f32_32x32x16_bf16 v[32:47], v[72:75], v[112:115], v[32:47]
  ds_read_b128 v[72:75], v2 offset:17024
  v_exp_f32 v154, v154
  v_exp_f32 v155, v155
  v_cvt_pk_bf16_f32 v68, v152, v153
  v_cvt_pk_bf16_f32 v69, v154, v155
  v_exp_f32 v156, v156
  v_exp_f32 v157, v157
  v_mfma_f32_32x32x16_bf16 v[96:111], v[80:83], v[64:67], v[96:111]
  ds_read_b64_tr_b16 v[80:81], v4 offset:14592
  v_exp_f32 v158, v158
  v_exp_f32 v159, v159
  v_cvt_pk_bf16_f32 v70, v156, v157
  v_cvt_pk_bf16_f32 v71, v158, v159
  v_exp_f32 v16, v16
  v_exp_f32 v17, v17
  v_mfma_f32_32x32x16_bf16 v[96:111], v[84:87], v[68:71], v[96:111]
  ds_read_b64_tr_b16 v[82:83], v5 offset:14592
  v_exp_f32 v18, v18
  v_exp_f32 v19, v19
  v_cvt_pk_bf16_f32 v64, v16, v17
  v_cvt_pk_bf16_f32 v65, v18, v19
  v_exp_f32 v20, v20
  v_exp_f32 v21, v21
  v_mfma_f32_32x32x4_2b_bf16 v[128:159], v[76:77], v[92:93], 0
  ds_read_b32 v76, v3 offset:19456
  v_exp_f32 v22, v22
  v_exp_f32 v23, v23
  v_cvt_pk_bf16_f32 v66, v20, v21
  v_cvt_pk_bf16_f32 v67, v22, v23
  v_exp_f32 v24, v24
  v_exp_f32 v25, v25
  v_exp_f32 v26, v26
  v_exp_f32 v27, v27
  v_cvt_pk_bf16_f32 v68, v24, v25
  v_cvt_pk_bf16_f32 v69, v26, v27
  v_exp_f32 v28, v28
  v_exp_f32 v29, v29
  s_waitcnt lgkmcnt(0)
  v_mfma_f32_32x32x16_bf16 v[48:63], v[80:83], v[64:67], v[48:63]
  v_exp_f32 v30, v30
  v_exp_f32 v31, v31
  v_cvt_pk_bf16_f32 v70, v28, v29
  v_cvt_pk_bf16_f32 v71, v30, v31
  v_exp_f32 v32, v32
  v_exp_f32 v33, v33
  v_mfma_f32_32x32x16_bf16 v[48:63], v[124:127], v[68:71], v[48:63]
  ds_read_b64_tr_b16 v[84:85], v6 offset:17024
  v_exp_f32 v34, v34
  v_exp_f32 v35, v35
  v_cvt_pk_bf16_f32 v64, v32, v33
  v_cvt_pk_bf16_f32 v65, v34, v35
  v_exp_f32 v36, v36
  v_exp_f32 v37, v37
  v_mfma_f32_32x32x16_bf16 v[128:143], v[72:75], v[88:91], v[128:143]
  ds_read_b64_tr_b16 v[86:87], v7 offset:17024
  v_exp_f32 v38, v38
  v_exp_f32 v39, v39
  v_cvt_pk_bf16_f32 v66, v36, v37
  v_cvt_pk_bf16_f32 v67, v38, v39
  v_exp_f32 v40, v40
  v_exp_f32 v41, v41
  v_mfma_f32_32x32x16_bf16 v[144:159], v[72:75], v[112:115], v[144:159]
  ds_read_b128 v[72:75], v2 offset:19456
  v_exp_f32 v42, v42
  v_exp_f32 v43, v43
  v_cvt_pk_bf16_f32 v68, v40, v41
  v_cvt_pk_bf16_f32 v69, v42, v43
  v_exp_f32 v44, v44
  v_exp_f32 v45, v45
  v_mfma_f32_32x32x16_bf16 v[96:111], v[80:83], v[64:67], v[96:111]
  ds_read_b64_tr_b16 v[80:81], v4 offset:17024
  v_exp_f32 v46, v46
  v_exp_f32 v47, v47
  v_cvt_pk_bf16_f32 v70, v44, v45
  v_cvt_pk_bf16_f32 v71, v46, v47
  v_exp_f32 v128, v128
  v_exp_f32 v129, v129
  v_mfma_f32_32x32x16_bf16 v[96:111], v[124:127], v[68:71], v[96:111]
  ds_read_b64_tr_b16 v[82:83], v5 offset:17024
  v_exp_f32 v130, v130
  v_exp_f32 v131, v131
  v_cvt_pk_bf16_f32 v64, v128, v129
  v_cvt_pk_bf16_f32 v65, v130, v131
  v_exp_f32 v132, v132
  v_exp_f32 v133, v133
  v_mfma_f32_32x32x4_2b_bf16 v[16:47], v[76:77], v[92:93], 0
  ds_read_b32 v76, v3 offset:21888
  v_exp_f32 v134, v134
  v_exp_f32 v135, v135
  v_cvt_pk_bf16_f32 v66, v132, v133
  v_cvt_pk_bf16_f32 v67, v134, v135
  v_exp_f32 v136, v136
  v_exp_f32 v137, v137
  v_exp_f32 v138, v138
  v_exp_f32 v139, v139
  v_cvt_pk_bf16_f32 v68, v136, v137
  v_cvt_pk_bf16_f32 v69, v138, v139
  v_exp_f32 v140, v140
  v_exp_f32 v141, v141
  s_waitcnt lgkmcnt(0)
  v_mfma_f32_32x32x16_bf16 v[48:63], v[80:83], v[64:67], v[48:63]
  s_add_u32 s20, s20, 1
  s_cmp_eq_u32 s20, s21
  v_exp_f32 v142, v142
  v_exp_f32 v143, v143
  v_cvt_pk_bf16_f32 v70, v140, v141
  v_cvt_pk_bf16_f32 v71, v142, v143
  v_exp_f32 v144, v144
  v_exp_f32 v145, v145
  v_mfma_f32_32x32x16_bf16 v[48:63], v[84:87], v[68:71], v[48:63]
  ds_read_b64_tr_b16 v[124:125], v6 offset:19456
  v_exp_f32 v146, v146
  v_exp_f32 v147, v147
  v_cvt_pk_bf16_f32 v64, v144, v145
  v_cvt_pk_bf16_f32 v65, v146, v147
  v_exp_f32 v148, v148
  v_exp_f32 v149, v149
  v_mfma_f32_32x32x16_bf16 v[16:31], v[72:75], v[88:91], v[16:31]
  ds_read_b64_tr_b16 v[126:127], v7 offset:19456
  v_exp_f32 v150, v150
  v_exp_f32 v151, v151
  v_cvt_pk_bf16_f32 v66, v148, v149
  v_cvt_pk_bf16_f32 v67, v150, v151
  v_exp_f32 v152, v152
  v_exp_f32 v153, v153
  v_mfma_f32_32x32x16_bf16 v[32:47], v[72:75], v[112:115], v[32:47]
  ds_read_b128 v[72:75], v2 offset:21888
  v_exp_f32 v154, v154
  v_exp_f32 v155, v155
  v_cvt_pk_bf16_f32 v68, v152, v153
  v_cvt_pk_bf16_f32 v69, v154, v155
  v_exp_f32 v156, v156
  v_exp_f32 v157, v157
  v_mfma_f32_32x32x16_bf16 v[96:111], v[80:83], v[64:67], v[96:111]
  ds_read_b64_tr_b16 v[80:81], v4 offset:19456
  v_exp_f32 v158, v158
  v_exp_f32 v159, v159
  v_cvt_pk_bf16_f32 v70, v156, v157
  v_cvt_pk_bf16_f32 v71, v158, v159
  v_add_u32 v2, 19456, v2
  v_add_u32 v3, 19456, v3
  v_add_u32 v4, 19456, v4
  v_add_u32 v5, 19456, v5
  v_add_u32 v6, 19456, v6
  v_add_u32 v7, 19456, v7
  s_cbranch_scc1 Lse_stub
  s_cmp_lt_u32 s20, s3
  s_cbranch_scc1 Lse_loop
  v_mfma_f32_32x32x16_bf16 v[96:111], v[84:87], v[68:71], v[96:111]
  s_setprio 0
  s_waitcnt lgkmcnt(0)
  s_and_b32 s19, s16, 3
  s_lshl_b32 s24, s19, 12
  v_add_u32 v120, s24, v1
  s_lshl_b32 s24, s19, 11
  s_add_u32 s24, s24, 155648
  v_add_u32 v121, s24, v1
  v_mov_b32 v122, 16384
  s_waitcnt lgkmcnt(0)
  s_cmp_eq_u32 s48, 1
  s_cbranch_scc1 Lse_x0
  s_barrier
Lse_x0:
  s_cmp_lg_u32 s33, 0
  s_cbranch_scc1 Lse_xy
  ds_write_b128 v120, v[48:51] offset:0
  ds_write_b128 v120, v[52:55] offset:1024
  ds_write_b128 v121, v[56:59] offset:0
  ds_write_b128 v120, v[96:99] offset:2048
  ds_write_b128 v120, v[100:103] offset:3072
  ds_write_b128 v121, v[104:107] offset:1024
  s_cmp_lg_u32 s21, 98
  s_cbranch_scc1 Lse_x1
  s_mov_b32 s21, 99
  s_mul_i32 s59, s61, 128
  s_add_u32 s59, s59, 56098816
  s_waitcnt vmcnt(0)
  v_mov_b32 v124, 1
  v_mov_b32 v125, s1
  v_add_u32 v124, s0, v124
  v_lshlrev_b32 v126, 3, v0
  s_mov_b64 exec, 65535
  buffer_store_dwordx2 v[124:125], v126, s[12:15], s59 offen sc1
  s_mov_b64 exec, -1
  v_and_b32 v124, 1, v0
  v_mul_u32_u24 v124, 1152, v124
  v_lshrrev_b32 v125, 4, v0
  v_lshl_add_u32 v124, v125, 4, v124
  s_mul_i32 s60, s39, 9216
  s_add_u32 s60, s60, 15736832
  s_mov_b32 s59, 36864
  s_bitcmp1_b32 s16, 0
  s_cselect_b32 s60, 14942208, s60
  s_cselect_b32 s59, 64, s59
  s_cselect_b64 vcc, -1, 0
  s_lshr_b32 s58, s16, 1
  s_add_u32 s57, s58, 16
  s_mul_i32 s57, s57, s59
  s_add_u32 s57, s57, s60
  s_lshl_b32 s58, s58, 3
  s_mul_i32 s58, s58, s59
  s_add_u32 s60, s60, s58
  v_cndmask_b32 v124, v1, v124, vcc
  buffer_load_dwordx4 v[160:163], v124, s[12:15], s60 offen sc1
  s_add_u32 s60, s60, s59
  buffer_load_dwordx4 v[164:167], v124, s[12:15], s60 offen sc1
  s_add_u32 s60, s60, s59
  buffer_load_dwordx4 v[168:171], v124, s[12:15], s60 offen sc1
  s_add_u32 s60, s60, s59
  buffer_load_dwordx4 v[172:175], v124, s[12:15], s60 offen sc1
  s_add_u32 s60, s60, s59
  buffer_load_dwordx4 v[176:179], v124, s[12:15], s60 offen sc1
  s_add_u32 s60, s60, s59
  buffer_load_dwordx4 v[180:183], v124, s[12:15], s60 offen sc1
  s_add_u32 s60, s60, s59
  buffer_load_dwordx4 v[184:187], v124, s[12:15], s60 offen sc1
  s_add_u32 s60, s60, s59
  buffer_load_dwordx4 v[188:191], v124, s[12:15], s60 offen sc1
  s_add_u32 s60, s60, s59
  buffer_load_dwordx4 v[192:195], v124, s[12:15], s57 offen sc1
  s_and_b32 s57, s2, 1
  s_lshl_b32 s57, s57, 3
  s_bfe_u32 s58, s2, 0x30003
  s_add_u32 s57, s57, s58
  s_lshl_b32 s57, s57, 2
  s_add_u32 s57, s57, s16
  s_mul_i32 s57, s57, 36
  s_mul_i32 s58, s39, 9
  s_add_u32 s57, s57, s58
  s_mul_i32 s57, s57, 3072
  s_add_u32 s57, s57, 56623104
  s_bfe_u32 s58, s2, 0x20001
  s_mul_i32 s59, s58, 3072
  s_add_u32 s59, s59, s57
  s_add_u32 s60, s59, 12288
  s_add_u32 s57, s57, 24576
  v_mov_b32 v16, -1
  v_mov_b32 v17, -1
  v_mov_b32 v18, -1
  v_mov_b32 v19, -1
  buffer_store_dwordx4 v[16:19], v1, s[12:15], s59 offen offset:0 sc1
  buffer_store_dwordx4 v[16:19], v1, s[12:15], s59 offen offset:1024 sc1
  buffer_store_dwordx4 v[16:19], v1, s[12:15], s59 offen offset:2048 sc1
  buffer_store_dwordx4 v[16:19], v1, s[12:15], s60 offen offset:0 sc1
  buffer_store_dwordx4 v[16:19], v1, s[12:15], s60 offen offset:1024 sc1
  buffer_store_dwordx4 v[16:19], v1, s[12:15], s60 offen offset:2048 sc1
  s_cmp_lg_u32 s58, s16
  s_cbranch_scc1 Lse_x1
  buffer_store_dwordx4 v[16:19], v1, s[12:15], s57 offen offset:0 sc1
  buffer_store_dwordx4 v[16:19], v1, s[12:15], s57 offen offset:1024 sc1
  buffer_store_dwordx4 v[16:19], v1, s[12:15], s57 offen offset:2048 sc1
Lse_x1:
  s_waitcnt lgkmcnt(0)
  s_barrier
  s_branch Lse_x2
Lse_xy:
  s_lshl_b32 s24, s17, 16
  s_lshl_b32 s23, s18, 9
  s_add_u32 s24, s24, s23
  s_add_u32 s24, s24, 8388608
  s_lshl_b32 s19, s18, 5
  s_add_u32 s19, s19, s17
  s_lshl_b32 s23, s19, 7
  s_add_u32 s23, s23, 10485760
  s_add_u32 s22, s23, 4096
  s_mul_i32 s19, s19, 128
  s_add_u32 s19, s19, 54525952
  s_add_u32 s25, s19, 4096
  s_mov_b32 s26, 0x5d800000
  v_and_b32 v119, 31, v0
  v_lshrrev_b32 v123, 5, v0
  v_lshlrev_b32 v119, 4, v119
  v_lshl_add_u32 v123, v123, 15, v119
  v_lshlrev_b32 v119, 2, v0
  s_barrier
  ds_read_b128 v[24:27], v121 offset:0
  ds_read_b128 v[16:19], v120 offset:0
  ds_read_b128 v[20:23], v120 offset:1024
  ds_read_b128 v[40:43], v121 offset:1024
  ds_read_b128 v[32:35], v120 offset:2048
  ds_read_b128 v[36:39], v120 offset:3072
  s_waitcnt lgkmcnt(5)
  v_add_f32 v58, v58, v26
  v_rcp_f32 v124, v58
  s_waitcnt lgkmcnt(3)
  v_pk_add_f32 v[48:49], v[48:49], v[16:17]
  v_pk_add_f32 v[50:51], v[50:51], v[18:19]
  v_pk_add_f32 v[52:53], v[52:53], v[20:21]
  v_pk_add_f32 v[54:55], v[54:55], v[22:23]
  v_pk_add_f32 v[56:57], v[56:57], v[24:25]
  v_pk_mul_f32 v[48:49], v[48:49], v[124:125] op_sel:[0,0] op_sel_hi:[1,0]
  v_pk_mul_f32 v[50:51], v[50:51], v[124:125] op_sel:[0,0] op_sel_hi:[1,0]
  v_pk_mul_f32 v[52:53], v[52:53], v[124:125] op_sel:[0,0] op_sel_hi:[1,0]
  v_pk_mul_f32 v[54:55], v[54:55], v[124:125] op_sel:[0,0] op_sel_hi:[1,0]
  v_pk_mul_f32 v[56:57], v[56:57], v[124:125] op_sel:[0,0] op_sel_hi:[1,0]
  v_cvt_pk_bf16_f32 v64, v48, v49
  v_cvt_pk_bf16_f32 v65, v50, v51
  v_cvt_pk_bf16_f32 v66, v52, v53
  v_cvt_pk_bf16_f32 v67, v54, v55
  v_cvt_pk_bf16_f32 v68, v56, v57
  buffer_store_dwordx4 v[64:67], v123, s[12:15], s24 offen offset:0 sc1
  s_mov_b64 exec, s[30:31]
  buffer_store_dword v68, v119, s[12:15], s23 offen sc1
  s_mov_b64 exec, -1
  s_waitcnt lgkmcnt(2)
  v_add_f32 v106, v106, v42
  v_rcp_f32 v125, v106
  s_waitcnt lgkmcnt(0)
  v_pk_add_f32 v[96:97], v[96:97], v[32:33]
  v_pk_add_f32 v[98:99], v[98:99], v[34:35]
  v_pk_add_f32 v[100:101], v[100:101], v[36:37]
  v_pk_add_f32 v[102:103], v[102:103], v[38:39]
  v_pk_add_f32 v[104:105], v[104:105], v[40:41]
  v_pk_mul_f32 v[96:97], v[96:97], v[124:125] op_sel:[0,1] op_sel_hi:[1,1]
  v_pk_mul_f32 v[98:99], v[98:99], v[124:125] op_sel:[0,1] op_sel_hi:[1,1]
  v_pk_mul_f32 v[100:101], v[100:101], v[124:125] op_sel:[0,1] op_sel_hi:[1,1]
  v_pk_mul_f32 v[102:103], v[102:103], v[124:125] op_sel:[0,1] op_sel_hi:[1,1]
  v_pk_mul_f32 v[104:105], v[104:105], v[124:125] op_sel:[0,1] op_sel_hi:[1,1]
  v_cvt_pk_bf16_f32 v80, v96, v97
  v_cvt_pk_bf16_f32 v81, v98, v99
  v_cvt_pk_bf16_f32 v82, v100, v101
  v_cvt_pk_bf16_f32 v83, v102, v103
  v_cvt_pk_bf16_f32 v84, v104, v105
  buffer_store_dwordx4 v[80:83], v123, s[12:15], s24 offen offset:512 sc1
  s_mov_b64 exec, s[30:31]
  buffer_store_dword v84, v119, s[12:15], s22 offen sc1
  s_mov_b64 exec, -1
  v_add_f32 v118, v58, v106
  v_cmp_ngt_f32 vcc, s26, v118
  s_lshl_b32 s26, s16, 2
  s_add_u32 s26, s26, 16368
  v_mov_b32 v118, s26
  s_cmp_lg_u64 vcc, 0
  s_cselect_b32 s26, 1, 0
  v_mov_b32 v120, s26
  ds_write_b32 v118, v120
  s_waitcnt lgkmcnt(0)
Lse_x2:
  s_barrier
  ds_read_b128 v[72:75], v122
  s_waitcnt lgkmcnt(0)
  v_or3_b32 v72, v72, v73, v74
  v_or_b32 v72, v72, v75
  s_nop 0
  v_readfirstlane_b32 s26, v72
  s_and_b32 s26, s26, s48
  s_cmp_eq_u32 s26, 1
  s_cbranch_scc1 Lse_fallback
  s_mov_b32 s4, s28
  s_mov_b32 s5, s29
  s_mov_b32 s6, 0x240000
  s_mov_b32 s7, 0x20000
  v_and_b32 v2, 15, v0
  v_lshrrev_b32 v3, 4, v0
  v_lshlrev_b32 v4, 15, v3
  v_lshl_add_u32 v4, v2, 4, v4
  v_and_b32 v7, 31, v0
  v_mul_u32_u24 v7, 128, v7
  v_mul_u32_u24 v5, 1152, v2
  v_lshl_add_u32 v5, v3, 3, v5
  v_lshlrev_b32 v6, 2, v2
  s_mul_i32 s24, s38, 36864
  s_lshl_b32 s23, s49, 5
  s_add_u32 s24, s24, s23
  s_add_u32 s23, s24, 18432
  s_lshl_b32 s26, s38, 7
  s_lshl_b32 s27, s38, 8
  s_add_u32 s27, s27, 15007748
  v_lshlrev_b32 v9, 3, v2
  s_cmp_lt_u32 s16, 2
  s_cbranch_scc1 Lse_ppx
  s_cmp_lt_u32 s16, 4
  s_cbranch_scc1 Lse_cfp
  s_waitcnt vmcnt(0)
  v_mov_b32 v60, 1
  v_mov_b32 v61, s1
  v_add_u32 v60, s0, v60
  v_lshlrev_b32 v62, 3, v0
  s_mov_b64 exec, 65535
  buffer_store_dwordx2 v[60:61], v62, s[12:15], s19 offen sc1
  buffer_store_dwordx2 v[60:61], v62, s[12:15], s25 offen sc1
  s_mov_b64 exec, -1
  s_branch Lse_ppx
Lse_cfp:
  s_mul_i32 s59, s9, 9
  s_sub_u32 s60, s16, 2
  s_lshl_b32 s60, s60, 3
  s_add_u32 s59, s59, s60
  s_lshr_b32 s55, s59, 4
  s_bfe_u32 s59, s2, 0x20001
  s_mul_i32 s59, s59, 81
  s_mul_i32 s60, s39, 9
  s_lshr_b32 s60, s60, 2
  s_add_u32 s59, s59, s60
  s_add_u32 s59, s59, 648
  v_subrev_u32 v9, 36, v0
  v_min_u32 v9, 26, v9
  v_mul_u32_u24 v10, 21846, v9
  v_lshrrev_b32 v10, 16, v10
  v_mad_u32_u24 v9, v10, 6, v9
  v_add_u32 v9, s59, v9
  v_mul_u32_u24 v10, 18, v0
  v_add_u32 v10, s55, v10
  v_cmp_gt_u32 vcc, 36, v0
  s_mov_b32 s59, 56098816
  s_nop 0
  v_cndmask_b32 v11, v9, v10, vcc
  v_mul_u32_u24 v11, 128, v11
  s_mov_b32 s60, 0
Lse_pp:
  buffer_load_dwordx2 v[60:61], v11, s[12:15], s59 offen sc1
  s_add_u32 s60, s60, 1
  s_waitcnt vmcnt(0)
  v_subrev_u32 v60, s0, v60
  v_xor_b32 v61, s1, v61
  v_subrev_u32 v60, 1, v60
  v_and_or_b32 v60, v60, -4, v61
  v_cmp_ne_u32 vcc, 0, v60
  s_cmp_ge_u32 s60, 400000
  s_cbranch_scc1 Lse_ppx
  s_cbranch_vccz Lse_ppx
  s_sleep 2
  s_branch Lse_pp
Lse_ppx:
  s_barrier
  s_cmp_gt_u32 s11, 4
  s_cbranch_scc1 Lse_cnx
  buffer_load_dwordx2 v[48:49], v5, s[4:7], s24 offen offset:0
  buffer_load_dwordx2 v[52:53], v5, s[4:7], s24 offen offset:32
  buffer_load_dword v56, v9, s[12:15], s27 offen offset:0 sc1
  buffer_load_dwordx2 v[50:51], v5, s[4:7], s23 offen offset:0
  buffer_load_dwordx2 v[54:55], v5, s[4:7], s23 offen offset:32
  buffer_load_dword v57, v9, s[12:15], s27 offen offset:128 sc1
  s_cmp_eq_u32 s11, 4
  s_cbranch_scc1 Lse_cnx
  buffer_load_dwordx4 v[112:115], v1, s[12:15], s62 offen offset:0 sc1
  buffer_load_dwordx4 v[116:119], v1, s[12:15], s62 offen offset:1024 sc1
  s_add_u32 s62, s62, 36864
  buffer_load_dwordx4 v[120:123], v1, s[12:15], s62 offen offset:0 sc1
  buffer_load_dwordx4 v[124:127], v1, s[12:15], s62 offen offset:1024 sc1
  s_add_u32 s62, s62, 36864
  buffer_load_dwordx4 v[128:131], v1, s[12:15], s62 offen offset:0 sc1
  buffer_load_dwordx4 v[132:135], v1, s[12:15], s62 offen offset:1024 sc1
  s_add_u32 s62, s62, 36864
  buffer_load_dwordx4 v[136:139], v1, s[12:15], s62 offen offset:0 sc1
  buffer_load_dwordx4 v[140:143], v1, s[12:15], s62 offen offset:1024 sc1
  s_add_u32 s62, s62, 36864
  buffer_load_dwordx4 v[144:147], v1, s[12:15], s62 offen offset:0 sc1
  buffer_load_dwordx4 v[148:151], v1, s[12:15], s62 offen offset:1024 sc1
  s_add_u32 s62, s62, 36864
  buffer_load_dwordx4 v[152:155], v1, s[12:15], s62 offen offset:0 sc1
  buffer_load_dwordx4 v[156:159], v1, s[12:15], s62 offen offset:1024 sc1
  s_add_u32 s62, s62, 36864
Lse_cnx:
  s_mul_i32 s59, s38, 4096
  s_add_u32 s59, s59, 54525952
  s_lshl_b32 s57, s38, 9
  s_add_u32 s57, s57, 8388608
  s_lshr_b32 s58, s16, 1
  s_lshl_b32 s58, s58, 17
  s_add_u32 s57, s57, s58
  s_and_b32 s58, s16, 1
  s_lshl_b32 s58, s58, 8
  s_add_u32 s57, s57, s58
  s_lshl_b32 s58, s16, 10
  s_lshl_b32 s56, s38, 12
  s_add_u32 s56, s56, s58
  s_add_u32 s56, s56, 10485760
  s_add_u32 s58, s58, 126976
  v_add_u32 v5, 126976, v1
  v_lshlrev_b32 v8, 9, v3
  v_add_u32 v8, v8, v6
  v_add_u32 v8, 159744, v8
  s_add_u32 s47, s8, s9
  s_mul_i32 s46, s47, 21846
  s_lshr_b32 s46, s46, 16
  s_mul_i32 s46, s46, 3
  s_sub_u32 s47, s47, s46
  s_mov_b32 s47, 0
  s_mul_i32 s40, s47, 12288
  s_add_u32 s41, s40, 12288
  s_cmp_ge_u32 s41, 36864
  s_cselect_b32 s41, 0, s41
  s_add_u32 s42, s41, 12288
  s_cmp_ge_u32 s42, 36864
  s_cselect_b32 s42, 0, s42
  s_mov_b32 s43, s47
  s_cmp_ge_u32 s16, 4
  s_cbranch_scc1 Lse_pbx
  s_cmp_eq_u32 s16, 1
  s_cbranch_scc1 Lse_pb0
  s_sub_u32 s34, s16, 1
  s_max_i32 s34, s34, 0
  s_mul_i32 s22, s34, 36864
  s_add_u32 s22, s22, s10
  s_mul_i32 s34, s34, 12288
  s_add_u32 m0, s34, 0
  s_add_u32 s35, s22, s40
  s_add_u32 s35, s35, 0
  buffer_load_dwordx4 v1, s[12:15], s35 offen offset:0 sc1 lds
  buffer_load_dwordx4 v1, s[12:15], s35 offen offset:1024 sc1 lds
  buffer_load_dwordx4 v1, s[12:15], s35 offen offset:2048 sc1 lds
  buffer_load_dwordx4 v1, s[12:15], s35 offen offset:3072 sc1 lds
  s_add_u32 m0, s34, 4096
  s_add_u32 s35, s22, s40
  s_add_u32 s35, s35, 4096
  buffer_load_dwordx4 v1, s[12:15], s35 offen offset:0 sc1 lds
  buffer_load_dwordx4 v1, s[12:15], s35 offen offset:1024 sc1 lds
  buffer_load_dwordx4 v1, s[12:15], s35 offen offset:2048 sc1 lds
  buffer_load_dwordx4 v1, s[12:15], s35 offen offset:3072 sc1 lds
  s_add_u32 m0, s34, 8192
  s_add_u32 s35, s22, s40
  s_add_u32 s35, s35, 8192
  buffer_load_dwordx4 v1, s[12:15], s35 offen offset:0 sc1 lds
  buffer_load_dwordx4 v1, s[12:15], s35 offen offset:1024 sc1 lds
  buffer_load_dwordx4 v1, s[12:15], s35 offen offset:2048 sc1 lds
  buffer_load_dwordx4 v1, s[12:15], s35 offen offset:3072 sc1 lds
  s_branch Lse_pbx
Lse_pb0:
  s_mov_b32 s60, 0
Lse_pb:
  buffer_load_dwordx2 v[60:61], v7, s[12:15], s59 offen sc1
  s_add_u32 s60, s60, 1
  s_waitcnt vmcnt(0)
  v_subrev_u32 v60, s0, v60
  v_xor_b32 v61, s1, v61
  v_subrev_u32 v60, 1, v60
  v_and_or_b32 v60, v60, -4, v61
  v_cmp_ne_u32 vcc, 0, v60
  s_cmp_ge_u32 s60, 400000
  s_cbranch_scc1 Lse_pbx
  s_cbranch_vccz Lse_pbx
  s_sleep 2
  s_branch Lse_pb
Lse_pbx:
  s_barrier
  s_add_u32 m0, s58, 0
  s_add_u32 s62, s57, 0
  buffer_load_dwordx4 v4, s[12:15], s62 offen sc1 lds
  s_add_u32 m0, s58, 8192
  s_add_u32 s62, s57, 524288
  buffer_load_dwordx4 v4, s[12:15], s62 offen sc1 lds
  s_add_u32 m0, s58, 16384
  s_add_u32 s62, s57, 1048576
  buffer_load_dwordx4 v4, s[12:15], s62 offen sc1 lds
  s_add_u32 m0, s58, 24576
  s_add_u32 s62, s57, 1572864
  buffer_load_dwordx4 v4, s[12:15], s62 offen sc1 lds
  s_cmp_ge_u32 s16, 4
  s_cbranch_scc1 Lse_co
  s_add_u32 m0, s58, 32768
  s_nop 0
  buffer_load_dwordx4 v1, s[12:15], s56 offen sc1 lds
Lse_co:
  s_waitcnt vmcnt(0)
  s_barrier
  v_add_u32 v10, 110592, v1
  s_cmp_lt_u32 s16, 4
  s_cbranch_scc1 Lse_chelp
  ds_read_b128 v[64:67], v5 offset:0
  ds_read_b128 v[68:71], v5 offset:1024
  ds_read_b128 v[72:75], v5 offset:2048
  ds_read_b128 v[76:79], v5 offset:3072
  ds_read_b128 v[80:83], v5 offset:4096
  ds_read_b128 v[84:87], v5 offset:5120
  ds_read_b128 v[88:91], v5 offset:6144
  ds_read_b128 v[92:95], v5 offset:7168
  ds_read_b128 v[96:99], v5 offset:8192
  ds_read_b128 v[100:103], v5 offset:9216
  s_waitcnt lgkmcnt(8)
  v_mfma_f32_16x16x32_bf16 v[16:19], v[160:163], v[64:67], 0
  ds_read_b128 v[104:107], v5 offset:10240
  v_mfma_f32_16x16x32_bf16 v[20:23], v[160:163], v[68:71], 0
  ds_read_b128 v[108:111], v5 offset:11264
  v_mfma_f32_16x16x32_bf16 v[24:27], v[164:167], v[64:67], 0
  v_mfma_f32_16x16x32_bf16 v[28:31], v[164:167], v[68:71], 0
  s_waitcnt lgkmcnt(8)
  v_mfma_f32_16x16x32_bf16 v[16:19], v[168:171], v[72:75], v[16:19]
  ds_read_b128 v[64:67], v5 offset:12288
  v_mfma_f32_16x16x32_bf16 v[20:23], v[168:171], v[76:79], v[20:23]
  ds_read_b128 v[68:71], v5 offset:13312
  v_mfma_f32_16x16x32_bf16 v[24:27], v[172:175], v[72:75], v[24:27]
  v_mfma_f32_16x16x32_bf16 v[28:31], v[172:175], v[76:79], v[28:31]
  s_waitcnt lgkmcnt(8)
  v_mfma_f32_16x16x32_bf16 v[16:19], v[176:179], v[80:83], v[16:19]
  ds_read_b128 v[72:75], v5 offset:14336
  v_mfma_f32_16x16x32_bf16 v[20:23], v[176:179], v[84:87], v[20:23]
  ds_read_b128 v[76:79], v5 offset:15360
  v_mfma_f32_16x16x32_bf16 v[24:27], v[180:183], v[80:83], v[24:27]
  v_mfma_f32_16x16x32_bf16 v[28:31], v[180:183], v[84:87], v[28:31]
  s_waitcnt lgkmcnt(8)
  v_mfma_f32_16x16x32_bf16 v[16:19], v[184:187], v[88:91], v[16:19]
  ds_read_b128 v[80:83], v5 offset:16384
  v_mfma_f32_16x16x32_bf16 v[20:23], v[184:187], v[92:95], v[20:23]
  ds_read_b128 v[84:87], v5 offset:17408
  v_mfma_f32_16x16x32_bf16 v[24:27], v[188:191], v[88:91], v[24:27]
  v_mfma_f32_16x16x32_bf16 v[28:31], v[188:191], v[92:95], v[28:31]
  s_waitcnt lgkmcnt(8)
  v_mfma_f32_16x16x32_bf16 v[16:19], v[192:195], v[96:99], v[16:19]
  ds_read_b128 v[88:91], v5 offset:18432
  v_mfma_f32_16x16x32_bf16 v[20:23], v[192:195], v[100:103], v[20:23]
  ds_read_b128 v[92:95], v5 offset:19456
  v_mfma_f32_16x16x32_bf16 v[24:27], v[196:199], v[96:99], v[24:27]
  v_mfma_f32_16x16x32_bf16 v[28:31], v[196:199], v[100:103], v[28:31]
  s_waitcnt lgkmcnt(8)
  v_mfma_f32_16x16x32_bf16 v[16:19], v[200:203], v[104:107], v[16:19]
  ds_read_b128 v[96:99], v5 offset:20480
  v_mfma_f32_16x16x32_bf16 v[20:23], v[200:203], v[108:111], v[20:23]
  ds_read_b128 v[100:103], v5 offset:21504
  v_mfma_f32_16x16x32_bf16 v[24:27], v[204:207], v[104:107], v[24:27]
  v_mfma_f32_16x16x32_bf16 v[28:31], v[204:207], v[108:111], v[28:31]
  s_waitcnt lgkmcnt(8)
  v_mfma_f32_16x16x32_bf16 v[16:19], v[208:211], v[64:67], v[16:19]
  ds_read_b128 v[104:107], v5 offset:22528
  v_mfma_f32_16x16x32_bf16 v[20:23], v[208:211], v[68:71], v[20:23]
  ds_read_b128 v[108:111], v5 offset:23552
  v_mfma_f32_16x16x32_bf16 v[24:27], v[212:215], v[64:67], v[24:27]
  v_mfma_f32_16x16x32_bf16 v[28:31], v[212:215], v[68:71], v[28:31]
  s_waitcnt lgkmcnt(8)
  v_mfma_f32_16x16x32_bf16 v[16:19], v[216:219], v[72:75], v[16:19]
  ds_read_b128 v[64:67], v5 offset:24576
  v_mfma_f32_16x16x32_bf16 v[20:23], v[216:219], v[76:79], v[20:23]
  ds_read_b128 v[68:71], v5 offset:25600
  v_mfma_f32_16x16x32_bf16 v[24:27], v[220:223], v[72:75], v[24:27]
  v_mfma_f32_16x16x32_bf16 v[28:31], v[220:223], v[76:79], v[28:31]
  s_waitcnt lgkmcnt(8)
  v_mfma_f32_16x16x32_bf16 v[16:19], v[224:227], v[80:83], v[16:19]
  ds_read_b128 v[72:75], v5 offset:26624
  v_mfma_f32_16x16x32_bf16 v[20:23], v[224:227], v[84:87], v[20:23]
  ds_read_b128 v[76:79], v5 offset:27648
  v_mfma_f32_16x16x32_bf16 v[24:27], v[228:231], v[80:83], v[24:27]
  v_mfma_f32_16x16x32_bf16 v[28:31], v[228:231], v[84:87], v[28:31]
  s_waitcnt lgkmcnt(8)
  v_mfma_f32_16x16x32_bf16 v[16:19], v[232:235], v[88:91], v[16:19]
  ds_read_b128 v[80:83], v5 offset:28672
  v_mfma_f32_16x16x32_bf16 v[20:23], v[232:235], v[92:95], v[20:23]
  ds_read_b128 v[84:87], v5 offset:29696
  v_mfma_f32_16x16x32_bf16 v[24:27], v[236:239], v[88:91], v[24:27]
  v_mfma_f32_16x16x32_bf16 v[28:31], v[236:239], v[92:95], v[28:31]
  s_waitcnt lgkmcnt(8)
  v_mfma_f32_16x16x32_bf16 v[16:19], v[240:243], v[96:99], v[16:19]
  ds_read_b128 v[88:91], v5 offset:30720
  v_mfma_f32_16x16x32_bf16 v[20:23], v[240:243], v[100:103], v[20:23]
  ds_read_b128 v[92:95], v5 offset:31744
  v_mfma_f32_16x16x32_bf16 v[24:27], v[244:247], v[96:99], v[24:27]
  v_mfma_f32_16x16x32_bf16 v[28:31], v[244:247], v[100:103], v[28:31]
  s_waitcnt lgkmcnt(8)
  v_mfma_f32_16x16x32_bf16 v[16:19], v[248:251], v[104:107], v[16:19]
  ds_read2_b32 v[96:97], v8 offset0:0 offset1:32
  v_mfma_f32_16x16x32_bf16 v[20:23], v[248:251], v[108:111], v[20:23]
  ds_read2_b32 v[98:99], v8 offset0:64 offset1:96
  v_mfma_f32_16x16x32_bf16 v[24:27], v[252:255], v[104:107], v[24:27]
  ds_read2_b32 v[100:101], v8 offset0:16 offset1:48
  v_mfma_f32_16x16x32_bf16 v[28:31], v[252:255], v[108:111], v[28:31]
  ds_read2_b32 v[102:103], v8 offset0:80 offset1:112
  s_waitcnt lgkmcnt(10)
  v_mfma_f32_16x16x32_bf16 v[16:19], v[112:115], v[64:67], v[16:19]
  v_add_u32 v8, 2048, v8
  v_mfma_f32_16x16x32_bf16 v[20:23], v[112:115], v[68:71], v[20:23]
  ds_read2_b32 v[104:105], v8 offset0:0 offset1:32
  v_mfma_f32_16x16x32_bf16 v[24:27], v[116:119], v[64:67], v[24:27]
  ds_read2_b32 v[106:107], v8 offset0:64 offset1:96
  v_mfma_f32_16x16x32_bf16 v[28:31], v[116:119], v[68:71], v[28:31]
  ds_read2_b32 v[108:109], v8 offset0:16 offset1:48
  ds_read2_b32 v[110:111], v8 offset0:80 offset1:112
  s_waitcnt lgkmcnt(12)
  v_mfma_f32_16x16x32_bf16 v[16:19], v[120:123], v[72:75], v[16:19]
  v_mfma_f32_16x16x32_bf16 v[20:23], v[120:123], v[76:79], v[20:23]
  v_mfma_f32_16x16x32_bf16 v[24:27], v[124:127], v[72:75], v[24:27]
  v_mfma_f32_16x16x32_bf16 v[28:31], v[124:127], v[76:79], v[28:31]
  s_waitcnt lgkmcnt(10)
  v_mfma_f32_16x16x32_bf16 v[16:19], v[128:131], v[80:83], v[16:19]
  v_mfma_f32_16x16x32_bf16 v[20:23], v[128:131], v[84:87], v[20:23]
  v_mfma_f32_16x16x32_bf16 v[24:27], v[132:135], v[80:83], v[24:27]
  v_mfma_f32_16x16x32_bf16 v[28:31], v[132:135], v[84:87], v[28:31]
  s_waitcnt lgkmcnt(8)
  v_mfma_f32_16x16x32_bf16 v[16:19], v[136:139], v[88:91], v[16:19]
  v_mfma_f32_16x16x32_bf16 v[20:23], v[136:139], v[92:95], v[20:23]
  v_mfma_f32_16x16x32_bf16 v[24:27], v[140:143], v[88:91], v[24:27]
  v_mfma_f32_16x16x32_bf16 v[28:31], v[140:143], v[92:95], v[28:31]
  s_waitcnt lgkmcnt(4)
  v_mfma_f32_16x16x32_bf16 v[16:19], v[144:147], v[96:99], v[16:19]
  v_mfma_f32_16x16x32_bf16 v[20:23], v[144:147], v[100:103], v[20:23]
  v_mfma_f32_16x16x32_bf16 v[24:27], v[148:151], v[96:99], v[24:27]
  v_mfma_f32_16x16x32_bf16 v[28:31], v[148:151], v[100:103], v[28:31]
  s_waitcnt lgkmcnt(0)
  v_mfma_f32_16x16x32_bf16 v[16:19], v[152:155], v[104:107], v[16:19]
  v_mfma_f32_16x16x32_bf16 v[20:23], v[152:155], v[108:111], v[20:23]
  v_mfma_f32_16x16x32_bf16 v[24:27], v[156:159], v[104:107], v[24:27]
  v_mfma_f32_16x16x32_bf16 v[28:31], v[156:159], v[108:111], v[28:31]
Lse_cepi:
  s_lshl_b32 s24, s49, 16
  s_lshl_b32 s23, s38, 9
  s_add_u32 s24, s24, s23
  s_add_u32 s24, s24, 11534336
  v_lshrrev_b32 v8, 5, v0
  v_lshlrev_b32 v8, 15, v8
  v_and_b32 v9, 31, v0
  v_lshl_add_u32 v8, v9, 4, v8
  v_lshlrev_b32 v9, 2, v9
  v_mov_b32 v58, 0
  v_mov_b32 v59, 0
  v_lshlrev_b32 v32, 16, v48
  v_and_b32 v33, 0xffff0000, v48
  v_lshlrev_b32 v34, 16, v49
  v_and_b32 v35, 0xffff0000, v49
  v_lshlrev_b32 v36, 16, v50
  v_and_b32 v37, 0xffff0000, v50
  v_lshlrev_b32 v38, 16, v51
  v_and_b32 v39, 0xffff0000, v51
  v_lshlrev_b32 v40, 16, v52
  v_and_b32 v41, 0xffff0000, v52
  v_lshlrev_b32 v42, 16, v53
  v_and_b32 v43, 0xffff0000, v53
  v_lshlrev_b32 v44, 16, v54
  v_and_b32 v45, 0xffff0000, v54
  v_lshlrev_b32 v46, 16, v55
  v_and_b32 v47, 0xffff0000, v55
  s_barrier
  ds_read_b64 v[64:65], v10 offset:2048
  ds_read_b64 v[66:67], v10 offset:6144
  ds_read_b64 v[68:69], v10 offset:3072
  ds_read_b64 v[70:71], v10 offset:7168
  ds_read_b128 v[72:75], v10 offset:4096
  ds_read_b128 v[76:79], v10 offset:5120
  v_pk_add_f32 v[16:17], v[16:17], v[32:33]
  v_pk_add_f32 v[18:19], v[18:19], v[34:35]
  v_pk_add_f32 v[20:21], v[20:21], v[36:37]
  v_pk_add_f32 v[22:23], v[22:23], v[38:39]
  v_pk_add_f32 v[24:25], v[24:25], v[40:41]
  v_pk_add_f32 v[26:27], v[26:27], v[42:43]
  v_pk_add_f32 v[28:29], v[28:29], v[44:45]
  v_pk_add_f32 v[30:31], v[30:31], v[46:47]
  s_waitcnt lgkmcnt(0)
  v_pk_add_f32 v[64:65], v[64:65], v[66:67]
  v_add_f32 v56, v56, v64
  v_add_f32 v56, v56, v65
  v_pk_add_f32 v[68:69], v[68:69], v[70:71]
  v_add_f32 v57, v57, v68
  v_add_f32 v57, v57, v69
  s_cmp_lg_u32 s11, 4
  s_cbranch_scc1 Lse_cn8
  v_pk_add_f32 v[16:17], v[16:17], v[72:73]
  v_pk_add_f32 v[18:19], v[18:19], v[74:75]
  v_pk_add_f32 v[20:21], v[20:21], v[76:77]
  v_pk_add_f32 v[22:23], v[22:23], v[78:79]
Lse_cn8:
  v_sub_f32 v16, v16, v56
  v_sub_f32 v17, v17, v56
  v_sub_f32 v18, v18, v56
  v_sub_f32 v19, v19, v56
  v_cvt_pk_bf16_f32 v48, v16, v17
  v_cvt_pk_bf16_f32 v49, v18, v19
  v_fmac_f32 v58, v16, v16
  v_fmac_f32 v58, v17, v17
  v_fmac_f32 v58, v18, v18
  v_fmac_f32 v58, v19, v19
  v_sub_f32 v20, v20, v57
  v_sub_f32 v21, v21, v57
  v_sub_f32 v22, v22, v57
  v_sub_f32 v23, v23, v57
  v_cvt_pk_bf16_f32 v50, v20, v21
  v_cvt_pk_bf16_f32 v51, v22, v23
  v_fmac_f32 v59, v20, v20
  v_fmac_f32 v59, v21, v21
  v_fmac_f32 v59, v22, v22
  v_fmac_f32 v59, v23, v23
  v_permlane16_swap_b32 v48, v50
  v_permlane16_swap_b32 v49, v51
  buffer_store_dwordx4 v[48:51], v8, s[12:15], s24 offen sc1
  s_add_u32 s24, s24, 65536
  s_cmp_eq_u32 s11, 4
  s_cbranch_scc1 Lse_cq
  v_sub_f32 v24, v24, v56
  v_sub_f32 v25, v25, v56
  v_sub_f32 v26, v26, v56
  v_sub_f32 v27, v27, v56
  v_cvt_pk_bf16_f32 v52, v24, v25
  v_cvt_pk_bf16_f32 v53, v26, v27
  v_fmac_f32 v58, v24, v24
  v_fmac_f32 v58, v25, v25
  v_fmac_f32 v58, v26, v26
  v_fmac_f32 v58, v27, v27
  v_sub_f32 v28, v28, v57
  v_sub_f32 v29, v29, v57
  v_sub_f32 v30, v30, v57
  v_sub_f32 v31, v31, v57
  v_cvt_pk_bf16_f32 v54, v28, v29
  v_cvt_pk_bf16_f32 v55, v30, v31
  v_fmac_f32 v59, v28, v28
  v_fmac_f32 v59, v29, v29
  v_fmac_f32 v59, v30, v30
  v_fmac_f32 v59, v31, v31
  v_permlane16_swap_b32 v52, v54
  v_permlane16_swap_b32 v53, v55
  buffer_store_dwordx4 v[52:55], v8, s[12:15], s24 offen sc1
  s_add_u32 s24, s24, 65536
Lse_cq:
  s_mul_i32 s23, s39, 5
  s_add_u32 s23, s23, s11
  v_permlane16_swap_b32 v58, v59
  v_permlane16_swap_b32 v56, v57
  s_lshl_b32 s27, s23, 13
  s_add_u32 s27, s27, s26
  s_add_u32 s27, s27, 14696448
  v_add_f32 v58, v58, v59
  v_mov_b32 v59, v58
  s_add_u32 s26, s26, 14688256
  s_cmp_lg_u32 s23, 0
  s_cselect_b32 s26, 1073741824, s26
  v_permlane32_swap_b32 v58, v59
  v_add_f32 v58, v58, v59
  s_mov_b32 exec_hi, 0
  buffer_store_dword v58, v9, s[12:15], s27 offen sc1
  buffer_store_dword v56, v9, s[12:15], s26 offen sc1
  s_mov_b64 exec, -1
  s_lshl_b32 s3, s38, 5
  s_add_u32 s3, s3, s23
  s_mul_i32 s3, s3, 128
  s_add_u32 s3, s3, 54788096
  s_branch Lse_dstart
Lse_chelp:
  s_cmp_eq_u32 s16, 0
  s_cbranch_scc1 Lse_ch2
  s_sub_u32 s34, s16, 1
  s_mul_i32 s22, s34, 36864
  s_add_u32 s22, s22, s10
  s_mul_i32 s34, s34, 12288
  s_add_u32 m0, s34, 36864
  s_add_u32 s35, s22, s41
  s_add_u32 s35, s35, 0
  buffer_load_dwordx4 v1, s[12:15], s35 offen offset:0 sc1 lds
  buffer_load_dwordx4 v1, s[12:15], s35 offen offset:1024 sc1 lds
  buffer_load_dwordx4 v1, s[12:15], s35 offen offset:2048 sc1 lds
  buffer_load_dwordx4 v1, s[12:15], s35 offen offset:3072 sc1 lds
  s_add_u32 m0, s34, 40960
  s_add_u32 s35, s22, s41
  s_add_u32 s35, s35, 4096
  buffer_load_dwordx4 v1, s[12:15], s35 offen offset:0 sc1 lds
  buffer_load_dwordx4 v1, s[12:15], s35 offen offset:1024 sc1 lds
  buffer_load_dwordx4 v1, s[12:15], s35 offen offset:2048 sc1 lds
  buffer_load_dwordx4 v1, s[12:15], s35 offen offset:3072 sc1 lds
  s_add_u32 m0, s34, 45056
  s_add_u32 s35, s22, s41
  s_add_u32 s35, s35, 8192
  buffer_load_dwordx4 v1, s[12:15], s35 offen offset:0 sc1 lds
  buffer_load_dwordx4 v1, s[12:15], s35 offen offset:1024 sc1 lds
  buffer_load_dwordx4 v1, s[12:15], s35 offen offset:2048 sc1 lds
  buffer_load_dwordx4 v1, s[12:15], s35 offen offset:3072 sc1 lds
  s_add_u32 m0, s34, 73728
  s_add_u32 s35, s22, s42
  s_add_u32 s35, s35, 0
  buffer_load_dwordx4 v1, s[12:15], s35 offen offset:0 sc1 lds
  buffer_load_dwordx4 v1, s[12:15], s35 offen offset:1024 sc1 lds
  buffer_load_dwordx4 v1, s[12:15], s35 offen offset:2048 sc1 lds
  buffer_load_dwordx4 v1, s[12:15], s35 offen offset:3072 sc1 lds
  s_add_u32 m0, s34, 77824
  s_add_u32 s35, s22, s42
  s_add_u32 s35, s35, 4096
  buffer_load_dwordx4 v1, s[12:15], s35 offen offset:0 sc1 lds
  buffer_load_dwordx4 v1, s[12:15], s35 offen offset:1024 sc1 lds
  buffer_load_dwordx4 v1, s[12:15], s35 offen offset:2048 sc1 lds
  buffer_load_dwordx4 v1, s[12:15], s35 offen offset:3072 sc1 lds
  s_add_u32 m0, s34, 81920
  s_add_u32 s35, s22, s42
  s_add_u32 s35, s35, 8192
  buffer_load_dwordx4 v1, s[12:15], s35 offen offset:0 sc1 lds
  buffer_load_dwordx4 v1, s[12:15], s35 offen offset:1024 sc1 lds
  buffer_load_dwordx4 v1, s[12:15], s35 offen offset:2048 sc1 lds
  buffer_load_dwordx4 v1, s[12:15], s35 offen offset:3072 sc1 lds
Lse_ch2:
  s_lshr_b32 s23, s16, 1
  s_lshl_b32 s24, s23, 14
  v_add_u32 v5, s24, v5
  s_lshl_b32 s24, s23, 11
  v_add_u32 v8, s24, v8
  s_lshl_b32 s24, s16, 11
  v_add_u32 v11, s24, v10
  s_setprio 1
  ds_read_b128 v[64:67], v5 offset:0
  ds_read_b128 v[68:71], v5 offset:1024
  ds_read_b128 v[72:75], v5 offset:2048
  ds_read_b128 v[76:79], v5 offset:3072
  ds_read_b128 v[80:83], v5 offset:4096
  ds_read_b128 v[84:87], v5 offset:5120
  ds_read_b128 v[88:91], v5 offset:6144
  ds_read_b128 v[92:95], v5 offset:7168
  ds_read_b128 v[96:99], v5 offset:8192
  ds_read_b128 v[100:103], v5 offset:9216
  ds_read_b128 v[104:107], v5 offset:10240
  ds_read_b128 v[108:111], v5 offset:11264
  s_waitcnt lgkmcnt(8)
  ds_read_b128 v[112:115], v5 offset:12288
  ds_read_b128 v[116:119], v5 offset:13312
  ds_read_b128 v[120:123], v5 offset:14336
  ds_read_b128 v[124:127], v5 offset:15360
  ds_read2_b32 v[128:129], v8 offset0:0 offset1:32
  ds_read2_b32 v[130:131], v8 offset0:64 offset1:96
  ds_read2_b32 v[132:133], v8 offset0:16 offset1:48
  ds_read2_b32 v[134:135], v8 offset0:80 offset1:112
  s_waitcnt lgkmcnt(15)
  v_mfma_f32_16x16x32_bf16 v[16:19], v[160:163], v[64:67], 0
  v_mfma_f32_16x16x32_bf16 v[20:23], v[160:163], v[68:71], 0
  s_waitcnt lgkmcnt(15)
  v_mfma_f32_16x16x32_bf16 v[16:19], v[164:167], v[72:75], v[16:19]
  v_mfma_f32_16x16x32_bf16 v[20:23], v[164:167], v[76:79], v[20:23]
  s_waitcnt lgkmcnt(14)
  v_mfma_f32_16x16x32_bf16 v[16:19], v[168:171], v[80:83], v[16:19]
  v_mfma_f32_16x16x32_bf16 v[20:23], v[168:171], v[84:87], v[20:23]
  s_waitcnt lgkmcnt(12)
  v_mfma_f32_16x16x32_bf16 v[16:19], v[172:175], v[88:91], v[16:19]
  v_mfma_f32_16x16x32_bf16 v[20:23], v[172:175], v[92:95], v[20:23]
  s_waitcnt lgkmcnt(10)
  v_mfma_f32_16x16x32_bf16 v[16:19], v[176:179], v[96:99], v[16:19]
  v_mfma_f32_16x16x32_bf16 v[20:23], v[176:179], v[100:103], v[20:23]
  s_waitcnt lgkmcnt(8)
  v_mfma_f32_16x16x32_bf16 v[16:19], v[180:183], v[104:107], v[16:19]
  v_mfma_f32_16x16x32_bf16 v[20:23], v[180:183], v[108:111], v[20:23]
  s_waitcnt lgkmcnt(6)
  v_mfma_f32_16x16x32_bf16 v[16:19], v[184:187], v[112:115], v[16:19]
  v_mfma_f32_16x16x32_bf16 v[20:23], v[184:187], v[116:119], v[20:23]
  s_waitcnt lgkmcnt(4)
  v_mfma_f32_16x16x32_bf16 v[16:19], v[188:191], v[120:123], v[16:19]
  v_mfma_f32_16x16x32_bf16 v[20:23], v[188:191], v[124:127], v[20:23]
  s_waitcnt lgkmcnt(0)
  v_mfma_f32_16x16x32_bf16 v[16:19], v[192:195], v[128:131], v[16:19]
  v_mfma_f32_16x16x32_bf16 v[20:23], v[192:195], v[132:135], v[20:23]
  s_setprio 0
  s_mov_b32 s3, 1073741824
  s_cmp_eq_u32 s16, 0
  s_cbranch_scc1 Lse_cepi
  s_nop 3
  ds_write_b128 v11, v[16:19]
  ds_write_b128 v11, v[20:23] offset:1024
  s_waitcnt lgkmcnt(0)
  s_barrier
Lse_dstart:
  s_lshl_b32 s3, s38, 2
  s_add_u32 s3, s3, s39
  s_mul_i32 s3, s3, 128
  s_add_u32 s3, s3, 54788096
  s_cmp_lg_u32 s16, 2
  s_cselect_b32 s3, 1073741824, s3
  s_lshl_b32 s11, s8, 3
  s_add_u32 s11, s11, s16
  s_lshl_b32 s21, s11, 9
  s_add_u32 s20, s21, 11534336
  s_mul_i32 s22, s43, 786432
  s_add_u32 s20, s20, s22
  s_mov_b32 s34, 131072
  s_mov_b32 s35, 131072
  s_cmp_eq_u32 s43, 2
  s_cselect_b32 s34, 4292739072, s34
  s_cmp_eq_u32 s43, 1
  s_cselect_b32 s35, 4292739072, s35
  s_mul_i32 s43, s43, 12288
  s_lshr_b32 s22, s9, 3
  s_mul_i32 s22, s22, 4718592
  s_add_u32 s21, s21, s22
  s_and_b32 s22, s9, 7
  s_mul_i32 s22, s22, 196608
  s_add_u32 s21, s21, s22
  s_add_u32 s21, s21, 35651584
  s_and_b32 s17, s2, 1
  s_lshl_b32 s17, s17, 3
  s_bfe_u32 s18, s2, 0x30003
  s_add_u32 s17, s17, s18
  s_lshr_b32 s18, s2, 6
  s_bfe_u32 s19, s2, 0x20001
  s_add_u32 s28, s16, 0
  s_lshl_b32 s44, s28, 10
  s_add_u32 s54, s44, s43
  s_cmp_ge_u32 s54, 36864
  s_cselect_b32 s29, 36864, 0
  s_sub_u32 s54, s54, s29
  s_mul_i32 s29, s28, 7282
  s_lshr_b32 s29, s29, 16
  s_mul_i32 s30, s29, 9
  s_sub_u32 s28, s28, s30
  s_add_u32 s30, s28, s19
  s_and_b32 s30, s30, 3
  s_and_b32 s31, s28, 4
  s_or_b32 s30, s30, s31
  s_cmp_eq_u32 s28, 8
  s_cselect_b32 s30, 8, s30
  s_lshl_b32 s30, s30, 10
  s_mul_i32 s29, s29, 36864
  s_add_u32 s38, s29, s30
  s_add_u32 s28, s16, 8
  s_lshl_b32 s45, s28, 10
  s_add_u32 s55, s45, s43
  s_cmp_ge_u32 s55, 36864
  s_cselect_b32 s29, 36864, 0
  s_sub_u32 s55, s55, s29
  s_mul_i32 s29, s28, 7282
  s_lshr_b32 s29, s29, 16
  s_mul_i32 s30, s29, 9
  s_sub_u32 s28, s28, s30
  s_add_u32 s30, s28, s19
  s_and_b32 s30, s30, 3
  s_and_b32 s31, s28, 4
  s_or_b32 s30, s30, s31
  s_cmp_eq_u32 s28, 8
  s_cselect_b32 s30, 8, s30
  s_lshl_b32 s30, s30, 10
  s_mul_i32 s29, s29, 36864
  s_add_u32 s39, s29, s30
  s_add_u32 s28, s16, 16
  s_lshl_b32 s46, s28, 10
  s_add_u32 s56, s46, s43
  s_cmp_ge_u32 s56, 36864
  s_cselect_b32 s29, 36864, 0
  s_sub_u32 s56, s56, s29
  s_mul_i32 s29, s28, 7282
  s_lshr_b32 s29, s29, 16
  s_mul_i32 s30, s29, 9
  s_sub_u32 s28, s28, s30
  s_add_u32 s30, s28, s19
  s_and_b32 s30, s30, 3
  s_and_b32 s31, s28, 4
  s_or_b32 s30, s30, s31
  s_cmp_eq_u32 s28, 8
  s_cselect_b32 s30, 8, s30
  s_lshl_b32 s30, s30, 10
  s_mul_i32 s29, s29, 36864
  s_add_u32 s40, s29, s30
  s_add_u32 s28, s16, 24
  s_lshl_b32 s47, s28, 10
  s_add_u32 s57, s47, s43
  s_cmp_ge_u32 s57, 36864
  s_cselect_b32 s29, 36864, 0
  s_sub_u32 s57, s57, s29
  s_mul_i32 s29, s28, 7282
  s_lshr_b32 s29, s29, 16
  s_mul_i32 s30, s29, 9
  s_sub_u32 s28, s28, s30
  s_add_u32 s30, s28, s19
  s_and_b32 s30, s30, 3
  s_and_b32 s31, s28, 4
  s_or_b32 s30, s30, s31
  s_cmp_eq_u32 s28, 8
  s_cselect_b32 s30, 8, s30
  s_lshl_b32 s30, s30, 10
  s_mul_i32 s29, s29, 36864
  s_add_u32 s41, s29, s30
  s_add_u32 s28, s16, 32
  s_add_u32 s29, s16, 24
  s_cmp_ge_u32 s28, 36
  s_cselect_b32 s28, s29, s28
  s_lshl_b32 s48, s28, 10
  s_add_u32 s58, s48, s43
  s_cmp_ge_u32 s58, 36864
  s_cselect_b32 s29, 36864, 0
  s_sub_u32 s58, s58, s29
  s_mul_i32 s29, s28, 7282
  s_lshr_b32 s29, s29, 16
  s_mul_i32 s30, s29, 9
  s_sub_u32 s28, s28, s30
  s_add_u32 s30, s28, s19
  s_and_b32 s30, s30, 3
  s_and_b32 s31, s28, 4
  s_or_b32 s30, s30, s31
  s_cmp_eq_u32 s28, 8
  s_cselect_b32 s30, 8, s30
  s_lshl_b32 s30, s30, 10
  s_mul_i32 s29, s29, 36864
  s_add_u32 s42, s29, s30
  s_add_u32 s51, s10, 110592
  s_mov_b32 s50, 36864
  s_mov_b32 s24, 110592
  s_mul_i32 s53, s19, 1327104
  s_mul_i32 s29, s18, 9216
  s_add_u32 s53, s53, s29
  s_add_u32 s53, s53, 29360128
  v_lshrrev_b32 v3, 5, v0
  v_lshlrev_b32 v3, 15, v3
  v_and_b32 v5, 31, v0
  v_lshl_add_u32 v3, v5, 4, v3
  v_mov_b32 v5, v1
  v_add_u32 v6, 36864, v1
  s_mov_b32 s26, 36864
  v_and_b32 v7, 3, v0
  v_mul_u32_u24 v7, 128, v7
  s_mul_i32 s61, s11, 512
  s_add_u32 s61, s61, 54788096
  s_lshl_b32 s28, s17, 2
  s_and_b32 s29, s16, 3
  s_add_u32 s28, s28, s29
  s_mul_i32 s52, s28, 36
  s_mul_i32 s29, s18, 9
  s_add_u32 s52, s52, s29
  s_mul_i32 s52, s52, 3072
  s_add_u32 s62, s52, 56623104
  s_and_b32 s29, s16, 4
  s_add_u32 s29, s29, s19
  s_mul_i32 s29, s29, 3072
  s_add_u32 s52, s62, s29
  s_add_u32 s63, s62, 24576
  s_cmp_eq_u32 s16, s19
  s_cselect_b32 s63, s63, 1073741824
  s_mov_b32 s27, 0
  s_lshl_b32 s30, s11, 5
  s_add_u32 s30, s30, s9
  s_mul_i32 s30, s30, 128
  s_add_u32 s30, s30, 55050240
  s_lshl_b32 s31, s2, 3
  s_add_u32 s31, s31, s16
  s_mul_i32 s31, s31, 128
  s_add_u32 s31, s31, 55836672
  s_lshl_b32 s32, s28, 2
  s_add_u32 s32, s32, s19
  s_mul_i32 s32, s32, 1024
  s_add_u32 s32, s32, 55050240
  v_and_b32 v2, 7, v0
  v_mul_u32_u24 v2, 128, v2
  s_sub_u32 s22, s16, 1
  s_cmp_lt_u32 s22, 3
  s_cbranch_scc1 Lse_z0
  s_waitcnt vmcnt(0)
Lse_z0:
  s_barrier
  v_mov_b32 v12, 1
  v_mov_b32 v13, s1
  v_add_u32 v12, s0, v12
  v_lshlrev_b32 v14, 3, v0
  s_mov_b64 exec, 65535
  buffer_store_dwordx2 v[12:13], v14, s[12:15], s3 offen sc1
  s_mov_b64 exec, -1
  ds_read_b128 v[64:67], v5 offset:0
  ds_read_b128 v[68:71], v5 offset:1024
  ds_read_b128 v[72:75], v5 offset:12288
  ds_read_b128 v[76:79], v5 offset:13312
  ds_read_b128 v[80:83], v5 offset:24576
  v_mov_b32 v8, -1
  v_mov_b32 v9, -1
  v_mov_b32 v10, -1
  v_mov_b32 v11, -1
  s_sleep 12
  s_mov_b32 s60, 0
Lse_pc:
  buffer_load_dwordx2 v[12:13], v7, s[12:15], s61 offen sc1
  s_add_u32 s60, s60, 1
  s_waitcnt vmcnt(0)
  v_subrev_u32 v12, s0, v12
  v_xor_b32 v13, s1, v13
  v_subrev_u32 v12, 1, v12
  v_and_or_b32 v12, v12, -4, v13
  v_cmp_ne_u32 vcc, 0, v12
  s_cmp_ge_u32 s60, 400000
  s_cbranch_scc1 Lse_pcx
  s_cbranch_vccz Lse_pcx
  s_sleep 2
  s_branch Lse_pc
Lse_pcx:
  buffer_load_dwordx4 v[112:115], v4, s[12:15], s20 offen offset:0 sc1
  buffer_load_dwordx4 v[116:119], v4, s[12:15], s20 offen offset:256 sc1
  s_add_u32 s20, s20, 131072
  buffer_load_dwordx4 v[120:123], v4, s[12:15], s20 offen offset:0 sc1
  buffer_load_dwordx4 v[124:127], v4, s[12:15], s20 offen offset:256 sc1
  s_add_u32 s20, s20, 131072
  buffer_load_dwordx4 v[128:131], v4, s[12:15], s20 offen offset:0 sc1
  buffer_load_dwordx4 v[132:135], v4, s[12:15], s20 offen offset:256 sc1
  s_add_u32 s20, s20, 131072
  buffer_load_dwordx4 v[136:139], v4, s[12:15], s20 offen offset:0 sc1
  buffer_load_dwordx4 v[140:143], v4, s[12:15], s20 offen offset:256 sc1
  s_add_u32 s20, s20, 131072
  s_waitcnt vmcnt(6) lgkmcnt(3)
  v_mfma_f32_16x16x32_bf16 v[16:19], v[64:67], v[112:115], 0
  ds_read_b128 v[84:87], v5 offset:25600
  v_mfma_f32_16x16x32_bf16 v[20:23], v[64:67], v[116:119], 0
  buffer_load_dwordx4 v[144:147], v4, s[12:15], s20 offen offset:0 sc1
  v_mfma_f32_16x16x32_bf16 v[24:27], v[68:71], v[112:115], 0
  ds_read_b128 v[64:67], v5 offset:2048
  v_mfma_f32_16x16x32_bf16 v[28:31], v[68:71], v[116:119], 0
  buffer_load_dwordx4 v[148:151], v4, s[12:15], s20 offen offset:256 sc1
  s_waitcnt lgkmcnt(3)
  v_mfma_f32_16x16x32_bf16 v[32:35], v[72:75], v[112:115], 0
  ds_read_b128 v[68:71], v5 offset:3072
  v_mfma_f32_16x16x32_bf16 v[36:39], v[72:75], v[116:119], 0
  s_add_u32 s20, s20, 131072
  v_mfma_f32_16x16x32_bf16 v[40:43], v[76:79], v[112:115], 0
  ds_read_b128 v[72:75], v5 offset:14336
  v_mfma_f32_16x16x32_bf16 v[44:47], v[76:79], v[116:119], 0
  s_add_u32 s26, s26, 36864
  s_cmp_ge_u32 s26, 147456
  s_cselect_b32 s26, 0, s26
  s_waitcnt lgkmcnt(3)
  v_mfma_f32_16x16x32_bf16 v[48:51], v[80:83], v[112:115], 0
  ds_read_b128 v[76:79], v5 offset:15360
  v_mfma_f32_16x16x32_bf16 v[52:55], v[80:83], v[116:119], 0
  v_mfma_f32_16x16x32_bf16 v[56:59], v[84:87], v[112:115], 0
  ds_read_b128 v[80:83], v5 offset:26624
  v_mfma_f32_16x16x32_bf16 v[60:63], v[84:87], v[116:119], 0
  s_waitcnt vmcnt(6) lgkmcnt(3)
  v_mfma_f32_16x16x32_bf16 v[16:19], v[64:67], v[120:123], v[16:19]
  ds_read_b128 v[84:87], v5 offset:27648
  v_mfma_f32_16x16x32_bf16 v[20:23], v[64:67], v[124:127], v[20:23]
  buffer_load_dwordx4 v[152:155], v4, s[12:15], s20 offen offset:0 sc1
  v_mfma_f32_16x16x32_bf16 v[24:27], v[68:71], v[120:123], v[24:27]
  ds_read_b128 v[64:67], v5 offset:4096
  v_mfma_f32_16x16x32_bf16 v[28:31], v[68:71], v[124:127], v[28:31]
  buffer_load_dwordx4 v[156:159], v4, s[12:15], s20 offen offset:256 sc1
  s_waitcnt lgkmcnt(3)
  v_mfma_f32_16x16x32_bf16 v[32:35], v[72:75], v[120:123], v[32:35]
  ds_read_b128 v[68:71], v5 offset:5120
  v_mfma_f32_16x16x32_bf16 v[36:39], v[72:75], v[124:127], v[36:39]
  s_add_u32 s20, s20, s34
  v_mfma_f32_16x16x32_bf16 v[40:43], v[76:79], v[120:123], v[40:43]
  ds_read_b128 v[72:75], v5 offset:16384
  v_mfma_f32_16x16x32_bf16 v[44:47], v[76:79], v[124:127], v[44:47]
  s_waitcnt lgkmcnt(3)
  v_mfma_f32_16x16x32_bf16 v[48:51], v[80:83], v[120:123], v[48:51]
  ds_read_b128 v[76:79], v5 offset:17408
  v_mfma_f32_16x16x32_bf16 v[52:55], v[80:83], v[124:127], v[52:55]
  v_mfma_f32_16x16x32_bf16 v[56:59], v[84:87], v[120:123], v[56:59]
  ds_read_b128 v[80:83], v5 offset:28672
  v_mfma_f32_16x16x32_bf16 v[60:63], v[84:87], v[124:127], v[60:63]
  s_waitcnt vmcnt(6) lgkmcnt(3)
  v_mfma_f32_16x16x32_bf16 v[16:19], v[64:67], v[128:131], v[16:19]
  ds_read_b128 v[84:87], v5 offset:29696
  v_mfma_f32_16x16x32_bf16 v[20:23], v[64:67], v[132:135], v[20:23]
  buffer_load_dwordx4 v[160:163], v4, s[12:15], s20 offen offset:0 sc1
  v_mfma_f32_16x16x32_bf16 v[24:27], v[68:71], v[128:131], v[24:27]
  ds_read_b128 v[64:67], v5 offset:6144
  v_mfma_f32_16x16x32_bf16 v[28:31], v[68:71], v[132:135], v[28:31]
  buffer_load_dwordx4 v[164:167], v4, s[12:15], s20 offen offset:256 sc1
  s_waitcnt lgkmcnt(3)
  v_mfma_f32_16x16x32_bf16 v[32:35], v[72:75], v[128:131], v[32:35]
  ds_read_b128 v[68:71], v5 offset:7168
  v_mfma_f32_16x16x32_bf16 v[36:39], v[72:75], v[132:135], v[36:39]
  s_add_u32 s20, s20, 131072
  v_mfma_f32_16x16x32_bf16 v[40:43], v[76:79], v[128:131], v[40:43]
  ds_read_b128 v[72:75], v5 offset:18432
  v_mfma_f32_16x16x32_bf16 v[44:47], v[76:79], v[132:135], v[44:47]
  s_waitcnt lgkmcnt(3)
  v_mfma_f32_16x16x32_bf16 v[48:51], v[80:83], v[128:131], v[48:51]
  ds_read_b128 v[76:79], v5 offset:19456
  v_mfma_f32_16x16x32_bf16 v[52:55], v[80:83], v[132:135], v[52:55]
  v_mfma_f32_16x16x32_bf16 v[56:59], v[84:87], v[128:131], v[56:59]
  ds_read_b128 v[80:83], v5 offset:30720
  v_mfma_f32_16x16x32_bf16 v[60:63], v[84:87], v[132:135], v[60:63]
  s_waitcnt vmcnt(6) lgkmcnt(3)
  v_mfma_f32_16x16x32_bf16 v[16:19], v[64:67], v[136:139], v[16:19]
  ds_read_b128 v[84:87], v5 offset:31744
  v_mfma_f32_16x16x32_bf16 v[20:23], v[64:67], v[140:143], v[20:23]
  buffer_load_dwordx4 v[168:171], v4, s[12:15], s20 offen offset:0 sc1
  v_mfma_f32_16x16x32_bf16 v[24:27], v[68:71], v[136:139], v[24:27]
  ds_read_b128 v[64:67], v5 offset:8192
  v_mfma_f32_16x16x32_bf16 v[28:31], v[68:71], v[140:143], v[28:31]
  buffer_load_dwordx4 v[172:175], v4, s[12:15], s20 offen offset:256 sc1
  s_waitcnt lgkmcnt(3)
  v_mfma_f32_16x16x32_bf16 v[32:35], v[72:75], v[136:139], v[32:35]
  ds_read_b128 v[68:71], v5 offset:9216
  v_mfma_f32_16x16x32_bf16 v[36:39], v[72:75], v[140:143], v[36:39]
  s_add_u32 s20, s20, 131072
  v_mfma_f32_16x16x32_bf16 v[40:43], v[76:79], v[136:139], v[40:43]
  ds_read_b128 v[72:75], v5 offset:20480
  v_mfma_f32_16x16x32_bf16 v[44:47], v[76:79], v[140:143], v[44:47]
  s_waitcnt lgkmcnt(3)
  v_mfma_f32_16x16x32_bf16 v[48:51], v[80:83], v[136:139], v[48:51]
  ds_read_b128 v[76:79], v5 offset:21504
  v_mfma_f32_16x16x32_bf16 v[52:55], v[80:83], v[140:143], v[52:55]
  v_mfma_f32_16x16x32_bf16 v[56:59], v[84:87], v[136:139], v[56:59]
  ds_read_b128 v[80:83], v5 offset:32768
  v_mfma_f32_16x16x32_bf16 v[60:63], v[84:87], v[140:143], v[60:63]
  s_waitcnt vmcnt(6) lgkmcnt(3)
  v_mfma_f32_16x16x32_bf16 v[16:19], v[64:67], v[144:147], v[16:19]
  ds_read_b128 v[84:87], v5 offset:33792
  v_mfma_f32_16x16x32_bf16 v[20:23], v[64:67], v[148:151], v[20:23]
  buffer_load_dwordx4 v[176:179], v4, s[12:15], s20 offen offset:0 sc1
  v_mfma_f32_16x16x32_bf16 v[24:27], v[68:71], v[144:147], v[24:27]
  ds_read_b128 v[64:67], v5 offset:10240
  v_mfma_f32_16x16x32_bf16 v[28:31], v[68:71], v[148:151], v[28:31]
  buffer_load_dwordx4 v[180:183], v4, s[12:15], s20 offen offset:256 sc1
  s_waitcnt lgkmcnt(3)
  v_mfma_f32_16x16x32_bf16 v[32:35], v[72:75], v[144:147], v[32:35]
  ds_read_b128 v[68:71], v5 offset:11264
  v_mfma_f32_16x16x32_bf16 v[36:39], v[72:75], v[148:151], v[36:39]
  s_add_u32 s20, s20, 131072
  v_mfma_f32_16x16x32_bf16 v[40:43], v[76:79], v[144:147], v[40:43]
  ds_read_b128 v[72:75], v5 offset:22528
  v_mfma_f32_16x16x32_bf16 v[44:47], v[76:79], v[148:151], v[44:47]
  s_waitcnt lgkmcnt(3)
  v_mfma_f32_16x16x32_bf16 v[48:51], v[80:83], v[144:147], v[48:51]
  ds_read_b128 v[76:79], v5 offset:23552
  v_mfma_f32_16x16x32_bf16 v[52:55], v[80:83], v[148:151], v[52:55]
  v_mfma_f32_16x16x32_bf16 v[56:59], v[84:87], v[144:147], v[56:59]
  ds_read_b128 v[80:83], v5 offset:34816
  v_mfma_f32_16x16x32_bf16 v[60:63], v[84:87], v[148:151], v[60:63]
  s_waitcnt vmcnt(6) lgkmcnt(3)
  s_barrier
  v_mfma_f32_16x16x32_bf16 v[16:19], v[64:67], v[152:155], v[16:19]
  ds_read_b128 v[84:87], v5 offset:35840
  v_mfma_f32_16x16x32_bf16 v[20:23], v[64:67], v[156:159], v[20:23]
  buffer_load_dwordx4 v[184:187], v4, s[12:15], s20 offen offset:0 sc1
  v_mfma_f32_16x16x32_bf16 v[24:27], v[68:71], v[152:155], v[24:27]
  ds_read_b128 v[64:67], v6 offset:0
  v_mfma_f32_16x16x32_bf16 v[28:31], v[68:71], v[156:159], v[28:31]
  buffer_load_dwordx4 v[188:191], v4, s[12:15], s20 offen offset:256 sc1
  s_waitcnt lgkmcnt(3)
  v_mfma_f32_16x16x32_bf16 v[32:35], v[72:75], v[152:155], v[32:35]
  ds_read_b128 v[68:71], v6 offset:1024
  v_mfma_f32_16x16x32_bf16 v[36:39], v[72:75], v[156:159], v[36:39]
  s_add_u32 s20, s20, 131072
  v_mfma_f32_16x16x32_bf16 v[40:43], v[76:79], v[152:155], v[40:43]
  ds_read_b128 v[72:75], v6 offset:12288
  v_mfma_f32_16x16x32_bf16 v[44:47], v[76:79], v[156:159], v[44:47]
  s_waitcnt lgkmcnt(3)
  v_mfma_f32_16x16x32_bf16 v[48:51], v[80:83], v[152:155], v[48:51]
  ds_read_b128 v[76:79], v6 offset:13312
  v_mfma_f32_16x16x32_bf16 v[52:55], v[80:83], v[156:159], v[52:55]
  v_mfma_f32_16x16x32_bf16 v[56:59], v[84:87], v[152:155], v[56:59]
  ds_read_b128 v[80:83], v6 offset:24576
  v_mfma_f32_16x16x32_bf16 v[60:63], v[84:87], v[156:159], v[60:63]
  v_mov_b32 v5, v6
  v_add_u32 v6, s26, v1
  s_waitcnt vmcnt(6) lgkmcnt(3)
  v_mfma_f32_16x16x32_bf16 v[16:19], v[64:67], v[160:163], v[16:19]
  ds_read_b128 v[84:87], v5 offset:25600
  v_mfma_f32_16x16x32_bf16 v[20:23], v[64:67], v[164:167], v[20:23]
  buffer_load_dwordx4 v[192:195], v4, s[12:15], s20 offen offset:0 sc1
  v_mfma_f32_16x16x32_bf16 v[24:27], v[68:71], v[160:163], v[24:27]
  ds_read_b128 v[64:67], v5 offset:2048
  v_mfma_f32_16x16x32_bf16 v[28:31], v[68:71], v[164:167], v[28:31]
  buffer_load_dwordx4 v[196:199], v4, s[12:15], s20 offen offset:256 sc1
  s_waitcnt lgkmcnt(3)
  v_mfma_f32_16x16x32_bf16 v[32:35], v[72:75], v[160:163], v[32:35]
  ds_read_b128 v[68:71], v5 offset:3072
  v_mfma_f32_16x16x32_bf16 v[36:39], v[72:75], v[164:167], v[36:39]
  s_add_u32 s20, s20, 131072
  v_mfma_f32_16x16x32_bf16 v[40:43], v[76:79], v[160:163], v[40:43]
  ds_read_b128 v[72:75], v5 offset:14336
  v_mfma_f32_16x16x32_bf16 v[44:47], v[76:79], v[164:167], v[44:47]
  s_waitcnt lgkmcnt(3)
  v_mfma_f32_16x16x32_bf16 v[48:51], v[80:83], v[160:163], v[48:51]
  ds_read_b128 v[76:79], v5 offset:15360
  v_mfma_f32_16x16x32_bf16 v[52:55], v[80:83], v[164:167], v[52:55]
  s_cmp_ge_u32 s16, 4
  s_cbranch_scc1 Lse_nd1
  s_add_u32 m0, s24, s48
  s_add_u32 s22, s51, s58
  buffer_load_dwordx4 v1, s[12:15], s22 offen sc1 lds
Lse_nd1:
  v_mfma_f32_16x16x32_bf16 v[56:59], v[84:87], v[160:163], v[56:59]
  ds_read_b128 v[80:83], v5 offset:26624
  v_mfma_f32_16x16x32_bf16 v[60:63], v[84:87], v[164:167], v[60:63]
  s_waitcnt vmcnt(6) lgkmcnt(3)
  v_mfma_f32_16x16x32_bf16 v[16:19], v[64:67], v[168:171], v[16:19]
  ds_read_b128 v[84:87], v5 offset:27648
  v_mfma_f32_16x16x32_bf16 v[20:23], v[64:67], v[172:175], v[20:23]
  buffer_load_dwordx4 v[200:203], v4, s[12:15], s20 offen offset:0 sc1
  v_mfma_f32_16x16x32_bf16 v[24:27], v[68:71], v[168:171], v[24:27]
  ds_read_b128 v[64:67], v5 offset:4096
  v_mfma_f32_16x16x32_bf16 v[28:31], v[68:71], v[172:175], v[28:31]
  buffer_load_dwordx4 v[204:207], v4, s[12:15], s20 offen offset:256 sc1
  s_waitcnt lgkmcnt(3)
  v_mfma_f32_16x16x32_bf16 v[32:35], v[72:75], v[168:171], v[32:35]
  ds_read_b128 v[68:71], v5 offset:5120
  v_mfma_f32_16x16x32_bf16 v[36:39], v[72:75], v[172:175], v[36:39]
  s_add_u32 s20, s20, s35
  v_mfma_f32_16x16x32_bf16 v[40:43], v[76:79], v[168:171], v[40:43]
  ds_read_b128 v[72:75], v5 offset:16384
  v_mfma_f32_16x16x32_bf16 v[44:47], v[76:79], v[172:175], v[44:47]
  s_add_u32 m0, s24, s44
  s_add_u32 s22, s51, s54
  buffer_load_dwordx4 v1, s[12:15], s22 offen sc1 lds
  s_waitcnt lgkmcnt(3)
  v_mfma_f32_16x16x32_bf16 v[48:51], v[80:83], v[168:171], v[48:51]
  ds_read_b128 v[76:79], v5 offset:17408
  v_mfma_f32_16x16x32_bf16 v[52:55], v[80:83], v[172:175], v[52:55]
  v_mfma_f32_16x16x32_bf16 v[56:59], v[84:87], v[168:171], v[56:59]
  ds_read_b128 v[80:83], v5 offset:28672
  v_mfma_f32_16x16x32_bf16 v[60:63], v[84:87], v[172:175], v[60:63]
  s_waitcnt vmcnt(7) lgkmcnt(3)
  v_mfma_f32_16x16x32_bf16 v[16:19], v[64:67], v[176:179], v[16:19]
  ds_read_b128 v[84:87], v5 offset:29696
  v_mfma_f32_16x16x32_bf16 v[20:23], v[64:67], v[180:183], v[20:23]
  buffer_load_dwordx4 v[208:211], v4, s[12:15], s20 offen offset:0 sc1
  v_mfma_f32_16x16x32_bf16 v[24:27], v[68:71], v[176:179], v[24:27]
  ds_read_b128 v[64:67], v5 offset:6144
  v_mfma_f32_16x16x32_bf16 v[28:31], v[68:71], v[180:183], v[28:31]
  buffer_load_dwordx4 v[212:215], v4, s[12:15], s20 offen offset:256 sc1
  s_waitcnt lgkmcnt(3)
  v_mfma_f32_16x16x32_bf16 v[32:35], v[72:75], v[176:179], v[32:35]
  ds_read_b128 v[68:71], v5 offset:7168
  v_mfma_f32_16x16x32_bf16 v[36:39], v[72:75], v[180:183], v[36:39]
  s_add_u32 m0, s24, s45
  s_add_u32 s22, s51, s55
  buffer_load_dwordx4 v1, s[12:15], s22 offen sc1 lds
  v_mfma_f32_16x16x32_bf16 v[40:43], v[76:79], v[176:179], v[40:43]
  ds_read_b128 v[72:75], v5 offset:18432
  v_mfma_f32_16x16x32_bf16 v[44:47], v[76:79], v[180:183], v[44:47]
  s_add_u32 s20, s20, 131072
  s_waitcnt lgkmcnt(3)
  v_mfma_f32_16x16x32_bf16 v[48:51], v[80:83], v[176:179], v[48:51]
  ds_read_b128 v[76:79], v5 offset:19456
  v_mfma_f32_16x16x32_bf16 v[52:55], v[80:83], v[180:183], v[52:55]
  v_mfma_f32_16x16x32_bf16 v[56:59], v[84:87], v[176:179], v[56:59]
  ds_read_b128 v[80:83], v5 offset:30720
  v_mfma_f32_16x16x32_bf16 v[60:63], v[84:87], v[180:183], v[60:63]
  s_waitcnt vmcnt(8) lgkmcnt(3)
  v_mfma_f32_16x16x32_bf16 v[16:19], v[64:67], v[184:187], v[16:19]
  ds_read_b128 v[84:87], v5 offset:31744
  v_mfma_f32_16x16x32_bf16 v[20:23], v[64:67], v[188:191], v[20:23]
  buffer_load_dwordx4 v[216:219], v4, s[12:15], s20 offen offset:0 sc1
  v_mfma_f32_16x16x32_bf16 v[24:27], v[68:71], v[184:187], v[24:27]
  ds_read_b128 v[64:67], v5 offset:8192
  v_mfma_f32_16x16x32_bf16 v[28:31], v[68:71], v[188:191], v[28:31]
  s_add_u32 m0, s24, s46
  s_add_u32 s22, s51, s56
  buffer_load_dwordx4 v1, s[12:15], s22 offen sc1 lds
  s_waitcnt lgkmcnt(3)
  v_mfma_f32_16x16x32_bf16 v[32:35], v[72:75], v[184:187], v[32:35]
  ds_read_b128 v[68:71], v5 offset:9216
  v_mfma_f32_16x16x32_bf16 v[36:39], v[72:75], v[188:191], v[36:39]
  buffer_load_dwordx4 v[220:223], v4, s[12:15], s20 offen offset:256 sc1
  v_mfma_f32_16x16x32_bf16 v[40:43], v[76:79], v[184:187], v[40:43]
  ds_read_b128 v[72:75], v5 offset:20480
  v_mfma_f32_16x16x32_bf16 v[44:47], v[76:79], v[188:191], v[44:47]
  s_add_u32 s20, s20, 131072
  s_waitcnt lgkmcnt(3)
  v_mfma_f32_16x16x32_bf16 v[48:51], v[80:83], v[184:187], v[48:51]
  ds_read_b128 v[76:79], v5 offset:21504
  v_mfma_f32_16x16x32_bf16 v[52:55], v[80:83], v[188:191], v[52:55]
  v_mfma_f32_16x16x32_bf16 v[56:59], v[84:87], v[184:187], v[56:59]
  ds_read_b128 v[80:83], v5 offset:32768
  v_mfma_f32_16x16x32_bf16 v[60:63], v[84:87], v[188:191], v[60:63]
  s_waitcnt vmcnt(9) lgkmcnt(3)
  v_mfma_f32_16x16x32_bf16 v[16:19], v[64:67], v[192:195], v[16:19]
  ds_read_b128 v[84:87], v5 offset:33792
  v_mfma_f32_16x16x32_bf16 v[20:23], v[64:67], v[196:199], v[20:23]
  s_add_u32 m0, s24, s47
  s_add_u32 s22, s51, s57
  buffer_load_dwordx4 v1, s[12:15], s22 offen sc1 lds
  v_mfma_f32_16x16x32_bf16 v[24:27], v[68:71], v[192:195], v[24:27]
  ds_read_b128 v[64:67], v5 offset:10240
  v_mfma_f32_16x16x32_bf16 v[28:31], v[68:71], v[196:199], v[28:31]
  buffer_load_dwordx4 v[224:227], v4, s[12:15], s20 offen offset:0 sc1
  s_waitcnt lgkmcnt(3)
  v_mfma_f32_16x16x32_bf16 v[32:35], v[72:75], v[192:195], v[32:35]
  ds_read_b128 v[68:71], v5 offset:11264
  v_mfma_f32_16x16x32_bf16 v[36:39], v[72:75], v[196:199], v[36:39]
  buffer_load_dwordx4 v[228:231], v4, s[12:15], s20 offen offset:256 sc1
  v_mfma_f32_16x16x32_bf16 v[40:43], v[76:79], v[192:195], v[40:43]
  ds_read_b128 v[72:75], v5 offset:22528
  v_mfma_f32_16x16x32_bf16 v[44:47], v[76:79], v[196:199], v[44:47]
  s_add_u32 s20, s20, 131072
  s_waitcnt lgkmcnt(3)
  v_mfma_f32_16x16x32_bf16 v[48:51], v[80:83], v[192:195], v[48:51]
  ds_read_b128 v[76:79], v5 offset:23552
  v_mfma_f32_16x16x32_bf16 v[52:55], v[80:83], v[196:199], v[52:55]
  s_add_u32 s51, s51, s50
  v_mfma_f32_16x16x32_bf16 v[56:59], v[84:87], v[192:195], v[56:59]
  ds_read_b128 v[80:83], v5 offset:34816
  v_mfma_f32_16x16x32_bf16 v[60:63], v[84:87], v[196:199], v[60:63]
  s_add_u32 s24, s24, 36864
  s_cmp_ge_u32 s24, 147456
  s_cselect_b32 s24, 0, s24
  s_waitcnt vmcnt(10) lgkmcnt(3)
  s_barrier
  v_mfma_f32_16x16x32_bf16 v[16:19], v[64:67], v[200:203], v[16:19]
  ds_read_b128 v[84:87], v5 offset:35840
  v_mfma_f32_16x16x32_bf16 v[20:23], v[64:67], v[204:207], v[20:23]
  buffer_load_dwordx4 v[232:235], v4, s[12:15], s20 offen offset:0 sc1
  v_mfma_f32_16x16x32_bf16 v[24:27], v[68:71], v[200:203], v[24:27]
  ds_read_b128 v[64:67], v6 offset:0
  v_mfma_f32_16x16x32_bf16 v[28:31], v[68:71], v[204:207], v[28:31]
  buffer_load_dwordx4 v[236:239], v4, s[12:15], s20 offen offset:256 sc1
  s_waitcnt lgkmcnt(3)
  v_mfma_f32_16x16x32_bf16 v[32:35], v[72:75], v[200:203], v[32:35]
  ds_read_b128 v[68:71], v6 offset:1024
  v_mfma_f32_16x16x32_bf16 v[36:39], v[72:75], v[204:207], v[36:39]
  s_add_u32 s20, s20, 131072
  v_mfma_f32_16x16x32_bf16 v[40:43], v[76:79], v[200:203], v[40:43]
  ds_read_b128 v[72:75], v6 offset:12288
  v_mfma_f32_16x16x32_bf16 v[44:47], v[76:79], v[204:207], v[44:47]
  s_add_u32 s26, s26, 36864
  s_cmp_ge_u32 s26, 147456
  s_cselect_b32 s26, 0, s26
  s_waitcnt lgkmcnt(3)
  v_mfma_f32_16x16x32_bf16 v[48:51], v[80:83], v[200:203], v[48:51]
  ds_read_b128 v[76:79], v6 offset:13312
  v_mfma_f32_16x16x32_bf16 v[52:55], v[80:83], v[204:207], v[52:55]
  v_mfma_f32_16x16x32_bf16 v[56:59], v[84:87], v[200:203], v[56:59]
  ds_read_b128 v[80:83], v6 offset:24576
  v_mfma_f32_16x16x32_bf16 v[60:63], v[84:87], v[204:207], v[60:63]
  v_mov_b32 v5, v6
  v_add_u32 v6, s26, v1
  s_waitcnt vmcnt(9) lgkmcnt(3)
  v_mfma_f32_16x16x32_bf16 v[16:19], v[64:67], v[208:211], v[16:19]
  ds_read_b128 v[84:87], v5 offset:25600
  v_mfma_f32_16x16x32_bf16 v[20:23], v[64:67], v[212:215], v[20:23]
  buffer_load_dwordx4 v[240:243], v4, s[12:15], s20 offen offset:0 sc1
  v_mfma_f32_16x16x32_bf16 v[24:27], v[68:71], v[208:211], v[24:27]
  ds_read_b128 v[64:67], v5 offset:2048
  v_mfma_f32_16x16x32_bf16 v[28:31], v[68:71], v[212:215], v[28:31]
  buffer_load_dwordx4 v[244:247], v4, s[12:15], s20 offen offset:256 sc1
  s_waitcnt lgkmcnt(3)
  v_mfma_f32_16x16x32_bf16 v[32:35], v[72:75], v[208:211], v[32:35]
  ds_read_b128 v[68:71], v5 offset:3072
  v_mfma_f32_16x16x32_bf16 v[36:39], v[72:75], v[212:215], v[36:39]
  s_add_u32 s20, s20, 131072
  v_mfma_f32_16x16x32_bf16 v[40:43], v[76:79], v[208:211], v[40:43]
  ds_read_b128 v[72:75], v5 offset:14336
  v_mfma_f32_16x16x32_bf16 v[44:47], v[76:79], v[212:215], v[44:47]
  s_waitcnt lgkmcnt(3)
  v_mfma_f32_16x16x32_bf16 v[48:51], v[80:83], v[208:211], v[48:51]
  ds_read_b128 v[76:79], v5 offset:15360
  v_mfma_f32_16x16x32_bf16 v[52:55], v[80:83], v[212:215], v[52:55]
  s_cmp_ge_u32 s16, 4
  s_cbranch_scc1 Lse_nd2
  s_add_u32 m0, s24, s48
  s_add_u32 s22, s51, s58
  buffer_load_dwordx4 v1, s[12:15], s22 offen sc1 lds
Lse_nd2:
  v_mfma_f32_16x16x32_bf16 v[56:59], v[84:87], v[208:211], v[56:59]
  ds_read_b128 v[80:83], v5 offset:26624
  v_mfma_f32_16x16x32_bf16 v[60:63], v[84:87], v[212:215], v[60:63]
  s_waitcnt vmcnt(7) lgkmcnt(3)
  v_mfma_f32_16x16x32_bf16 v[16:19], v[64:67], v[216:219], v[16:19]
  ds_read_b128 v[84:87], v5 offset:27648
  v_mfma_f32_16x16x32_bf16 v[20:23], v[64:67], v[220:223], v[20:23]
  buffer_load_dwordx4 v[248:251], v4, s[12:15], s20 offen offset:0 sc1
  v_mfma_f32_16x16x32_bf16 v[24:27], v[68:71], v[216:219], v[24:27]
  ds_read_b128 v[64:67], v5 offset:4096
  v_mfma_f32_16x16x32_bf16 v[28:31], v[68:71], v[220:223], v[28:31]
  buffer_load_dwordx4 v[252:255], v4, s[12:15], s20 offen offset:256 sc1
  s_waitcnt lgkmcnt(3)
  v_mfma_f32_16x16x32_bf16 v[32:35], v[72:75], v[216:219], v[32:35]
  ds_read_b128 v[68:71], v5 offset:5120
  v_mfma_f32_16x16x32_bf16 v[36:39], v[72:75], v[220:223], v[36:39]
  s_add_u32 s20, s20, 131072
  v_mfma_f32_16x16x32_bf16 v[40:43], v[76:79], v[216:219], v[40:43]
  ds_read_b128 v[72:75], v5 offset:16384
  v_mfma_f32_16x16x32_bf16 v[44:47], v[76:79], v[220:223], v[44:47]
  s_add_u32 m0, s24, s44
  s_add_u32 s22, s51, s54
  buffer_load_dwordx4 v1, s[12:15], s22 offen sc1 lds
  s_waitcnt lgkmcnt(3)
  v_mfma_f32_16x16x32_bf16 v[48:51], v[80:83], v[216:219], v[48:51]
  ds_read_b128 v[76:79], v5 offset:17408
  v_mfma_f32_16x16x32_bf16 v[52:55], v[80:83], v[220:223], v[52:55]
  v_mfma_f32_16x16x32_bf16 v[56:59], v[84:87], v[216:219], v[56:59]
  ds_read_b128 v[80:83], v5 offset:28672
  v_mfma_f32_16x16x32_bf16 v[60:63], v[84:87], v[220:223], v[60:63]
  s_waitcnt vmcnt(7) lgkmcnt(3)
  v_mfma_f32_16x16x32_bf16 v[16:19], v[64:67], v[224:227], v[16:19]
  ds_read_b128 v[84:87], v5 offset:29696
  v_mfma_f32_16x16x32_bf16 v[20:23], v[64:67], v[228:231], v[20:23]
  v_mfma_f32_16x16x32_bf16 v[24:27], v[68:71], v[224:227], v[24:27]
  ds_read_b128 v[64:67], v5 offset:6144
  v_mfma_f32_16x16x32_bf16 v[28:31], v[68:71], v[228:231], v[28:31]
  s_waitcnt lgkmcnt(3)
  v_mfma_f32_16x16x32_bf16 v[32:35], v[72:75], v[224:227], v[32:35]
  ds_read_b128 v[68:71], v5 offset:7168
  v_mfma_f32_16x16x32_bf16 v[36:39], v[72:75], v[228:231], v[36:39]
  s_add_u32 m0, s24, s45
  s_add_u32 s22, s51, s55
  buffer_load_dwordx4 v1, s[12:15], s22 offen sc1 lds
  v_mfma_f32_16x16x32_bf16 v[40:43], v[76:79], v[224:227], v[40:43]
  ds_read_b128 v[72:75], v5 offset:18432
  v_mfma_f32_16x16x32_bf16 v[44:47], v[76:79], v[228:231], v[44:47]
  s_waitcnt lgkmcnt(3)
  v_mfma_f32_16x16x32_bf16 v[48:51], v[80:83], v[224:227], v[48:51]
  ds_read_b128 v[76:79], v5 offset:19456
  v_mfma_f32_16x16x32_bf16 v[52:55], v[80:83], v[228:231], v[52:55]
  v_mfma_f32_16x16x32_bf16 v[56:59], v[84:87], v[224:227], v[56:59]
  ds_read_b128 v[80:83], v5 offset:30720
  v_mfma_f32_16x16x32_bf16 v[60:63], v[84:87], v[228:231], v[60:63]
  s_waitcnt vmcnt(6) lgkmcnt(3)
  v_mfma_f32_16x16x32_bf16 v[16:19], v[64:67], v[232:235], v[16:19]
  ds_read_b128 v[84:87], v5 offset:31744
  v_mfma_f32_16x16x32_bf16 v[20:23], v[64:67], v[236:239], v[20:23]
  v_mfma_f32_16x16x32_bf16 v[24:27], v[68:71], v[232:235], v[24:27]
  ds_read_b128 v[64:67], v5 offset:8192
  v_mfma_f32_16x16x32_bf16 v[28:31], v[68:71], v[236:239], v[28:31]
  s_add_u32 m0, s24, s46
  s_add_u32 s22, s51, s56
  buffer_load_dwordx4 v1, s[12:15], s22 offen sc1 lds
  s_waitcnt lgkmcnt(3)
  v_mfma_f32_16x16x32_bf16 v[32:35], v[72:75], v[232:235], v[32:35]
  ds_read_b128 v[68:71], v5 offset:9216
  v_mfma_f32_16x16x32_bf16 v[36:39], v[72:75], v[236:239], v[36:39]
  v_mfma_f32_16x16x32_bf16 v[40:43], v[76:79], v[232:235], v[40:43]
  ds_read_b128 v[72:75], v5 offset:20480
  v_mfma_f32_16x16x32_bf16 v[44:47], v[76:79], v[236:239], v[44:47]
  s_waitcnt lgkmcnt(3)
  v_mfma_f32_16x16x32_bf16 v[48:51], v[80:83], v[232:235], v[48:51]
  ds_read_b128 v[76:79], v5 offset:21504
  v_mfma_f32_16x16x32_bf16 v[52:55], v[80:83], v[236:239], v[52:55]
  v_mfma_f32_16x16x32_bf16 v[56:59], v[84:87], v[232:235], v[56:59]
  ds_read_b128 v[80:83], v5 offset:32768
  v_mfma_f32_16x16x32_bf16 v[60:63], v[84:87], v[236:239], v[60:63]
  s_waitcnt vmcnt(5) lgkmcnt(3)
  v_mfma_f32_16x16x32_bf16 v[16:19], v[64:67], v[240:243], v[16:19]
  ds_read_b128 v[84:87], v5 offset:33792
  v_mfma_f32_16x16x32_bf16 v[20:23], v[64:67], v[244:247], v[20:23]
  s_add_u32 m0, s24, s47
  s_add_u32 s22, s51, s57
  buffer_load_dwordx4 v1, s[12:15], s22 offen sc1 lds
  v_mfma_f32_16x16x32_bf16 v[24:27], v[68:71], v[240:243], v[24:27]
  ds_read_b128 v[64:67], v5 offset:10240
  v_mfma_f32_16x16x32_bf16 v[28:31], v[68:71], v[244:247], v[28:31]
  s_add_u32 s51, s51, s50
  s_waitcnt lgkmcnt(3)
  v_mfma_f32_16x16x32_bf16 v[32:35], v[72:75], v[240:243], v[32:35]
  ds_read_b128 v[68:71], v5 offset:11264
  v_mfma_f32_16x16x32_bf16 v[36:39], v[72:75], v[244:247], v[36:39]
  s_add_u32 s24, s24, 36864
  s_cmp_ge_u32 s24, 147456
  s_cselect_b32 s24, 0, s24
  v_mfma_f32_16x16x32_bf16 v[40:43], v[76:79], v[240:243], v[40:43]
  ds_read_b128 v[72:75], v5 offset:22528
  v_mfma_f32_16x16x32_bf16 v[44:47], v[76:79], v[244:247], v[44:47]
  s_add_u32 s26, s26, 36864
  s_cmp_ge_u32 s26, 147456
  s_cselect_b32 s26, 0, s26
  s_waitcnt lgkmcnt(3)
  v_mfma_f32_16x16x32_bf16 v[48:51], v[80:83], v[240:243], v[48:51]
  ds_read_b128 v[76:79], v5 offset:23552
  v_mfma_f32_16x16x32_bf16 v[52:55], v[80:83], v[244:247], v[52:55]
  v_mfma_f32_16x16x32_bf16 v[56:59], v[84:87], v[240:243], v[56:59]
  ds_read_b128 v[80:83], v5 offset:34816
  v_mfma_f32_16x16x32_bf16 v[60:63], v[84:87], v[244:247], v[60:63]
  s_waitcnt vmcnt(4) lgkmcnt(3)
  s_barrier
  v_mfma_f32_16x16x32_bf16 v[16:19], v[64:67], v[248:251], v[16:19]
  ds_read_b128 v[84:87], v5 offset:35840
  v_mfma_f32_16x16x32_bf16 v[20:23], v[64:67], v[252:255], v[20:23]
  v_mfma_f32_16x16x32_bf16 v[24:27], v[68:71], v[248:251], v[24:27]
  ds_read_b128 v[64:67], v6 offset:0
  v_mfma_f32_16x16x32_bf16 v[28:31], v[68:71], v[252:255], v[28:31]
  s_waitcnt lgkmcnt(3)
  v_mfma_f32_16x16x32_bf16 v[32:35], v[72:75], v[248:251], v[32:35]
  ds_read_b128 v[68:71], v6 offset:1024
  v_mfma_f32_16x16x32_bf16 v[36:39], v[72:75], v[252:255], v[36:39]
  v_mfma_f32_16x16x32_bf16 v[40:43], v[76:79], v[248:251], v[40:43]
  ds_read_b128 v[72:75], v6 offset:2048
  v_mfma_f32_16x16x32_bf16 v[44:47], v[76:79], v[252:255], v[44:47]
  s_waitcnt lgkmcnt(3)
  v_mfma_f32_16x16x32_bf16 v[48:51], v[80:83], v[248:251], v[48:51]
  ds_read_b128 v[76:79], v6 offset:3072
  v_mfma_f32_16x16x32_bf16 v[52:55], v[80:83], v[252:255], v[52:55]
  v_mfma_f32_16x16x32_bf16 v[56:59], v[84:87], v[248:251], v[56:59]
  ds_read_b128 v[80:83], v6 offset:4096
  v_mfma_f32_16x16x32_bf16 v[60:63], v[84:87], v[252:255], v[60:63]
  v_mov_b32 v5, v6
  v_add_u32 v6, s26, v1
  s_mov_b32 s27, 4
  s_lshr_b32 s49, s16, 2
  s_add_u32 s49, s49, 8
  v_pk_mul_f32 v[88:89], v[16:17], v[24:25]
  v_pk_mul_f32 v[90:91], v[18:19], v[26:27]
  v_pk_mul_f32 v[92:93], v[20:21], v[28:29]
  v_pk_mul_f32 v[94:95], v[22:23], v[30:31]
  v_pk_mul_f32 v[96:97], v[32:33], v[40:41]
  v_pk_mul_f32 v[98:99], v[34:35], v[42:43]
  v_pk_mul_f32 v[100:101], v[36:37], v[44:45]
  v_pk_mul_f32 v[102:103], v[38:39], v[46:47]
  s_nop 1
  v_pk_mul_f32 v[104:105], v[48:49], v[56:57]
  v_pk_mul_f32 v[106:107], v[50:51], v[58:59]
  v_pk_mul_f32 v[108:109], v[52:53], v[60:61]
  v_pk_mul_f32 v[110:111], v[54:55], v[62:63]
  s_waitcnt lgkmcnt(3)
  v_mfma_f32_16x16x32_bf16 v[16:19], v[64:67], v[112:115], 0
  ds_read_b128 v[84:87], v5 offset:5120
  v_mfma_f32_16x16x32_bf16 v[20:23], v[64:67], v[116:119], 0
  v_cvt_pk_bf16_f32 v88, v88, v89
  v_cvt_pk_bf16_f32 v89, v90, v91
  v_mfma_f32_16x16x32_bf16 v[24:27], v[68:71], v[112:115], 0
  ds_read_b128 v[64:67], v5 offset:6144
  v_mfma_f32_16x16x32_bf16 v[28:31], v[68:71], v[116:119], 0
  v_cvt_pk_bf16_f32 v90, v92, v93
  v_cvt_pk_bf16_f32 v91, v94, v95
  s_nop 0
  s_waitcnt lgkmcnt(3)
  v_mfma_f32_16x16x32_bf16 v[16:19], v[72:75], v[120:123], v[16:19]
  ds_read_b128 v[68:71], v5 offset:7168
  v_mfma_f32_16x16x32_bf16 v[20:23], v[72:75], v[124:127], v[20:23]
  v_permlane16_swap_b32 v88, v90
  v_permlane16_swap_b32 v89, v91
  v_mfma_f32_16x16x32_bf16 v[24:27], v[76:79], v[120:123], v[24:27]
  ds_read_b128 v[72:75], v5 offset:8192
  v_mfma_f32_16x16x32_bf16 v[28:31], v[76:79], v[124:127], v[28:31]
  buffer_store_dwordx4 v[88:91], v3, s[12:15], s21 offen sc1
  s_add_u32 s21, s21, 65536
  s_waitcnt lgkmcnt(3)
  v_mfma_f32_16x16x32_bf16 v[16:19], v[80:83], v[128:131], v[16:19]
  ds_read_b128 v[76:79], v5 offset:9216
  v_mfma_f32_16x16x32_bf16 v[20:23], v[80:83], v[132:135], v[20:23]
  s_cmp_ge_u32 s16, 4
  s_cbranch_scc1 Lse_nd3
  s_add_u32 m0, s24, s48
  s_add_u32 s22, s51, s58
  buffer_load_dwordx4 v1, s[12:15], s22 offen sc1 lds
Lse_nd3:
  v_mfma_f32_16x16x32_bf16 v[24:27], v[84:87], v[128:131], v[24:27]
  ds_read_b128 v[80:83], v5 offset:10240
  v_mfma_f32_16x16x32_bf16 v[28:31], v[84:87], v[132:135], v[28:31]
  v_cvt_pk_bf16_f32 v96, v96, v97
  v_cvt_pk_bf16_f32 v97, v98, v99
  s_waitcnt lgkmcnt(3)
  v_mfma_f32_16x16x32_bf16 v[16:19], v[64:67], v[136:139], v[16:19]
  ds_read_b128 v[84:87], v5 offset:11264
  v_mfma_f32_16x16x32_bf16 v[20:23], v[64:67], v[140:143], v[20:23]
  v_cvt_pk_bf16_f32 v98, v100, v101
  v_cvt_pk_bf16_f32 v99, v102, v103
  s_nop 0
  v_mfma_f32_16x16x32_bf16 v[24:27], v[68:71], v[136:139], v[24:27]
  ds_read_b128 v[64:67], v5 offset:12288
  v_mfma_f32_16x16x32_bf16 v[28:31], v[68:71], v[140:143], v[28:31]
  v_permlane16_swap_b32 v96, v98
  v_permlane16_swap_b32 v97, v99
  s_waitcnt lgkmcnt(3)
  v_mfma_f32_16x16x32_bf16 v[16:19], v[72:75], v[144:147], v[16:19]
  ds_read_b128 v[68:71], v5 offset:13312
  v_mfma_f32_16x16x32_bf16 v[20:23], v[72:75], v[148:151], v[20:23]
  buffer_store_dwordx4 v[96:99], v3, s[12:15], s21 offen sc1
  s_add_u32 s21, s21, 65536
  v_mfma_f32_16x16x32_bf16 v[24:27], v[76:79], v[144:147], v[24:27]
  ds_read_b128 v[72:75], v5 offset:14336
  v_mfma_f32_16x16x32_bf16 v[28:31], v[76:79], v[148:151], v[28:31]
  s_add_u32 m0, s24, s44
  s_add_u32 s22, s51, s54
  buffer_load_dwordx4 v1, s[12:15], s22 offen sc1 lds
  s_waitcnt lgkmcnt(3)
  v_mfma_f32_16x16x32_bf16 v[16:19], v[80:83], v[152:155], v[16:19]
  ds_read_b128 v[76:79], v5 offset:15360
  v_mfma_f32_16x16x32_bf16 v[20:23], v[80:83], v[156:159], v[20:23]
  v_cvt_pk_bf16_f32 v104, v104, v105
  v_cvt_pk_bf16_f32 v105, v106, v107
  v_mfma_f32_16x16x32_bf16 v[24:27], v[84:87], v[152:155], v[24:27]
  ds_read_b128 v[80:83], v5 offset:16384
  v_mfma_f32_16x16x32_bf16 v[28:31], v[84:87], v[156:159], v[28:31]
  v_cvt_pk_bf16_f32 v106, v108, v109
  v_cvt_pk_bf16_f32 v107, v110, v111
  s_nop 0
  s_waitcnt lgkmcnt(3)
  v_mfma_f32_16x16x32_bf16 v[16:19], v[64:67], v[160:163], v[16:19]
  ds_read_b128 v[84:87], v5 offset:17408
  v_mfma_f32_16x16x32_bf16 v[20:23], v[64:67], v[164:167], v[20:23]
  v_permlane16_swap_b32 v104, v106
  v_permlane16_swap_b32 v105, v107
  v_mfma_f32_16x16x32_bf16 v[24:27], v[68:71], v[160:163], v[24:27]
  ds_read_b128 v[64:67], v5 offset:18432
  v_mfma_f32_16x16x32_bf16 v[28:31], v[68:71], v[164:167], v[28:31]
  buffer_store_dwordx4 v[104:107], v3, s[12:15], s21 offen sc1
  s_add_u32 s21, s21, 1441792
  s_waitcnt lgkmcnt(3)
  v_mfma_f32_16x16x32_bf16 v[16:19], v[72:75], v[168:171], v[16:19]
  ds_read_b128 v[68:71], v5 offset:19456
  v_mfma_f32_16x16x32_bf16 v[20:23], v[72:75], v[172:175], v[20:23]
  s_add_u32 m0, s24, s45
  s_add_u32 s22, s51, s55
  buffer_load_dwordx4 v1, s[12:15], s22 offen sc1 lds
  v_mfma_f32_16x16x32_bf16 v[24:27], v[76:79], v[168:171], v[24:27]
  ds_read_b128 v[72:75], v5 offset:20480
  v_mfma_f32_16x16x32_bf16 v[28:31], v[76:79], v[172:175], v[28:31]
  s_waitcnt lgkmcnt(3)
  v_mfma_f32_16x16x32_bf16 v[16:19], v[80:83], v[176:179], v[16:19]
  ds_read_b128 v[76:79], v5 offset:21504
  v_mfma_f32_16x16x32_bf16 v[20:23], v[80:83], v[180:183], v[20:23]
  v_mfma_f32_16x16x32_bf16 v[24:27], v[84:87], v[176:179], v[24:27]
  ds_read_b128 v[80:83], v5 offset:22528
  v_mfma_f32_16x16x32_bf16 v[28:31], v[84:87], v[180:183], v[28:31]
  s_waitcnt lgkmcnt(3)
  v_mfma_f32_16x16x32_bf16 v[16:19], v[64:67], v[184:187], v[16:19]
  ds_read_b128 v[84:87], v5 offset:23552
  v_mfma_f32_16x16x32_bf16 v[20:23], v[64:67], v[188:191], v[20:23]
  v_mfma_f32_16x16x32_bf16 v[24:27], v[68:71], v[184:187], v[24:27]
  ds_read_b128 v[64:67], v5 offset:24576
  v_mfma_f32_16x16x32_bf16 v[28:31], v[68:71], v[188:191], v[28:31]
  s_add_u32 m0, s24, s46
  s_add_u32 s22, s51, s56
  buffer_load_dwordx4 v1, s[12:15], s22 offen sc1 lds
  s_waitcnt lgkmcnt(3)
  v_mfma_f32_16x16x32_bf16 v[16:19], v[72:75], v[192:195], v[16:19]
  ds_read_b128 v[68:71], v5 offset:25600
  v_mfma_f32_16x16x32_bf16 v[20:23], v[72:75], v[196:199], v[20:23]
  v_mfma_f32_16x16x32_bf16 v[24:27], v[76:79], v[192:195], v[24:27]
  ds_read_b128 v[72:75], v5 offset:26624
  v_mfma_f32_16x16x32_bf16 v[28:31], v[76:79], v[196:199], v[28:31]
  s_waitcnt lgkmcnt(3)
  v_mfma_f32_16x16x32_bf16 v[16:19], v[80:83], v[200:203], v[16:19]
  ds_read_b128 v[76:79], v5 offset:27648
  v_mfma_f32_16x16x32_bf16 v[20:23], v[80:83], v[204:207], v[20:23]
  v_mfma_f32_16x16x32_bf16 v[24:27], v[84:87], v[200:203], v[24:27]
  ds_read_b128 v[80:83], v5 offset:28672
  v_mfma_f32_16x16x32_bf16 v[28:31], v[84:87], v[204:207], v[28:31]
  s_waitcnt lgkmcnt(3)
  v_mfma_f32_16x16x32_bf16 v[16:19], v[64:67], v[208:211], v[16:19]
  ds_read_b128 v[84:87], v5 offset:29696
  v_mfma_f32_16x16x32_bf16 v[20:23], v[64:67], v[212:215], v[20:23]
  s_add_u32 m0, s24, s47
  s_add_u32 s22, s51, s57
  buffer_load_dwordx4 v1, s[12:15], s22 offen sc1 lds
  v_mfma_f32_16x16x32_bf16 v[24:27], v[68:71], v[208:211], v[24:27]
  ds_read_b128 v[64:67], v5 offset:30720
  v_mfma_f32_16x16x32_bf16 v[28:31], v[68:71], v[212:215], v[28:31]
  s_add_u32 s51, s51, s50
  s_waitcnt lgkmcnt(3)
  v_mfma_f32_16x16x32_bf16 v[16:19], v[72:75], v[216:219], v[16:19]
  ds_read_b128 v[68:71], v5 offset:31744
  v_mfma_f32_16x16x32_bf16 v[20:23], v[72:75], v[220:223], v[20:23]
  s_add_u32 s24, s24, 36864
  s_cmp_ge_u32 s24, 147456
  s_cselect_b32 s24, 0, s24
  v_mfma_f32_16x16x32_bf16 v[24:27], v[76:79], v[216:219], v[24:27]
  ds_read_b128 v[72:75], v5 offset:32768
  v_mfma_f32_16x16x32_bf16 v[28:31], v[76:79], v[220:223], v[28:31]
  s_add_u32 s26, s26, 36864
  s_cmp_ge_u32 s26, 147456
  s_cselect_b32 s26, 0, s26
  s_waitcnt lgkmcnt(3)
  v_mfma_f32_16x16x32_bf16 v[16:19], v[80:83], v[224:227], v[16:19]
  ds_read_b128 v[76:79], v5 offset:33792
  v_mfma_f32_16x16x32_bf16 v[20:23], v[80:83], v[228:231], v[20:23]
  v_mfma_f32_16x16x32_bf16 v[24:27], v[84:87], v[224:227], v[24:27]
  ds_read_b128 v[80:83], v5 offset:34816
  v_mfma_f32_16x16x32_bf16 v[28:31], v[84:87], v[228:231], v[28:31]
  s_waitcnt vmcnt(7) lgkmcnt(3)
  s_barrier
  v_mfma_f32_16x16x32_bf16 v[16:19], v[64:67], v[232:235], v[16:19]
  ds_read_b128 v[84:87], v5 offset:35840
  v_mfma_f32_16x16x32_bf16 v[20:23], v[64:67], v[236:239], v[20:23]
  v_mfma_f32_16x16x32_bf16 v[24:27], v[68:71], v[232:235], v[24:27]
  ds_read_b128 v[64:67], v6 offset:0
  v_mfma_f32_16x16x32_bf16 v[28:31], v[68:71], v[236:239], v[28:31]
  s_waitcnt lgkmcnt(3)
  v_mfma_f32_16x16x32_bf16 v[16:19], v[72:75], v[240:243], v[16:19]
  ds_read_b128 v[68:71], v6 offset:1024
  v_mfma_f32_16x16x32_bf16 v[20:23], v[72:75], v[244:247], v[20:23]
  v_mfma_f32_16x16x32_bf16 v[24:27], v[76:79], v[240:243], v[24:27]
  ds_read_b128 v[72:75], v6 offset:2048
  v_mfma_f32_16x16x32_bf16 v[28:31], v[76:79], v[244:247], v[28:31]
  s_waitcnt lgkmcnt(3)
  v_mfma_f32_16x16x32_bf16 v[16:19], v[80:83], v[248:251], v[16:19]
  ds_read_b128 v[76:79], v6 offset:3072
  v_mfma_f32_16x16x32_bf16 v[20:23], v[80:83], v[252:255], v[20:23]
  v_mfma_f32_16x16x32_bf16 v[24:27], v[84:87], v[248:251], v[24:27]
  ds_read_b128 v[80:83], v6 offset:4096
  v_mfma_f32_16x16x32_bf16 v[28:31], v[84:87], v[252:255], v[28:31]
  v_mov_b32 v5, v6
  v_add_u32 v6, s26, v1
  s_nop 5
  v_pk_mul_f32 v[88:89], v[16:17], v[24:25]
  v_pk_mul_f32 v[90:91], v[18:19], v[26:27]
  v_pk_mul_f32 v[92:93], v[20:21], v[28:29]
  v_pk_mul_f32 v[94:95], v[22:23], v[30:31]
.p2align 6
Lse_dloop:
  s_waitcnt lgkmcnt(3)
  v_mfma_f32_16x16x32_bf16 v[16:19], v[64:67], v[112:115], 0
  ds_read_b128 v[84:87], v5 offset:5120
  v_mfma_f32_16x16x32_bf16 v[20:23], v[64:67], v[116:119], 0
  s_branch Lse_dside
Lse_dback:
  v_mfma_f32_16x16x32_bf16 v[24:27], v[68:71], v[112:115], 0
  ds_read_b128 v[64:67], v5 offset:6144
  v_mfma_f32_16x16x32_bf16 v[28:31], v[68:71], v[116:119], 0
  v_cvt_pk_bf16_f32 v88, v88, v89
  s_waitcnt lgkmcnt(3)
  v_mfma_f32_16x16x32_bf16 v[16:19], v[72:75], v[120:123], v[16:19]
  ds_read_b128 v[68:71], v5 offset:7168
  v_mfma_f32_16x16x32_bf16 v[20:23], v[72:75], v[124:127], v[20:23]
  v_cvt_pk_bf16_f32 v89, v90, v91
  v_mfma_f32_16x16x32_bf16 v[24:27], v[76:79], v[120:123], v[24:27]
  ds_read_b128 v[72:75], v5 offset:8192
  v_mfma_f32_16x16x32_bf16 v[28:31], v[76:79], v[124:127], v[28:31]
  v_cvt_pk_bf16_f32 v90, v92, v93
  s_waitcnt lgkmcnt(3)
  v_mfma_f32_16x16x32_bf16 v[16:19], v[80:83], v[128:131], v[16:19]
  ds_read_b128 v[76:79], v5 offset:9216
  v_mfma_f32_16x16x32_bf16 v[20:23], v[80:83], v[132:135], v[20:23]
  s_cmp_ge_u32 s16, 4
  s_cbranch_scc1 Lse_nd4
  s_add_u32 m0, s24, s48
  s_add_u32 s22, s51, s58
  buffer_load_dwordx4 v1, s[12:15], s22 offen sc1 lds
Lse_nd4:
  v_mfma_f32_16x16x32_bf16 v[24:27], v[84:87], v[128:131], v[24:27]
  ds_read_b128 v[80:83], v5 offset:10240
  v_mfma_f32_16x16x32_bf16 v[28:31], v[84:87], v[132:135], v[28:31]
  v_cvt_pk_bf16_f32 v91, v94, v95
  s_nop 0
  s_waitcnt lgkmcnt(3)
  v_mfma_f32_16x16x32_bf16 v[16:19], v[64:67], v[136:139], v[16:19]
  ds_read_b128 v[84:87], v5 offset:11264
  v_mfma_f32_16x16x32_bf16 v[20:23], v[64:67], v[140:143], v[20:23]
  v_permlane16_swap_b32 v88, v90
  v_mfma_f32_16x16x32_bf16 v[24:27], v[68:71], v[136:139], v[24:27]
  ds_read_b128 v[64:67], v5 offset:12288
  v_mfma_f32_16x16x32_bf16 v[28:31], v[68:71], v[140:143], v[28:31]
  v_permlane16_swap_b32 v89, v91
  s_waitcnt lgkmcnt(3)
  v_mfma_f32_16x16x32_bf16 v[16:19], v[72:75], v[144:147], v[16:19]
  ds_read_b128 v[68:71], v5 offset:13312
  v_mfma_f32_16x16x32_bf16 v[20:23], v[72:75], v[148:151], v[20:23]
  buffer_store_dwordx4 v[88:91], v3, s[12:15], s21 offen sc1
  v_mfma_f32_16x16x32_bf16 v[24:27], v[76:79], v[144:147], v[24:27]
  ds_read_b128 v[72:75], v5 offset:14336
  v_mfma_f32_16x16x32_bf16 v[28:31], v[76:79], v[148:151], v[28:31]
  s_add_u32 m0, s24, s44
  s_add_u32 s22, s51, s54
  buffer_load_dwordx4 v1, s[12:15], s22 offen sc1 lds
  s_waitcnt lgkmcnt(3)
  v_mfma_f32_16x16x32_bf16 v[16:19], v[80:83], v[152:155], v[16:19]
  ds_read_b128 v[76:79], v5 offset:15360
  v_mfma_f32_16x16x32_bf16 v[20:23], v[80:83], v[156:159], v[20:23]
  s_add_u32 s21, s21, 65536
  v_mfma_f32_16x16x32_bf16 v[24:27], v[84:87], v[152:155], v[24:27]
  ds_read_b128 v[80:83], v5 offset:16384
  v_mfma_f32_16x16x32_bf16 v[28:31], v[84:87], v[156:159], v[28:31]
  s_waitcnt lgkmcnt(3)
  v_mfma_f32_16x16x32_bf16 v[16:19], v[64:67], v[160:163], v[16:19]
  ds_read_b128 v[84:87], v5 offset:17408
  v_mfma_f32_16x16x32_bf16 v[20:23], v[64:67], v[164:167], v[20:23]
  v_mfma_f32_16x16x32_bf16 v[24:27], v[68:71], v[160:163], v[24:27]
  ds_read_b128 v[64:67], v5 offset:18432
  v_mfma_f32_16x16x32_bf16 v[28:31], v[68:71], v[164:167], v[28:31]
  s_waitcnt lgkmcnt(3)
  v_mfma_f32_16x16x32_bf16 v[16:19], v[72:75], v[168:171], v[16:19]
  ds_read_b128 v[68:71], v5 offset:19456
  v_mfma_f32_16x16x32_bf16 v[20:23], v[72:75], v[172:175], v[20:23]
  s_add_u32 m0, s24, s45
  s_add_u32 s22, s51, s55
  buffer_load_dwordx4 v1, s[12:15], s22 offen sc1 lds
  v_mfma_f32_16x16x32_bf16 v[24:27], v[76:79], v[168:171], v[24:27]
  ds_read_b128 v[72:75], v5 offset:20480
  v_mfma_f32_16x16x32_bf16 v[28:31], v[76:79], v[172:175], v[28:31]
  s_waitcnt lgkmcnt(3)
  v_mfma_f32_16x16x32_bf16 v[16:19], v[80:83], v[176:179], v[16:19]
  ds_read_b128 v[76:79], v5 offset:21504
  v_mfma_f32_16x16x32_bf16 v[20:23], v[80:83], v[180:183], v[20:23]
  v_mfma_f32_16x16x32_bf16 v[24:27], v[84:87], v[176:179], v[24:27]
  ds_read_b128 v[80:83], v5 offset:22528
  v_mfma_f32_16x16x32_bf16 v[28:31], v[84:87], v[180:183], v[28:31]
  s_waitcnt lgkmcnt(3)
  v_mfma_f32_16x16x32_bf16 v[16:19], v[64:67], v[184:187], v[16:19]
  ds_read_b128 v[84:87], v5 offset:23552
  v_mfma_f32_16x16x32_bf16 v[20:23], v[64:67], v[188:191], v[20:23]
  v_mfma_f32_16x16x32_bf16 v[24:27], v[68:71], v[184:187], v[24:27]
  ds_read_b128 v[64:67], v5 offset:24576
  v_mfma_f32_16x16x32_bf16 v[28:31], v[68:71], v[188:191], v[28:31]
  s_add_u32 m0, s24, s46
  s_add_u32 s22, s51, s56
  buffer_load_dwordx4 v1, s[12:15], s22 offen sc1 lds
  s_waitcnt lgkmcnt(3)
  v_mfma_f32_16x16x32_bf16 v[16:19], v[72:75], v[192:195], v[16:19]
  ds_read_b128 v[68:71], v5 offset:25600
  v_mfma_f32_16x16x32_bf16 v[20:23], v[72:75], v[196:199], v[20:23]
  v_mfma_f32_16x16x32_bf16 v[24:27], v[76:79], v[192:195], v[24:27]
  ds_read_b128 v[72:75], v5 offset:26624
  v_mfma_f32_16x16x32_bf16 v[28:31], v[76:79], v[196:199], v[28:31]
  s_waitcnt lgkmcnt(3)
  v_mfma_f32_16x16x32_bf16 v[16:19], v[80:83], v[200:203], v[16:19]
  ds_read_b128 v[76:79], v5 offset:27648
  v_mfma_f32_16x16x32_bf16 v[20:23], v[80:83], v[204:207], v[20:23]
  v_mfma_f32_16x16x32_bf16 v[24:27], v[84:87], v[200:203], v[24:27]
  ds_read_b128 v[80:83], v5 offset:28672
  v_mfma_f32_16x16x32_bf16 v[28:31], v[84:87], v[204:207], v[28:31]
  s_waitcnt lgkmcnt(3)
  v_mfma_f32_16x16x32_bf16 v[16:19], v[64:67], v[208:211], v[16:19]
  ds_read_b128 v[84:87], v5 offset:29696
  v_mfma_f32_16x16x32_bf16 v[20:23], v[64:67], v[212:215], v[20:23]
  s_add_u32 m0, s24, s47
  s_add_u32 s22, s51, s57
  buffer_load_dwordx4 v1, s[12:15], s22 offen sc1 lds
  v_mfma_f32_16x16x32_bf16 v[24:27], v[68:71], v[208:211], v[24:27]
  ds_read_b128 v[64:67], v5 offset:30720
  v_mfma_f32_16x16x32_bf16 v[28:31], v[68:71], v[212:215], v[28:31]
  s_add_u32 s51, s51, s50
  s_waitcnt lgkmcnt(3)
  v_mfma_f32_16x16x32_bf16 v[16:19], v[72:75], v[216:219], v[16:19]
  ds_read_b128 v[68:71], v5 offset:31744
  v_mfma_f32_16x16x32_bf16 v[20:23], v[72:75], v[220:223], v[20:23]
  s_add_u32 s24, s24, 36864
  s_cmp_ge_u32 s24, 147456
  s_cselect_b32 s24, 0, s24
  v_mfma_f32_16x16x32_bf16 v[24:27], v[76:79], v[216:219], v[24:27]
  ds_read_b128 v[72:75], v5 offset:32768
  v_mfma_f32_16x16x32_bf16 v[28:31], v[76:79], v[220:223], v[28:31]
  s_add_u32 s26, s26, 36864
  s_cmp_ge_u32 s26, 147456
  s_cselect_b32 s26, 0, s26
  s_waitcnt lgkmcnt(3)
  v_mfma_f32_16x16x32_bf16 v[16:19], v[80:83], v[224:227], v[16:19]
  ds_read_b128 v[76:79], v5 offset:33792
  v_mfma_f32_16x16x32_bf16 v[20:23], v[80:83], v[228:231], v[20:23]
  v_mfma_f32_16x16x32_bf16 v[24:27], v[84:87], v[224:227], v[24:27]
  ds_read_b128 v[80:83], v5 offset:34816
  v_mfma_f32_16x16x32_bf16 v[28:31], v[84:87], v[228:231], v[28:31]
  s_waitcnt vmcnt(5) lgkmcnt(3)
  s_barrier
  v_mfma_f32_16x16x32_bf16 v[16:19], v[64:67], v[232:235], v[16:19]
  ds_read_b128 v[84:87], v5 offset:35840
  v_mfma_f32_16x16x32_bf16 v[20:23], v[64:67], v[236:239], v[20:23]
  v_mfma_f32_16x16x32_bf16 v[24:27], v[68:71], v[232:235], v[24:27]
  ds_read_b128 v[64:67], v6 offset:0
  v_mfma_f32_16x16x32_bf16 v[28:31], v[68:71], v[236:239], v[28:31]
  s_waitcnt lgkmcnt(3)
  v_mfma_f32_16x16x32_bf16 v[16:19], v[72:75], v[240:243], v[16:19]
  ds_read_b128 v[68:71], v6 offset:1024
  v_mfma_f32_16x16x32_bf16 v[20:23], v[72:75], v[244:247], v[20:23]
  v_mfma_f32_16x16x32_bf16 v[24:27], v[76:79], v[240:243], v[24:27]
  ds_read_b128 v[72:75], v6 offset:2048
  v_mfma_f32_16x16x32_bf16 v[28:31], v[76:79], v[244:247], v[28:31]
  s_waitcnt lgkmcnt(3)
  v_mfma_f32_16x16x32_bf16 v[16:19], v[80:83], v[248:251], v[16:19]
  ds_read_b128 v[76:79], v6 offset:3072
  v_mfma_f32_16x16x32_bf16 v[20:23], v[80:83], v[252:255], v[20:23]
  v_mfma_f32_16x16x32_bf16 v[24:27], v[84:87], v[248:251], v[24:27]
  ds_read_b128 v[80:83], v6 offset:4096
  v_mfma_f32_16x16x32_bf16 v[28:31], v[84:87], v[252:255], v[28:31]
  v_mov_b32 v5, v6
  v_add_u32 v6, s26, v1
  s_add_u32 s27, s27, 1
  s_cmp_lt_u32 s27, s49
  s_nop 3
  v_pk_mul_f32 v[88:89], v[16:17], v[24:25]
  v_pk_mul_f32 v[90:91], v[18:19], v[26:27]
  v_pk_mul_f32 v[92:93], v[20:21], v[28:29]
  v_pk_mul_f32 v[94:95], v[22:23], v[30:31]
  s_cbranch_scc1 Lse_dloop
  s_cmp_lt_u32 s16, 4
  s_cbranch_scc1 Lse_econs
  s_add_u32 s32, s32, 262144
  buffer_load_dwordx2 v[16:17], v2, s[12:15], s32 offen sc1
  s_and_b32 s33, s16, 3
  s_add_u32 s40, s19, 0
  s_and_b32 s40, s40, 3
  s_lshl_b32 s44, s40, 10
  s_add_u32 s41, s19, 1
  s_and_b32 s41, s41, 3
  s_lshl_b32 s45, s41, 10
  s_add_u32 s42, s19, 2
  s_and_b32 s42, s42, 3
  s_lshl_b32 s46, s42, 10
  s_add_u32 s43, s19, 3
  s_and_b32 s43, s43, 3
  s_lshl_b32 s47, s43, 10
  s_mul_i32 s29, s33, 6144
  s_add_u32 s29, s29, 73728
  v_add_u32 v11, s29, v1
  s_mul_i32 s23, s33, 36864
  s_add_u32 s23, s23, s53
  s_add_u32 s23, s23, 294912
  s_mul_i32 s22, s33, 9216
  s_add_u32 s24, s22, 110592
  v_cvt_pk_bf16_f32 v88, v88, v89
  v_cvt_pk_bf16_f32 v89, v90, v91
  v_cvt_pk_bf16_f32 v90, v92, v93
  v_cvt_pk_bf16_f32 v91, v94, v95
  s_nop 0
  v_permlane16_swap_b32 v88, v90
  v_permlane16_swap_b32 v89, v91
  s_mul_i32 s29, s33, 3072
  s_add_u32 s29, s29, 147456
  v_add_u32 v5, s29, v1
  s_sub_u32 s29, s21, 2048
  s_barrier
  ds_read_b128 v[92:95], v5 offset:0
  s_add_u32 m0, s24, 0
  s_add_u32 s48, s23, s44
  buffer_load_dwordx4 v1, s[12:15], s48 offen sc1 lds
  s_add_u32 m0, s24, 1024
  s_add_u32 s49, s23, s45
  buffer_load_dwordx4 v1, s[12:15], s49 offen sc1 lds
  s_add_u32 m0, s24, 2048
  s_add_u32 s50, s23, s46
  buffer_load_dwordx4 v1, s[12:15], s50 offen sc1 lds
  s_add_u32 m0, s24, 3072
  s_add_u32 s51, s23, s47
  buffer_load_dwordx4 v1, s[12:15], s51 offen sc1 lds
  s_add_u32 m0, s24, 4096
  s_add_u32 s25, s48, 4096
  buffer_load_dwordx4 v1, s[12:15], s25 offen sc1 lds
  s_add_u32 m0, s24, 5120
  s_add_u32 s25, s49, 4096
  buffer_load_dwordx4 v1, s[12:15], s25 offen sc1 lds
  s_add_u32 m0, s24, 6144
  s_add_u32 s25, s50, 4096
  buffer_load_dwordx4 v1, s[12:15], s25 offen sc1 lds
  s_add_u32 m0, s24, 7168
  s_add_u32 s25, s51, 4096
  buffer_load_dwordx4 v1, s[12:15], s25 offen sc1 lds
  s_add_u32 m0, s24, 8192
  s_add_u32 s25, s23, 8192
  buffer_load_dwordx4 v1, s[12:15], s25 offen sc1 lds
  s_add_u32 s23, s23, 147456
  s_add_u32 s24, s24, 36864
  s_cmp_ge_u32 s24, 147456
  s_cselect_b32 s24, s22, s24
  buffer_store_dwordx4 v[88:91], v3, s[12:15], s21 offen sc1
  s_add_u32 s21, s21, 65536
  s_waitcnt lgkmcnt(0)
  buffer_store_dwordx4 v[92:95], v3, s[12:15], s29 offen sc1
  s_add_u32 s29, s29, 65536
  s_mov_b32 s4, s36
  s_mov_b32 s5, s37
  s_mov_b32 s6, 0x240000
  s_mov_b32 s7, 0x20000
  s_waitcnt vmcnt(11)
  s_barrier
  v_subrev_u32 v16, s0, v16
  v_xor_b32 v17, s1, v17
  v_subrev_u32 v16, 1, v16
  v_and_or_b32 v16, v16, -4, v17
  v_cmp_ne_u32 vcc, 0, v16
  s_nop 0
  s_cbranch_vccz Lse_pe2x
  s_mov_b32 s60, 0
Lse_pe2:
  buffer_load_dwordx2 v[16:17], v2, s[12:15], s32 offen sc1
  s_add_u32 s60, s60, 1
  s_waitcnt vmcnt(0)
  v_subrev_u32 v16, s0, v16
  v_xor_b32 v17, s1, v17
  v_subrev_u32 v16, 1, v16
  v_and_or_b32 v16, v16, -4, v17
  v_cmp_ne_u32 vcc, 0, v16
  s_cmp_ge_u32 s60, 400000
  s_cbranch_scc1 Lse_pe2x
  s_cbranch_vccz Lse_pe2x
  s_sleep 2
  s_branch Lse_pe2
Lse_pe2x:
  s_add_u32 m0, s24, 0
  s_add_u32 s48, s23, s44
  buffer_load_dwordx4 v1, s[12:15], s48 offen sc1 lds
  s_add_u32 m0, s24, 1024
  s_add_u32 s49, s23, s45
  buffer_load_dwordx4 v1, s[12:15], s49 offen sc1 lds
  s_add_u32 m0, s24, 2048
  s_add_u32 s50, s23, s46
  buffer_load_dwordx4 v1, s[12:15], s50 offen sc1 lds
  s_add_u32 m0, s24, 3072
  s_add_u32 s51, s23, s47
  buffer_load_dwordx4 v1, s[12:15], s51 offen sc1 lds
  s_add_u32 m0, s24, 4096
  s_add_u32 s25, s48, 4096
  buffer_load_dwordx4 v1, s[12:15], s25 offen sc1 lds
  s_add_u32 m0, s24, 5120
  s_add_u32 s25, s49, 4096
  buffer_load_dwordx4 v1, s[12:15], s25 offen sc1 lds
  s_add_u32 m0, s24, 6144
  s_add_u32 s25, s50, 4096
  buffer_load_dwordx4 v1, s[12:15], s25 offen sc1 lds
  s_add_u32 m0, s24, 7168
  s_add_u32 s25, s51, 4096
  buffer_load_dwordx4 v1, s[12:15], s25 offen sc1 lds
  s_add_u32 m0, s24, 8192
  s_add_u32 s25, s23, 8192
  buffer_load_dwordx4 v1, s[12:15], s25 offen sc1 lds
  s_add_u32 s23, s23, 147456
  s_add_u32 s24, s24, 36864
  s_cmp_ge_u32 s24, 147456
  s_cselect_b32 s24, s22, s24
  s_sub_u32 s26, s30, 16384
  s_sub_u32 s27, s31, 512
  s_waitcnt vmcnt(11)
  s_barrier
  s_waitcnt vmcnt(9)
  v_mov_b32 v12, 1
  v_mov_b32 v13, s1
  v_add_u32 v12, s0, v12
  v_lshlrev_b32 v14, 3, v0
  s_mov_b64 exec, 65535
  buffer_store_dwordx2 v[12:13], v14, s[12:15], s30 offen sc1
  buffer_store_dwordx2 v[12:13], v14, s[12:15], s26 offen sc1
  buffer_store_dwordx2 v[12:13], v14, s[12:15], s27 offen sc1
  s_mov_b64 exec, -1
  s_add_u32 m0, s24, 0
  s_add_u32 s48, s23, s44
  buffer_load_dwordx4 v1, s[12:15], s48 offen sc1 lds
  s_add_u32 m0, s24, 1024
  s_add_u32 s49, s23, s45
  buffer_load_dwordx4 v1, s[12:15], s49 offen sc1 lds
  s_add_u32 m0, s24, 2048
  s_add_u32 s50, s23, s46
  buffer_load_dwordx4 v1, s[12:15], s50 offen sc1 lds
  s_add_u32 m0, s24, 3072
  s_add_u32 s51, s23, s47
  buffer_load_dwordx4 v1, s[12:15], s51 offen sc1 lds
  s_add_u32 m0, s24, 4096
  s_add_u32 s25, s48, 4096
  buffer_load_dwordx4 v1, s[12:15], s25 offen sc1 lds
  s_add_u32 m0, s24, 5120
  s_add_u32 s25, s49, 4096
  buffer_load_dwordx4 v1, s[12:15], s25 offen sc1 lds
  s_add_u32 m0, s24, 6144
  s_add_u32 s25, s50, 4096
  buffer_load_dwordx4 v1, s[12:15], s25 offen sc1 lds
  s_add_u32 m0, s24, 7168
  s_add_u32 s25, s51, 4096
  buffer_load_dwordx4 v1, s[12:15], s25 offen sc1 lds
  s_add_u32 m0, s24, 8192
  s_add_u32 s25, s23, 8192
  buffer_load_dwordx4 v1, s[12:15], s25 offen sc1 lds
  s_add_u32 s23, s23, 147456
  s_add_u32 s24, s24, 36864
  s_cmp_ge_u32 s24, 147456
  s_cselect_b32 s24, s22, s24
  s_waitcnt vmcnt(12)
  s_barrier
  s_add_u32 m0, s24, 0
  s_add_u32 s48, s23, s44
  buffer_load_dwordx4 v1, s[12:15], s48 offen sc1 lds
  s_add_u32 m0, s24, 1024
  s_add_u32 s49, s23, s45
  buffer_load_dwordx4 v1, s[12:15], s49 offen sc1 lds
  s_add_u32 m0, s24, 2048
  s_add_u32 s50, s23, s46
  buffer_load_dwordx4 v1, s[12:15], s50 offen sc1 lds
  s_add_u32 m0, s24, 3072
  s_add_u32 s51, s23, s47
  buffer_load_dwordx4 v1, s[12:15], s51 offen sc1 lds
  s_add_u32 m0, s24, 4096
  s_add_u32 s25, s48, 4096
  buffer_load_dwordx4 v1, s[12:15], s25 offen sc1 lds
  s_add_u32 m0, s24, 5120
  s_add_u32 s25, s49, 4096
  buffer_load_dwordx4 v1, s[12:15], s25 offen sc1 lds
  s_add_u32 m0, s24, 6144
  s_add_u32 s25, s50, 4096
  buffer_load_dwordx4 v1, s[12:15], s25 offen sc1 lds
  s_add_u32 m0, s24, 7168
  s_add_u32 s25, s51, 4096
  buffer_load_dwordx4 v1, s[12:15], s25 offen sc1 lds
  s_add_u32 m0, s24, 8192
  s_add_u32 s25, s23, 8192
  buffer_load_dwordx4 v1, s[12:15], s25 offen sc1 lds
  s_add_u32 s23, s23, 147456
  s_add_u32 s24, s24, 36864
  s_cmp_ge_u32 s24, 147456
  s_cselect_b32 s24, s22, s24
  s_waitcnt vmcnt(9)
  s_barrier
  s_add_u32 s32, s32, 262144
  buffer_load_dwordx2 v[16:17], v2, s[12:15], s32 offen sc1
  s_add_u32 m0, s24, 0
  s_add_u32 s48, s23, s44
  buffer_load_dwordx4 v1, s[12:15], s48 offen sc1 lds
  s_add_u32 m0, s24, 1024
  s_add_u32 s49, s23, s45
  buffer_load_dwordx4 v1, s[12:15], s49 offen sc1 lds
  s_add_u32 m0, s24, 2048
  s_add_u32 s50, s23, s46
  buffer_load_dwordx4 v1, s[12:15], s50 offen sc1 lds
  s_add_u32 m0, s24, 3072
  s_add_u32 s51, s23, s47
  buffer_load_dwordx4 v1, s[12:15], s51 offen sc1 lds
  s_add_u32 m0, s24, 4096
  s_add_u32 s25, s48, 4096
  buffer_load_dwordx4 v1, s[12:15], s25 offen sc1 lds
  s_add_u32 m0, s24, 5120
  s_add_u32 s25, s49, 4096
  buffer_load_dwordx4 v1, s[12:15], s25 offen sc1 lds
  s_add_u32 m0, s24, 6144
  s_add_u32 s25, s50, 4096
  buffer_load_dwordx4 v1, s[12:15], s25 offen sc1 lds
  s_add_u32 m0, s24, 7168
  s_add_u32 s25, s51, 4096
  buffer_load_dwordx4 v1, s[12:15], s25 offen sc1 lds
  s_add_u32 m0, s24, 8192
  s_add_u32 s25, s23, 8192
  buffer_load_dwordx4 v1, s[12:15], s25 offen sc1 lds
  s_add_u32 s23, s23, 147456
  s_add_u32 s24, s24, 36864
  s_cmp_ge_u32 s24, 147456
  s_cselect_b32 s24, s22, s24
  s_waitcnt vmcnt(9)
  v_subrev_u32 v16, s0, v16
  v_xor_b32 v17, s1, v17
  v_subrev_u32 v16, 1, v16
  v_and_or_b32 v16, v16, -4, v17
  v_cmp_ne_u32 vcc, 0, v16
  s_nop 0
  s_cbranch_vccz Lse_pe3x
  s_mov_b32 s60, 0
Lse_pe3:
  buffer_load_dwordx2 v[16:17], v2, s[12:15], s32 offen sc1
  s_add_u32 s60, s60, 1
  s_waitcnt vmcnt(0)
  v_subrev_u32 v16, s0, v16
  v_xor_b32 v17, s1, v17
  v_subrev_u32 v16, 1, v16
  v_and_or_b32 v16, v16, -4, v17
  v_cmp_ne_u32 vcc, 0, v16
  s_cmp_ge_u32 s60, 400000
  s_cbranch_scc1 Lse_pe3x
  s_cbranch_vccz Lse_pe3x
  s_sleep 2
  s_branch Lse_pe3
Lse_pe3x:
  s_barrier
  s_add_u32 m0, s24, 0
  s_add_u32 s48, s23, s44
  buffer_load_dwordx4 v1, s[12:15], s48 offen sc1 lds
  s_add_u32 m0, s24, 1024
  s_add_u32 s49, s23, s45
  buffer_load_dwordx4 v1, s[12:15], s49 offen sc1 lds
  s_add_u32 m0, s24, 2048
  s_add_u32 s50, s23, s46
  buffer_load_dwordx4 v1, s[12:15], s50 offen sc1 lds
  s_add_u32 m0, s24, 3072
  s_add_u32 s51, s23, s47
  buffer_load_dwordx4 v1, s[12:15], s51 offen sc1 lds
  s_add_u32 m0, s24, 4096
  s_add_u32 s25, s48, 4096
  buffer_load_dwordx4 v1, s[12:15], s25 offen sc1 lds
  s_add_u32 m0, s24, 5120
  s_add_u32 s25, s49, 4096
  buffer_load_dwordx4 v1, s[12:15], s25 offen sc1 lds
  s_add_u32 m0, s24, 6144
  s_add_u32 s25, s50, 4096
  buffer_load_dwordx4 v1, s[12:15], s25 offen sc1 lds
  s_add_u32 m0, s24, 7168
  s_add_u32 s25, s51, 4096
  buffer_load_dwordx4 v1, s[12:15], s25 offen sc1 lds
  s_add_u32 m0, s24, 8192
  s_add_u32 s25, s23, 8192
  buffer_load_dwordx4 v1, s[12:15], s25 offen sc1 lds
  s_add_u32 s23, s23, 147456
  s_add_u32 s24, s24, 36864
  s_cmp_ge_u32 s24, 147456
  s_cselect_b32 s24, s22, s24
  s_waitcnt vmcnt(9)
  s_barrier
  s_add_u32 m0, s24, 0
  s_add_u32 s48, s23, s44
  buffer_load_dwordx4 v1, s[12:15], s48 offen sc1 lds
  s_add_u32 m0, s24, 1024
  s_add_u32 s49, s23, s45
  buffer_load_dwordx4 v1, s[12:15], s49 offen sc1 lds
  s_add_u32 m0, s24, 2048
  s_add_u32 s50, s23, s46
  buffer_load_dwordx4 v1, s[12:15], s50 offen sc1 lds
  s_add_u32 m0, s24, 3072
  s_add_u32 s51, s23, s47
  buffer_load_dwordx4 v1, s[12:15], s51 offen sc1 lds
  s_add_u32 m0, s24, 4096
  s_add_u32 s25, s48, 4096
  buffer_load_dwordx4 v1, s[12:15], s25 offen sc1 lds
  s_add_u32 m0, s24, 5120
  s_add_u32 s25, s49, 4096
  buffer_load_dwordx4 v1, s[12:15], s25 offen sc1 lds
  s_add_u32 m0, s24, 6144
  s_add_u32 s25, s50, 4096
  buffer_load_dwordx4 v1, s[12:15], s25 offen sc1 lds
  s_add_u32 m0, s24, 7168
  s_add_u32 s25, s51, 4096
  buffer_load_dwordx4 v1, s[12:15], s25 offen sc1 lds
  s_add_u32 m0, s24, 8192
  s_add_u32 s25, s23, 8192
  buffer_load_dwordx4 v1, s[12:15], s25 offen sc1 lds
  s_add_u32 s23, s23, 147456
  s_add_u32 s24, s24, 36864
  s_cmp_ge_u32 s24, 147456
  s_cselect_b32 s24, s22, s24
  v_bfe_u32 v10, v0, 1, 2
  v_and_b32 v9, 1, v0
  v_lshlrev_b32 v9, 2, v9
  v_lshlrev_b32 v10, 4, v10
  v_mul_u32_u24 v10, 128, v10
  s_andn2_b32 s59, s2, 6
  s_lshl_b32 s59, s59, 3
  s_add_u32 s59, s59, s33
  s_mul_i32 s59, s59, 128
  s_add_u32 s59, s59, 55836672
  buffer_load_dwordx2 v[12:13], v10, s[12:15], s59 offen sc1
  v_and_b32 v6, 31, v0
  v_lshrrev_b32 v7, 5, v0
  s_mul_i32 s54, s18, 9
  s_add_u32 s55, s54, s19
  s_add_u32 s54, s54, 8
  s_waitcnt vmcnt(10)
  s_barrier
  s_waitcnt vmcnt(0)
  v_subrev_u32 v12, s0, v12
  v_xor_b32 v13, s1, v13
  v_subrev_u32 v12, 1, v12
  v_and_or_b32 v12, v12, -4, v13
  v_cmp_ne_u32 vcc, 0, v12
  s_nop 0
  s_cbranch_vccz Lse_pxx
  s_mov_b32 s60, 0
Lse_px:
  buffer_load_dwordx2 v[12:13], v10, s[12:15], s59 offen sc1
  s_add_u32 s60, s60, 1
  s_waitcnt vmcnt(0)
  v_subrev_u32 v12, s0, v12
  v_xor_b32 v13, s1, v13
  v_subrev_u32 v12, 1, v12
  v_and_or_b32 v12, v12, -4, v13
  v_cmp_ne_u32 vcc, 0, v12
  s_cmp_ge_u32 s60, 400000
  s_cbranch_scc1 Lse_pxx
  s_cbranch_vccz Lse_pxx
  s_sleep 2
  s_branch Lse_px
Lse_pxx:
  s_barrier
  s_mul_i32 s58, s19, 3072
  s_add_u32 s58, s58, s62
  s_add_u32 s59, s58, 12288
  s_add_u32 s60, s62, 24576
  s_cmp_eq_u32 s19, s33
  s_cselect_b32 s60, s60, 1073741824
  s_mov_b32 s61, 0
  v_mul_u32_u24 v8, 1152, v6
  v_lshl_add_u32 v8, v7, 4, v8
  s_mul_i32 s56, s28, 36864
  s_lshl_b32 s57, s55, 5
  s_add_u32 s57, s57, s56
  s_lshl_b32 s54, s54, 5
  s_add_u32 s56, s56, s54
  s_mov_b32 s63, 0x3ae38e39
  v_add_f32 v48, v48, v49
  v_add_f32 v48, v48, v50
  v_add_f32 v48, v48, v51
  v_add_f32 v48, v48, v52
  v_add_f32 v48, v48, v53
  v_add_f32 v48, v48, v54
  v_add_f32 v48, v48, v55
  v_add_f32 v48, v48, v56
  v_add_f32 v48, v48, v57
  v_mov_b32 v49, v48
  v_mov_b32 v50, 0x3727c5ac
  s_nop 0
  v_permlane32_swap_b32 v48, v49
  v_add_f32 v48, v48, v49
  v_fma_f32 v48, v48, s63, v50
  v_rcp_f32 v48, v48
  v_lshlrev_b32 v136, 16, v36
  v_and_b32 v137, 0xffff0000, v36
  v_lshlrev_b32 v138, 16, v37
  v_and_b32 v139, 0xffff0000, v37
  v_lshlrev_b32 v140, 16, v38
  v_and_b32 v141, 0xffff0000, v38
  v_lshlrev_b32 v142, 16, v39
  v_and_b32 v143, 0xffff0000, v39
  v_lshlrev_b32 v144, 16, v40
  v_and_b32 v145, 0xffff0000, v40
  v_lshlrev_b32 v146, 16, v41
  v_and_b32 v147, 0xffff0000, v41
  v_lshlrev_b32 v148, 16, v42
  v_and_b32 v149, 0xffff0000, v42
  v_lshlrev_b32 v150, 16, v43
  v_and_b32 v151, 0xffff0000, v43
  v_lshlrev_b32 v152, 16, v44
  v_and_b32 v153, 0xffff0000, v44
  v_lshlrev_b32 v154, 16, v45
  v_and_b32 v155, 0xffff0000, v45
  v_lshlrev_b32 v156, 16, v46
  v_and_b32 v157, 0xffff0000, v46
  v_lshlrev_b32 v158, 16, v47
  v_and_b32 v159, 0xffff0000, v47
  v_add_f32 v136, v136, v58
  v_add_f32 v137, v137, v58
  v_add_f32 v138, v138, v58
  v_add_f32 v139, v139, v58
  v_add_f32 v140, v140, v58
  v_add_f32 v141, v141, v58
  v_add_f32 v142, v142, v58
  v_add_f32 v143, v143, v58
  v_add_f32 v144, v144, v58
  v_add_f32 v145, v145, v58
  v_add_f32 v146, v146, v58
  v_add_f32 v147, v147, v58
  v_add_f32 v148, v148, v58
  v_add_f32 v149, v149, v58
  v_add_f32 v150, v150, v58
  v_add_f32 v151, v151, v58
  v_add_f32 v152, v152, v58
  v_add_f32 v153, v153, v58
  v_add_f32 v154, v154, v58
  v_add_f32 v155, v155, v58
  v_add_f32 v156, v156, v58
  v_add_f32 v157, v157, v58
  v_add_f32 v158, v158, v58
  v_add_f32 v159, v159, v58
  s_barrier
  buffer_load_dwordx4 v[64:67], v1, s[12:15], s58 offen offset:0 sc1
  buffer_load_dwordx4 v[68:71], v1, s[12:15], s58 offen offset:1024 sc1
  buffer_load_dwordx4 v[72:75], v1, s[12:15], s58 offen offset:2048 sc1
  s_barrier
  ds_read_b128 v[112:115], v11 offset:0
  ds_read_b128 v[116:119], v11 offset:1024
  ds_read_b128 v[120:123], v11 offset:2048
  ds_read_b128 v[124:127], v11 offset:3072
  ds_read_b128 v[128:131], v11 offset:4096
  ds_read_b128 v[132:135], v11 offset:5120
  s_waitcnt lgkmcnt(0)
  v_permlane16_swap_b32 v112, v116
  v_permlane16_swap_b32 v113, v117
  v_permlane16_swap_b32 v114, v118
  v_permlane16_swap_b32 v115, v119
  v_permlane16_swap_b32 v120, v124
  v_permlane16_swap_b32 v121, v125
  v_permlane16_swap_b32 v122, v126
  v_permlane16_swap_b32 v123, v127
  v_permlane16_swap_b32 v128, v132
  v_permlane16_swap_b32 v129, v133
  v_permlane16_swap_b32 v130, v134
  v_permlane16_swap_b32 v131, v135
  buffer_load_dwordx4 v[76:79], v1, s[12:15], s59 offen offset:0 sc1
  buffer_load_dwordx4 v[80:83], v1, s[12:15], s59 offen offset:1024 sc1
  buffer_load_dwordx4 v[84:87], v1, s[12:15], s59 offen offset:2048 sc1
  buffer_load_dwordx4 v[88:91], v1, s[12:15], s60 offen offset:0 sc1
  buffer_load_dwordx4 v[92:95], v1, s[12:15], s60 offen offset:1024 sc1
  buffer_load_dwordx4 v[96:99], v1, s[12:15], s60 offen offset:2048 sc1
  s_branch Lse_pollw
Lse_poll:
  buffer_load_dwordx4 v[64:67], v1, s[12:15], s58 offen offset:0 sc1
  buffer_load_dwordx4 v[68:71], v1, s[12:15], s58 offen offset:1024 sc1
  buffer_load_dwordx4 v[72:75], v1, s[12:15], s58 offen offset:2048 sc1
  buffer_load_dwordx4 v[76:79], v1, s[12:15], s59 offen offset:0 sc1
  buffer_load_dwordx4 v[80:83], v1, s[12:15], s59 offen offset:1024 sc1
  buffer_load_dwordx4 v[84:87], v1, s[12:15], s59 offen offset:2048 sc1
  buffer_load_dwordx4 v[88:91], v1, s[12:15], s60 offen offset:0 sc1
  buffer_load_dwordx4 v[92:95], v1, s[12:15], s60 offen offset:1024 sc1
  buffer_load_dwordx4 v[96:99], v1, s[12:15], s60 offen offset:2048 sc1
Lse_pollw:
  s_waitcnt vmcnt(0)
  v_max3_u32 v100, v64, v65, v66
  v_max3_u32 v101, v67, v68, v69
  v_max3_u32 v100, v100, v70, v71
  v_max3_u32 v101, v101, v72, v73
  v_max3_u32 v100, v100, v74, v75
  v_max3_u32 v101, v101, v76, v77
  v_max3_u32 v100, v100, v78, v79
  v_max3_u32 v101, v101, v80, v81
  v_max3_u32 v100, v100, v82, v83
  v_max3_u32 v101, v101, v84, v85
  v_max3_u32 v100, v100, v86, v87
  v_max3_u32 v101, v101, v88, v89
  v_max3_u32 v100, v100, v90, v91
  v_max3_u32 v101, v101, v92, v93
  v_max3_u32 v100, v100, v94, v95
  v_max3_u32 v101, v101, v96, v97
  v_max3_u32 v100, v100, v98, v99
  v_max_u32 v100, v100, v101
  v_cmp_eq_u32 vcc, -1, v100
  s_add_u32 s61, s61, 1
  s_cmp_ge_u32 s61, 400000
  s_cbranch_scc1 Lse_got
  s_cbranch_vccnz Lse_poll
Lse_got:
  v_lshlrev_b32 v100, 16, v64
  v_and_b32 v101, 0xffff0000, v64
  v_pk_add_f32 v[112:113], v[112:113], v[100:101]
  v_lshlrev_b32 v102, 16, v65
  v_and_b32 v103, 0xffff0000, v65
  v_pk_add_f32 v[114:115], v[114:115], v[102:103]
  v_lshlrev_b32 v100, 16, v66
  v_and_b32 v101, 0xffff0000, v66
  v_pk_add_f32 v[116:117], v[116:117], v[100:101]
  v_lshlrev_b32 v102, 16, v67
  v_and_b32 v103, 0xffff0000, v67
  v_pk_add_f32 v[118:119], v[118:119], v[102:103]
  v_lshlrev_b32 v100, 16, v68
  v_and_b32 v101, 0xffff0000, v68
  v_pk_add_f32 v[112:113], v[112:113], v[100:101]
  v_lshlrev_b32 v102, 16, v69
  v_and_b32 v103, 0xffff0000, v69
  v_pk_add_f32 v[114:115], v[114:115], v[102:103]
  v_lshlrev_b32 v100, 16, v70
  v_and_b32 v101, 0xffff0000, v70
  v_pk_add_f32 v[116:117], v[116:117], v[100:101]
  v_lshlrev_b32 v102, 16, v71
  v_and_b32 v103, 0xffff0000, v71
  v_pk_add_f32 v[118:119], v[118:119], v[102:103]
  v_lshlrev_b32 v100, 16, v72
  v_and_b32 v101, 0xffff0000, v72
  v_pk_add_f32 v[112:113], v[112:113], v[100:101]
  v_lshlrev_b32 v102, 16, v73
  v_and_b32 v103, 0xffff0000, v73
  v_pk_add_f32 v[114:115], v[114:115], v[102:103]
  v_lshlrev_b32 v100, 16, v74
  v_and_b32 v101, 0xffff0000, v74
  v_pk_add_f32 v[116:117], v[116:117], v[100:101]
  v_lshlrev_b32 v102, 16, v75
  v_and_b32 v103, 0xffff0000, v75
  v_pk_add_f32 v[118:119], v[118:119], v[102:103]
  v_pk_fma_f32 v[136:137], v[112:113], v[48:49], v[136:137] op_sel_hi:[1,0,1]
  v_cvt_pk_bf16_f32 v36, v136, v137
  v_pk_fma_f32 v[138:139], v[114:115], v[48:49], v[138:139] op_sel_hi:[1,0,1]
  v_cvt_pk_bf16_f32 v37, v138, v139
  v_pk_fma_f32 v[140:141], v[116:117], v[48:49], v[140:141] op_sel_hi:[1,0,1]
  v_cvt_pk_bf16_f32 v38, v140, v141
  v_pk_fma_f32 v[142:143], v[118:119], v[48:49], v[142:143] op_sel_hi:[1,0,1]
  v_cvt_pk_bf16_f32 v39, v142, v143
  buffer_store_dwordx4 v[36:39], v8, s[4:7], s57 offen offset:0 sc1
  v_lshlrev_b32 v100, 16, v76
  v_and_b32 v101, 0xffff0000, v76
  v_pk_add_f32 v[120:121], v[120:121], v[100:101]
  v_lshlrev_b32 v102, 16, v77
  v_and_b32 v103, 0xffff0000, v77
  v_pk_add_f32 v[122:123], v[122:123], v[102:103]
  v_lshlrev_b32 v100, 16, v78
  v_and_b32 v101, 0xffff0000, v78
  v_pk_add_f32 v[124:125], v[124:125], v[100:101]
  v_lshlrev_b32 v102, 16, v79
  v_and_b32 v103, 0xffff0000, v79
  v_pk_add_f32 v[126:127], v[126:127], v[102:103]
  v_lshlrev_b32 v100, 16, v80
  v_and_b32 v101, 0xffff0000, v80
  v_pk_add_f32 v[120:121], v[120:121], v[100:101]
  v_lshlrev_b32 v102, 16, v81
  v_and_b32 v103, 0xffff0000, v81
  v_pk_add_f32 v[122:123], v[122:123], v[102:103]
  v_lshlrev_b32 v100, 16, v82
  v_and_b32 v101, 0xffff0000, v82
  v_pk_add_f32 v[124:125], v[124:125], v[100:101]
  v_lshlrev_b32 v102, 16, v83
  v_and_b32 v103, 0xffff0000, v83
  v_pk_add_f32 v[126:127], v[126:127], v[102:103]
  v_lshlrev_b32 v100, 16, v84
  v_and_b32 v101, 0xffff0000, v84
  v_pk_add_f32 v[120:121], v[120:121], v[100:101]
  v_lshlrev_b32 v102, 16, v85
  v_and_b32 v103, 0xffff0000, v85
  v_pk_add_f32 v[122:123], v[122:123], v[102:103]
  v_lshlrev_b32 v100, 16, v86
  v_and_b32 v101, 0xffff0000, v86
  v_pk_add_f32 v[124:125], v[124:125], v[100:101]
  v_lshlrev_b32 v102, 16, v87
  v_and_b32 v103, 0xffff0000, v87
  v_pk_add_f32 v[126:127], v[126:127], v[102:103]
  v_pk_fma_f32 v[144:145], v[120:121], v[48:49], v[144:145] op_sel_hi:[1,0,1]
  v_cvt_pk_bf16_f32 v40, v144, v145
  v_pk_fma_f32 v[146:147], v[122:123], v[48:49], v[146:147] op_sel_hi:[1,0,1]
  v_cvt_pk_bf16_f32 v41, v146, v147
  v_pk_fma_f32 v[148:149], v[124:125], v[48:49], v[148:149] op_sel_hi:[1,0,1]
  v_cvt_pk_bf16_f32 v42, v148, v149
  v_pk_fma_f32 v[150:151], v[126:127], v[48:49], v[150:151] op_sel_hi:[1,0,1]
  v_cvt_pk_bf16_f32 v43, v150, v151
  buffer_store_dwordx4 v[40:43], v8, s[4:7], s57 offen offset:128 sc1
  s_cmp_lg_u32 s19, s33
  s_cbranch_scc1 Lse_fin
  v_lshlrev_b32 v100, 16, v88
  v_and_b32 v101, 0xffff0000, v88
  v_pk_add_f32 v[128:129], v[128:129], v[100:101]
  v_lshlrev_b32 v102, 16, v89
  v_and_b32 v103, 0xffff0000, v89
  v_pk_add_f32 v[130:131], v[130:131], v[102:103]
  v_lshlrev_b32 v100, 16, v90
  v_and_b32 v101, 0xffff0000, v90
  v_pk_add_f32 v[132:133], v[132:133], v[100:101]
  v_lshlrev_b32 v102, 16, v91
  v_and_b32 v103, 0xffff0000, v91
  v_pk_add_f32 v[134:135], v[134:135], v[102:103]
  v_lshlrev_b32 v100, 16, v92
  v_and_b32 v101, 0xffff0000, v92
  v_pk_add_f32 v[128:129], v[128:129], v[100:101]
  v_lshlrev_b32 v102, 16, v93
  v_and_b32 v103, 0xffff0000, v93
  v_pk_add_f32 v[130:131], v[130:131], v[102:103]
  v_lshlrev_b32 v100, 16, v94
  v_and_b32 v101, 0xffff0000, v94
  v_pk_add_f32 v[132:133], v[132:133], v[100:101]
  v_lshlrev_b32 v102, 16, v95
  v_and_b32 v103, 0xffff0000, v95
  v_pk_add_f32 v[134:135], v[134:135], v[102:103]
  v_lshlrev_b32 v100, 16, v96
  v_and_b32 v101, 0xffff0000, v96
  v_pk_add_f32 v[128:129], v[128:129], v[100:101]
  v_lshlrev_b32 v102, 16, v97
  v_and_b32 v103, 0xffff0000, v97
  v_pk_add_f32 v[130:131], v[130:131], v[102:103]
  v_lshlrev_b32 v100, 16, v98
  v_and_b32 v101, 0xffff0000, v98
  v_pk_add_f32 v[132:133], v[132:133], v[100:101]
  v_lshlrev_b32 v102, 16, v99
  v_and_b32 v103, 0xffff0000, v99
  v_pk_add_f32 v[134:135], v[134:135], v[102:103]
  v_pk_fma_f32 v[152:153], v[128:129], v[48:49], v[152:153] op_sel_hi:[1,0,1]
  v_cvt_pk_bf16_f32 v44, v152, v153
  v_pk_fma_f32 v[154:155], v[130:131], v[48:49], v[154:155] op_sel_hi:[1,0,1]
  v_cvt_pk_bf16_f32 v45, v154, v155
  v_pk_fma_f32 v[156:157], v[132:133], v[48:49], v[156:157] op_sel_hi:[1,0,1]
  v_cvt_pk_bf16_f32 v46, v156, v157
  v_pk_fma_f32 v[158:159], v[134:135], v[48:49], v[158:159] op_sel_hi:[1,0,1]
  v_cvt_pk_bf16_f32 v47, v158, v159
  buffer_store_dwordx4 v[44:47], v8, s[4:7], s56 offen offset:0 sc1
  s_branch Lse_fin
Lse_econs:
  s_lshl_b32 s20, s28, 9
  s_mul_i32 s29, s19, 4718592
  s_add_u32 s20, s20, s29
  s_add_u32 s20, s20, 35651584
  s_waitcnt vmcnt(5)
  v_subrev_u32 v32, s0, v32
  v_xor_b32 v33, s1, v33
  v_subrev_u32 v32, 1, v32
  v_and_or_b32 v32, v32, -4, v33
  v_cmp_ne_u32 vcc, 0, v32
  s_nop 0
  s_cbranch_vccz Lse_pdx
  s_mov_b32 s60, 0
Lse_pd:
  buffer_load_dwordx2 v[32:33], v2, s[12:15], s32 offen sc1
  s_add_u32 s60, s60, 1
  s_waitcnt vmcnt(0)
  v_subrev_u32 v32, s0, v32
  v_xor_b32 v33, s1, v33
  v_subrev_u32 v32, 1, v32
  v_and_or_b32 v32, v32, -4, v33
  v_cmp_ne_u32 vcc, 0, v32
  s_cmp_ge_u32 s60, 400000
  s_cbranch_scc1 Lse_pdx
  s_cbranch_vccz Lse_pdx
  s_sleep 2
  s_branch Lse_pd
Lse_pdx:
  s_waitcnt lgkmcnt(3)
  v_mfma_f32_16x16x32_bf16 v[16:19], v[64:67], v[112:115], 0
  ds_read_b128 v[84:87], v5 offset:5120
  v_mfma_f32_16x16x32_bf16 v[20:23], v[64:67], v[116:119], 0
  v_mov_b32 v12, 1
  v_mov_b32 v13, s1
  v_add_u32 v12, s0, v12
  v_lshlrev_b32 v14, 3, v0
  s_mov_b64 exec, 65535
  buffer_store_dwordx2 v[12:13], v14, s[12:15], s30 offen sc1
  s_mov_b64 exec, -1
  v_mfma_f32_16x16x32_bf16 v[24:27], v[68:71], v[112:115], 0
  ds_read_b128 v[64:67], v5 offset:6144
  v_mfma_f32_16x16x32_bf16 v[28:31], v[68:71], v[116:119], 0
  v_cvt_pk_bf16_f32 v88, v88, v89
  v_cvt_pk_bf16_f32 v89, v90, v91
  s_waitcnt lgkmcnt(3)
  v_mfma_f32_16x16x32_bf16 v[16:19], v[72:75], v[120:123], v[16:19]
  ds_read_b128 v[68:71], v5 offset:7168
  v_mfma_f32_16x16x32_bf16 v[20:23], v[72:75], v[124:127], v[20:23]
  v_cvt_pk_bf16_f32 v90, v92, v93
  v_cvt_pk_bf16_f32 v91, v94, v95
  s_nop 0
  v_mfma_f32_16x16x32_bf16 v[24:27], v[76:79], v[120:123], v[24:27]
  ds_read_b128 v[72:75], v5 offset:8192
  v_mfma_f32_16x16x32_bf16 v[28:31], v[76:79], v[124:127], v[28:31]
  v_permlane16_swap_b32 v88, v90
  v_permlane16_swap_b32 v89, v91
  s_waitcnt lgkmcnt(3)
  v_mfma_f32_16x16x32_bf16 v[16:19], v[80:83], v[128:131], v[16:19]
  ds_read_b128 v[76:79], v5 offset:9216
  v_mfma_f32_16x16x32_bf16 v[20:23], v[80:83], v[132:135], v[20:23]
  buffer_store_dwordx4 v[88:91], v3, s[12:15], s21 offen sc1
  s_add_u32 s21, s21, 65536
  v_mfma_f32_16x16x32_bf16 v[24:27], v[84:87], v[128:131], v[24:27]
  ds_read_b128 v[80:83], v5 offset:10240
  v_mfma_f32_16x16x32_bf16 v[28:31], v[84:87], v[132:135], v[28:31]
  s_cmp_ge_u32 s16, 4
  s_cbranch_scc1 Lse_nd5
  s_add_u32 m0, s24, s48
  s_add_u32 s22, s51, s58
  buffer_load_dwordx4 v1, s[12:15], s22 offen sc1 lds
Lse_nd5:
  s_waitcnt lgkmcnt(3)
  v_mfma_f32_16x16x32_bf16 v[16:19], v[64:67], v[136:139], v[16:19]
  ds_read_b128 v[84:87], v5 offset:11264
  v_mfma_f32_16x16x32_bf16 v[20:23], v[64:67], v[140:143], v[20:23]
  s_add_u32 m0, s24, s44
  s_add_u32 s22, s51, s54
  buffer_load_dwordx4 v1, s[12:15], s22 offen sc1 lds
  v_mfma_f32_16x16x32_bf16 v[24:27], v[68:71], v[136:139], v[24:27]
  ds_read_b128 v[64:67], v5 offset:12288
  v_mfma_f32_16x16x32_bf16 v[28:31], v[68:71], v[140:143], v[28:31]
  s_add_u32 m0, s24, s45
  s_add_u32 s22, s51, s55
  buffer_load_dwordx4 v1, s[12:15], s22 offen sc1 lds
  s_waitcnt lgkmcnt(3)
  v_mfma_f32_16x16x32_bf16 v[16:19], v[72:75], v[144:147], v[16:19]
  ds_read_b128 v[68:71], v5 offset:13312
  v_mfma_f32_16x16x32_bf16 v[20:23], v[72:75], v[148:151], v[20:23]
  s_add_u32 m0, s24, s46
  s_add_u32 s22, s51, s56
  buffer_load_dwordx4 v1, s[12:15], s22 offen sc1 lds
  v_mfma_f32_16x16x32_bf16 v[24:27], v[76:79], v[144:147], v[24:27]
  ds_read_b128 v[72:75], v5 offset:14336
  v_mfma_f32_16x16x32_bf16 v[28:31], v[76:79], v[148:151], v[28:31]
  s_add_u32 m0, s24, s47
  s_add_u32 s22, s51, s57
  buffer_load_dwordx4 v1, s[12:15], s22 offen sc1 lds
  s_waitcnt lgkmcnt(3)
  v_mfma_f32_16x16x32_bf16 v[16:19], v[80:83], v[152:155], v[16:19]
  ds_read_b128 v[76:79], v5 offset:15360
  v_mfma_f32_16x16x32_bf16 v[20:23], v[80:83], v[156:159], v[20:23]
  v_mfma_f32_16x16x32_bf16 v[24:27], v[84:87], v[152:155], v[24:27]
  ds_read_b128 v[80:83], v5 offset:16384
  v_mfma_f32_16x16x32_bf16 v[28:31], v[84:87], v[156:159], v[28:31]
  s_waitcnt lgkmcnt(3)
  v_mfma_f32_16x16x32_bf16 v[16:19], v[64:67], v[160:163], v[16:19]
  ds_read_b128 v[84:87], v5 offset:17408
  buffer_load_dwordx4 v[112:115], v4, s[12:15], s20 offen offset:0 sc1
  v_mfma_f32_16x16x32_bf16 v[20:23], v[64:67], v[164:167], v[20:23]
  v_mfma_f32_16x16x32_bf16 v[24:27], v[68:71], v[160:163], v[24:27]
  ds_read_b128 v[64:67], v5 offset:18432
  buffer_load_dwordx4 v[116:119], v4, s[12:15], s20 offen offset:256 sc1
  s_add_u32 s20, s20, 131072
  v_mfma_f32_16x16x32_bf16 v[28:31], v[68:71], v[164:167], v[28:31]
  s_waitcnt lgkmcnt(3)
  v_mfma_f32_16x16x32_bf16 v[16:19], v[72:75], v[168:171], v[16:19]
  ds_read_b128 v[68:71], v5 offset:19456
  v_mfma_f32_16x16x32_bf16 v[20:23], v[72:75], v[172:175], v[20:23]
  v_mfma_f32_16x16x32_bf16 v[24:27], v[76:79], v[168:171], v[24:27]
  ds_read_b128 v[72:75], v5 offset:20480
  v_mfma_f32_16x16x32_bf16 v[28:31], v[76:79], v[172:175], v[28:31]
  s_waitcnt lgkmcnt(3)
  v_mfma_f32_16x16x32_bf16 v[16:19], v[80:83], v[176:179], v[16:19]
  ds_read_b128 v[76:79], v5 offset:21504
  buffer_load_dwordx4 v[120:123], v4, s[12:15], s20 offen offset:0 sc1
  v_mfma_f32_16x16x32_bf16 v[20:23], v[80:83], v[180:183], v[20:23]
  v_mfma_f32_16x16x32_bf16 v[24:27], v[84:87], v[176:179], v[24:27]
  ds_read_b128 v[80:83], v5 offset:22528
  buffer_load_dwordx4 v[124:127], v4, s[12:15], s20 offen offset:256 sc1
  s_add_u32 s20, s20, 131072
  v_mfma_f32_16x16x32_bf16 v[28:31], v[84:87], v[180:183], v[28:31]
  s_waitcnt lgkmcnt(3)
  v_mfma_f32_16x16x32_bf16 v[16:19], v[64:67], v[184:187], v[16:19]
  ds_read_b128 v[84:87], v5 offset:23552
  v_mfma_f32_16x16x32_bf16 v[20:23], v[64:67], v[188:191], v[20:23]
  v_mfma_f32_16x16x32_bf16 v[24:27], v[68:71], v[184:187], v[24:27]
  ds_read_b128 v[64:67], v5 offset:24576
  v_mfma_f32_16x16x32_bf16 v[28:31], v[68:71], v[188:191], v[28:31]
  s_waitcnt lgkmcnt(3)
  v_mfma_f32_16x16x32_bf16 v[16:19], v[72:75], v[192:195], v[16:19]
  ds_read_b128 v[68:71], v5 offset:25600
  buffer_load_dwordx4 v[128:131], v4, s[12:15], s20 offen offset:0 sc1
  v_mfma_f32_16x16x32_bf16 v[20:23], v[72:75], v[196:199], v[20:23]
  v_mfma_f32_16x16x32_bf16 v[24:27], v[76:79], v[192:195], v[24:27]
  ds_read_b128 v[72:75], v5 offset:26624
  buffer_load_dwordx4 v[132:135], v4, s[12:15], s20 offen offset:256 sc1
  s_add_u32 s20, s20, 131072
  v_mfma_f32_16x16x32_bf16 v[28:31], v[76:79], v[196:199], v[28:31]
  s_waitcnt lgkmcnt(3)
  v_mfma_f32_16x16x32_bf16 v[16:19], v[80:83], v[200:203], v[16:19]
  ds_read_b128 v[76:79], v5 offset:27648
  v_mfma_f32_16x16x32_bf16 v[20:23], v[80:83], v[204:207], v[20:23]
  v_mfma_f32_16x16x32_bf16 v[24:27], v[84:87], v[200:203], v[24:27]
  ds_read_b128 v[80:83], v5 offset:28672
  v_mfma_f32_16x16x32_bf16 v[28:31], v[84:87], v[204:207], v[28:31]
  s_waitcnt lgkmcnt(3)
  v_mfma_f32_16x16x32_bf16 v[16:19], v[64:67], v[208:211], v[16:19]
  ds_read_b128 v[84:87], v5 offset:29696
  buffer_load_dwordx4 v[136:139], v4, s[12:15], s20 offen offset:0 sc1
  v_mfma_f32_16x16x32_bf16 v[20:23], v[64:67], v[212:215], v[20:23]
  v_mfma_f32_16x16x32_bf16 v[24:27], v[68:71], v[208:211], v[24:27]
  ds_read_b128 v[64:67], v5 offset:30720
  buffer_load_dwordx4 v[140:143], v4, s[12:15], s20 offen offset:256 sc1
  s_add_u32 s20, s20, 131072
  v_mfma_f32_16x16x32_bf16 v[28:31], v[68:71], v[212:215], v[28:31]
  s_waitcnt lgkmcnt(3)
  v_mfma_f32_16x16x32_bf16 v[16:19], v[72:75], v[216:219], v[16:19]
  ds_read_b128 v[68:71], v5 offset:31744
  v_mfma_f32_16x16x32_bf16 v[20:23], v[72:75], v[220:223], v[20:23]
  v_mfma_f32_16x16x32_bf16 v[24:27], v[76:79], v[216:219], v[24:27]
  ds_read_b128 v[72:75], v5 offset:32768
  v_mfma_f32_16x16x32_bf16 v[28:31], v[76:79], v[220:223], v[28:31]
  s_waitcnt lgkmcnt(3)
  v_mfma_f32_16x16x32_bf16 v[16:19], v[80:83], v[224:227], v[16:19]
  ds_read_b128 v[76:79], v5 offset:33792
  buffer_load_dwordx4 v[144:147], v4, s[12:15], s20 offen offset:0 sc1
  v_mfma_f32_16x16x32_bf16 v[20:23], v[80:83], v[228:231], v[20:23]
  v_mfma_f32_16x16x32_bf16 v[24:27], v[84:87], v[224:227], v[24:27]
  ds_read_b128 v[80:83], v5 offset:34816
  buffer_load_dwordx4 v[148:151], v4, s[12:15], s20 offen offset:256 sc1
  s_add_u32 s20, s20, 131072
  v_mfma_f32_16x16x32_bf16 v[28:31], v[84:87], v[228:231], v[28:31]
  s_waitcnt vmcnt(16) lgkmcnt(3)
  s_barrier
  v_mfma_f32_16x16x32_bf16 v[16:19], v[64:67], v[232:235], v[16:19]
  ds_read_b128 v[84:87], v5 offset:35840
  v_mfma_f32_16x16x32_bf16 v[20:23], v[64:67], v[236:239], v[20:23]
  v_mfma_f32_16x16x32_bf16 v[24:27], v[68:71], v[232:235], v[24:27]
  ds_read_b128 v[64:67], v6 offset:0
  v_mfma_f32_16x16x32_bf16 v[28:31], v[68:71], v[236:239], v[28:31]
  s_waitcnt lgkmcnt(3)
  v_mfma_f32_16x16x32_bf16 v[16:19], v[72:75], v[240:243], v[16:19]
  ds_read_b128 v[68:71], v6 offset:1024
  v_mfma_f32_16x16x32_bf16 v[20:23], v[72:75], v[244:247], v[20:23]
  v_mfma_f32_16x16x32_bf16 v[24:27], v[76:79], v[240:243], v[24:27]
  ds_read_b128 v[72:75], v6 offset:2048
  v_mfma_f32_16x16x32_bf16 v[28:31], v[76:79], v[244:247], v[28:31]
  s_waitcnt lgkmcnt(3)
  v_mfma_f32_16x16x32_bf16 v[16:19], v[80:83], v[248:251], v[16:19]
  ds_read_b128 v[76:79], v6 offset:3072
  v_mfma_f32_16x16x32_bf16 v[20:23], v[80:83], v[252:255], v[20:23]
  v_mfma_f32_16x16x32_bf16 v[24:27], v[84:87], v[248:251], v[24:27]
  ds_read_b128 v[80:83], v6 offset:4096
  v_mfma_f32_16x16x32_bf16 v[28:31], v[84:87], v[252:255], v[28:31]
  v_mov_b32 v5, v6
  v_add_u32 v6, s26, v1
  s_nop 5
  v_pk_mul_f32 v[88:89], v[16:17], v[24:25]
  v_pk_mul_f32 v[90:91], v[18:19], v[26:27]
  v_pk_mul_f32 v[92:93], v[20:21], v[28:29]
  v_pk_mul_f32 v[94:95], v[22:23], v[30:31]
  v_add_u32 v5, 36864, v1
  v_add_u32 v6, 73728, v1
  ds_read_b128 v[208:211], v5 offset:0
  ds_read_b128 v[212:215], v5 offset:1024
  ds_read_b128 v[216:219], v5 offset:2048
  ds_read_b128 v[220:223], v5 offset:3072
  ds_read_b128 v[224:227], v5 offset:4096
  ds_read_b128 v[228:231], v5 offset:5120
  ds_read_b128 v[232:235], v5 offset:6144
  ds_read_b128 v[236:239], v5 offset:7168
  v_cvt_pk_bf16_f32 v88, v88, v89
  v_cvt_pk_bf16_f32 v89, v90, v91
  v_cvt_pk_bf16_f32 v90, v92, v93
  v_cvt_pk_bf16_f32 v91, v94, v95
  s_nop 0
  v_permlane16_swap_b32 v88, v90
  v_permlane16_swap_b32 v89, v91
  s_mul_i32 s29, s16, 3072
  s_add_u32 s29, s29, 147456
  v_add_u32 v7, s29, v1
  ds_write_b128 v7, v[88:91] offset:0
  s_and_b32 s33, s16, 3
  s_add_u32 s40, s19, 0
  s_and_b32 s40, s40, 3
  s_lshl_b32 s44, s40, 10
  s_add_u32 s41, s19, 1
  s_and_b32 s41, s41, 3
  s_lshl_b32 s45, s41, 10
  s_add_u32 s42, s19, 2
  s_and_b32 s42, s42, 3
  s_lshl_b32 s46, s42, 10
  s_add_u32 s43, s19, 3
  s_and_b32 s43, s43, 3
  s_lshl_b32 s47, s43, 10
  s_mul_i32 s29, s33, 6144
  s_add_u32 s29, s29, 73728
  v_add_u32 v11, s29, v1
  s_mov_b32 s26, 73728
  s_mov_b32 s27, 0
  s_sub_u32 s52, s33, s19
  s_and_b32 s52, s52, 3
  s_lshl_b32 s52, s52, 10
  s_add_u32 s52, s52, s62
  s_add_u32 s52, s52, 23552
  s_mov_b32 s53, 0xfffefffe
  v_mov_b32 v14, 0
  v_pk_mul_f32 v[16:17], v[14:15], v[14:15] op_sel_hi:[0,0]
  v_pk_mul_f32 v[18:19], v[14:15], v[14:15] op_sel_hi:[0,0]
  v_pk_mul_f32 v[20:21], v[14:15], v[14:15] op_sel_hi:[0,0]
  v_pk_mul_f32 v[22:23], v[14:15], v[14:15] op_sel_hi:[0,0]
  v_pk_mul_f32 v[24:25], v[14:15], v[14:15] op_sel_hi:[0,0]
  v_pk_mul_f32 v[26:27], v[14:15], v[14:15] op_sel_hi:[0,0]
  v_pk_mul_f32 v[28:29], v[14:15], v[14:15] op_sel_hi:[0,0]
  v_pk_mul_f32 v[30:31], v[14:15], v[14:15] op_sel_hi:[0,0]
  v_pk_mul_f32 v[32:33], v[14:15], v[14:15] op_sel_hi:[0,0]
  v_pk_mul_f32 v[34:35], v[14:15], v[14:15] op_sel_hi:[0,0]
  v_pk_mul_f32 v[36:37], v[14:15], v[14:15] op_sel_hi:[0,0]
  v_pk_mul_f32 v[38:39], v[14:15], v[14:15] op_sel_hi:[0,0]
  v_pk_mul_f32 v[40:41], v[14:15], v[14:15] op_sel_hi:[0,0]
  v_pk_mul_f32 v[42:43], v[14:15], v[14:15] op_sel_hi:[0,0]
  v_pk_mul_f32 v[44:45], v[14:15], v[14:15] op_sel_hi:[0,0]
  v_pk_mul_f32 v[46:47], v[14:15], v[14:15] op_sel_hi:[0,0]
  v_pk_mul_f32 v[48:49], v[14:15], v[14:15] op_sel_hi:[0,0]
  v_pk_mul_f32 v[50:51], v[14:15], v[14:15] op_sel_hi:[0,0]
  v_pk_mul_f32 v[52:53], v[14:15], v[14:15] op_sel_hi:[0,0]
  v_pk_mul_f32 v[54:55], v[14:15], v[14:15] op_sel_hi:[0,0]
  v_pk_mul_f32 v[56:57], v[14:15], v[14:15] op_sel_hi:[0,0]
  v_pk_mul_f32 v[58:59], v[14:15], v[14:15] op_sel_hi:[0,0]
  v_pk_mul_f32 v[60:61], v[14:15], v[14:15] op_sel_hi:[0,0]
  v_pk_mul_f32 v[62:63], v[14:15], v[14:15] op_sel_hi:[0,0]
  s_waitcnt vmcnt(10) lgkmcnt(0)
  s_barrier
  v_pk_mul_f32 v[64:65], v[14:15], v[14:15] op_sel_hi:[0,0]
  v_pk_mul_f32 v[66:67], v[14:15], v[14:15] op_sel_hi:[0,0]
  v_pk_mul_f32 v[68:69], v[14:15], v[14:15] op_sel_hi:[0,0]
  v_pk_mul_f32 v[70:71], v[14:15], v[14:15] op_sel_hi:[0,0]
  v_pk_mul_f32 v[72:73], v[14:15], v[14:15] op_sel_hi:[0,0]
  v_pk_mul_f32 v[74:75], v[14:15], v[14:15] op_sel_hi:[0,0]
  v_pk_mul_f32 v[76:77], v[14:15], v[14:15] op_sel_hi:[0,0]
  v_pk_mul_f32 v[78:79], v[14:15], v[14:15] op_sel_hi:[0,0]
  v_pk_mul_f32 v[80:81], v[14:15], v[14:15] op_sel_hi:[0,0]
  v_pk_mul_f32 v[82:83], v[14:15], v[14:15] op_sel_hi:[0,0]
  v_pk_mul_f32 v[84:85], v[14:15], v[14:15] op_sel_hi:[0,0]
  v_pk_mul_f32 v[86:87], v[14:15], v[14:15] op_sel_hi:[0,0]
.p2align 6
Lse_eloop:
  s_waitcnt vmcnt(8) lgkmcnt(5)
  v_mfma_f32_16x16x32_bf16 v[16:19], v[208:211], v[112:115], v[16:19]
  ds_read_b128 v[240:243], v5 offset:8192
  v_mfma_f32_16x16x32_bf16 v[20:23], v[208:211], v[116:119], v[20:23]
  v_mfma_f32_16x16x32_bf16 v[24:27], v[212:215], v[112:115], v[24:27]
  ds_read_b128 v[208:211], v5 offset:9216
  v_mfma_f32_16x16x32_bf16 v[28:31], v[212:215], v[116:119], v[28:31]
  buffer_load_dwordx4 v[152:155], v4, s[12:15], s20 offen offset:0 sc1
  v_mfma_f32_16x16x32_bf16 v[32:35], v[216:219], v[112:115], v[32:35]
  ds_read_b128 v[212:215], v5 offset:10240
  v_mfma_f32_16x16x32_bf16 v[36:39], v[216:219], v[116:119], v[36:39]
  buffer_load_dwordx4 v[156:159], v4, s[12:15], s20 offen offset:256 sc1
  s_waitcnt lgkmcnt(5)
  v_mfma_f32_16x16x32_bf16 v[40:43], v[220:223], v[112:115], v[40:43]
  ds_read_b128 v[216:219], v5 offset:11264
  v_mfma_f32_16x16x32_bf16 v[44:47], v[220:223], v[116:119], v[44:47]
  s_add_u32 s20, s20, 131072
  v_mfma_f32_16x16x32_bf16 v[48:51], v[224:227], v[112:115], v[48:51]
  ds_read_b128 v[220:223], v5 offset:12288
  v_mfma_f32_16x16x32_bf16 v[52:55], v[224:227], v[116:119], v[52:55]
  v_mfma_f32_16x16x32_bf16 v[56:59], v[228:231], v[112:115], v[56:59]
  ds_read_b128 v[224:227], v5 offset:13312
  v_mfma_f32_16x16x32_bf16 v[60:63], v[228:231], v[116:119], v[60:63]
  s_waitcnt lgkmcnt(5)
  v_mfma_f32_16x16x32_bf16 v[64:67], v[232:235], v[112:115], v[64:67]
  ds_read_b128 v[228:231], v5 offset:14336
  v_mfma_f32_16x16x32_bf16 v[68:71], v[232:235], v[116:119], v[68:71]
  v_mfma_f32_16x16x32_bf16 v[72:75], v[236:239], v[112:115], v[72:75]
  ds_read_b128 v[232:235], v5 offset:15360
  v_mfma_f32_16x16x32_bf16 v[76:79], v[236:239], v[116:119], v[76:79]
  v_mfma_f32_16x16x32_bf16 v[80:83], v[240:243], v[112:115], v[80:83]
  ds_read_b128 v[236:239], v5 offset:16384
  v_mfma_f32_16x16x32_bf16 v[84:87], v[240:243], v[116:119], v[84:87]
  s_waitcnt vmcnt(8) lgkmcnt(5)
  v_mfma_f32_16x16x32_bf16 v[16:19], v[208:211], v[120:123], v[16:19]
  ds_read_b128 v[240:243], v5 offset:17408
  v_mfma_f32_16x16x32_bf16 v[20:23], v[208:211], v[124:127], v[20:23]
  v_mfma_f32_16x16x32_bf16 v[24:27], v[212:215], v[120:123], v[24:27]
  ds_read_b128 v[208:211], v5 offset:18432
  v_mfma_f32_16x16x32_bf16 v[28:31], v[212:215], v[124:127], v[28:31]
  buffer_load_dwordx4 v[160:163], v4, s[12:15], s20 offen offset:0 sc1
  v_mfma_f32_16x16x32_bf16 v[32:35], v[216:219], v[120:123], v[32:35]
  ds_read_b128 v[212:215], v5 offset:19456
  v_mfma_f32_16x16x32_bf16 v[36:39], v[216:219], v[124:127], v[36:39]
  buffer_load_dwordx4 v[164:167], v4, s[12:15], s20 offen offset:256 sc1
  s_waitcnt lgkmcnt(5)
  v_mfma_f32_16x16x32_bf16 v[40:43], v[220:223], v[120:123], v[40:43]
  ds_read_b128 v[216:219], v5 offset:20480
  v_mfma_f32_16x16x32_bf16 v[44:47], v[220:223], v[124:127], v[44:47]
  s_add_u32 s20, s20, 131072
  v_mfma_f32_16x16x32_bf16 v[48:51], v[224:227], v[120:123], v[48:51]
  ds_read_b128 v[220:223], v5 offset:21504
  v_mfma_f32_16x16x32_bf16 v[52:55], v[224:227], v[124:127], v[52:55]
  v_mfma_f32_16x16x32_bf16 v[56:59], v[228:231], v[120:123], v[56:59]
  ds_read_b128 v[224:227], v5 offset:22528
  v_mfma_f32_16x16x32_bf16 v[60:63], v[228:231], v[124:127], v[60:63]
  s_waitcnt lgkmcnt(5)
  v_mfma_f32_16x16x32_bf16 v[64:67], v[232:235], v[120:123], v[64:67]
  ds_read_b128 v[228:231], v5 offset:23552
  v_mfma_f32_16x16x32_bf16 v[68:71], v[232:235], v[124:127], v[68:71]
  v_mfma_f32_16x16x32_bf16 v[72:75], v[236:239], v[120:123], v[72:75]
  ds_read_b128 v[232:235], v5 offset:24576
  v_mfma_f32_16x16x32_bf16 v[76:79], v[236:239], v[124:127], v[76:79]
  v_mfma_f32_16x16x32_bf16 v[80:83], v[240:243], v[120:123], v[80:83]
  ds_read_b128 v[236:239], v5 offset:25600
  v_mfma_f32_16x16x32_bf16 v[84:87], v[240:243], v[124:127], v[84:87]
  s_waitcnt vmcnt(8) lgkmcnt(5)
  v_mfma_f32_16x16x32_bf16 v[16:19], v[208:211], v[128:131], v[16:19]
  ds_read_b128 v[240:243], v5 offset:26624
  v_mfma_f32_16x16x32_bf16 v[20:23], v[208:211], v[132:135], v[20:23]
  v_mfma_f32_16x16x32_bf16 v[24:27], v[212:215], v[128:131], v[24:27]
  ds_read_b128 v[208:211], v5 offset:27648
  v_mfma_f32_16x16x32_bf16 v[28:31], v[212:215], v[132:135], v[28:31]
  buffer_load_dwordx4 v[168:171], v4, s[12:15], s20 offen offset:0 sc1
  v_mfma_f32_16x16x32_bf16 v[32:35], v[216:219], v[128:131], v[32:35]
  ds_read_b128 v[212:215], v5 offset:28672
  v_mfma_f32_16x16x32_bf16 v[36:39], v[216:219], v[132:135], v[36:39]
  buffer_load_dwordx4 v[172:175], v4, s[12:15], s20 offen offset:256 sc1
  s_waitcnt lgkmcnt(5)
  v_mfma_f32_16x16x32_bf16 v[40:43], v[220:223], v[128:131], v[40:43]
  ds_read_b128 v[216:219], v5 offset:29696
  v_mfma_f32_16x16x32_bf16 v[44:47], v[220:223], v[132:135], v[44:47]
  s_add_u32 s20, s20, 131072
  v_mfma_f32_16x16x32_bf16 v[48:51], v[224:227], v[128:131], v[48:51]
  ds_read_b128 v[220:223], v5 offset:30720
  v_mfma_f32_16x16x32_bf16 v[52:55], v[224:227], v[132:135], v[52:55]
  v_mfma_f32_16x16x32_bf16 v[56:59], v[228:231], v[128:131], v[56:59]
  ds_read_b128 v[224:227], v5 offset:31744
  v_mfma_f32_16x16x32_bf16 v[60:63], v[228:231], v[132:135], v[60:63]
  s_waitcnt lgkmcnt(5)
  v_mfma_f32_16x16x32_bf16 v[64:67], v[232:235], v[128:131], v[64:67]
  ds_read_b128 v[228:231], v5 offset:32768
  v_mfma_f32_16x16x32_bf16 v[68:71], v[232:235], v[132:135], v[68:71]
  v_mfma_f32_16x16x32_bf16 v[72:75], v[236:239], v[128:131], v[72:75]
  ds_read_b128 v[232:235], v5 offset:33792
  v_mfma_f32_16x16x32_bf16 v[76:79], v[236:239], v[132:135], v[76:79]
  v_mfma_f32_16x16x32_bf16 v[80:83], v[240:243], v[128:131], v[80:83]
  ds_read_b128 v[236:239], v5 offset:34816
  v_mfma_f32_16x16x32_bf16 v[84:87], v[240:243], v[132:135], v[84:87]
  s_waitcnt vmcnt(8) lgkmcnt(5)
  s_barrier
  v_mfma_f32_16x16x32_bf16 v[16:19], v[208:211], v[136:139], v[16:19]
  ds_read_b128 v[240:243], v5 offset:35840
  v_mfma_f32_16x16x32_bf16 v[20:23], v[208:211], v[140:143], v[20:23]
  v_mfma_f32_16x16x32_bf16 v[24:27], v[212:215], v[136:139], v[24:27]
  ds_read_b128 v[208:211], v6 offset:0
  v_mfma_f32_16x16x32_bf16 v[28:31], v[212:215], v[140:143], v[28:31]
  buffer_load_dwordx4 v[176:179], v4, s[12:15], s20 offen offset:0 sc1
  v_mfma_f32_16x16x32_bf16 v[32:35], v[216:219], v[136:139], v[32:35]
  ds_read_b128 v[212:215], v6 offset:1024
  v_mfma_f32_16x16x32_bf16 v[36:39], v[216:219], v[140:143], v[36:39]
  buffer_load_dwordx4 v[180:183], v4, s[12:15], s20 offen offset:256 sc1
  s_waitcnt lgkmcnt(5)
  v_mfma_f32_16x16x32_bf16 v[40:43], v[220:223], v[136:139], v[40:43]
  ds_read_b128 v[216:219], v6 offset:2048
  v_mfma_f32_16x16x32_bf16 v[44:47], v[220:223], v[140:143], v[44:47]
  s_add_u32 s20, s20, 131072
  v_mfma_f32_16x16x32_bf16 v[48:51], v[224:227], v[136:139], v[48:51]
  ds_read_b128 v[220:223], v6 offset:3072
  v_mfma_f32_16x16x32_bf16 v[52:55], v[224:227], v[140:143], v[52:55]
  s_add_u32 s26, s26, 36864
  s_cmp_ge_u32 s26, 147456
  v_mfma_f32_16x16x32_bf16 v[56:59], v[228:231], v[136:139], v[56:59]
  ds_read_b128 v[224:227], v6 offset:4096
  v_mfma_f32_16x16x32_bf16 v[60:63], v[228:231], v[140:143], v[60:63]
  s_cselect_b32 s26, 0, s26
  s_waitcnt lgkmcnt(5)
  v_mfma_f32_16x16x32_bf16 v[64:67], v[232:235], v[136:139], v[64:67]
  ds_read_b128 v[228:231], v6 offset:5120
  v_mfma_f32_16x16x32_bf16 v[68:71], v[232:235], v[140:143], v[68:71]
  v_mfma_f32_16x16x32_bf16 v[72:75], v[236:239], v[136:139], v[72:75]
  ds_read_b128 v[232:235], v6 offset:6144
  v_mfma_f32_16x16x32_bf16 v[76:79], v[236:239], v[140:143], v[76:79]
  v_mfma_f32_16x16x32_bf16 v[80:83], v[240:243], v[136:139], v[80:83]
  ds_read_b128 v[236:239], v6 offset:7168
  v_mfma_f32_16x16x32_bf16 v[84:87], v[240:243], v[140:143], v[84:87]
  v_mov_b32 v5, v6
  v_add_u32 v6, s26, v1
  s_waitcnt vmcnt(8) lgkmcnt(5)
  v_mfma_f32_16x16x32_bf16 v[16:19], v[208:211], v[144:147], v[16:19]
  ds_read_b128 v[240:243], v5 offset:8192
  v_mfma_f32_16x16x32_bf16 v[20:23], v[208:211], v[148:151], v[20:23]
  v_mfma_f32_16x16x32_bf16 v[24:27], v[212:215], v[144:147], v[24:27]
  ds_read_b128 v[208:211], v5 offset:9216
  v_mfma_f32_16x16x32_bf16 v[28:31], v[212:215], v[148:151], v[28:31]
  buffer_load_dwordx4 v[184:187], v4, s[12:15], s20 offen offset:0 sc1
  v_mfma_f32_16x16x32_bf16 v[32:35], v[216:219], v[144:147], v[32:35]
  ds_read_b128 v[212:215], v5 offset:10240
  v_mfma_f32_16x16x32_bf16 v[36:39], v[216:219], v[148:151], v[36:39]
  buffer_load_dwordx4 v[188:191], v4, s[12:15], s20 offen offset:256 sc1
  s_waitcnt lgkmcnt(5)
  v_mfma_f32_16x16x32_bf16 v[40:43], v[220:223], v[144:147], v[40:43]
  ds_read_b128 v[216:219], v5 offset:11264
  v_mfma_f32_16x16x32_bf16 v[44:47], v[220:223], v[148:151], v[44:47]
  s_add_u32 s20, s20, 131072
  v_mfma_f32_16x16x32_bf16 v[48:51], v[224:227], v[144:147], v[48:51]
  ds_read_b128 v[220:223], v5 offset:12288
  v_mfma_f32_16x16x32_bf16 v[52:55], v[224:227], v[148:151], v[52:55]
  v_mfma_f32_16x16x32_bf16 v[56:59], v[228:231], v[144:147], v[56:59]
  ds_read_b128 v[224:227], v5 offset:13312
  v_mfma_f32_16x16x32_bf16 v[60:63], v[228:231], v[148:151], v[60:63]
  s_waitcnt lgkmcnt(5)
  v_mfma_f32_16x16x32_bf16 v[64:67], v[232:235], v[144:147], v[64:67]
  ds_read_b128 v[228:231], v5 offset:14336
  v_mfma_f32_16x16x32_bf16 v[68:71], v[232:235], v[148:151], v[68:71]
  v_mfma_f32_16x16x32_bf16 v[72:75], v[236:239], v[144:147], v[72:75]
  ds_read_b128 v[232:235], v5 offset:15360
  v_mfma_f32_16x16x32_bf16 v[76:79], v[236:239], v[148:151], v[76:79]
  v_mfma_f32_16x16x32_bf16 v[80:83], v[240:243], v[144:147], v[80:83]
  ds_read_b128 v[236:239], v5 offset:16384
  v_mfma_f32_16x16x32_bf16 v[84:87], v[240:243], v[148:151], v[84:87]
  s_waitcnt vmcnt(8) lgkmcnt(5)
  v_mfma_f32_16x16x32_bf16 v[16:19], v[208:211], v[152:155], v[16:19]
  ds_read_b128 v[240:243], v5 offset:17408
  v_mfma_f32_16x16x32_bf16 v[20:23], v[208:211], v[156:159], v[20:23]
  v_mfma_f32_16x16x32_bf16 v[24:27], v[212:215], v[152:155], v[24:27]
  ds_read_b128 v[208:211], v5 offset:18432
  v_mfma_f32_16x16x32_bf16 v[28:31], v[212:215], v[156:159], v[28:31]
  buffer_load_dwordx4 v[192:195], v4, s[12:15], s20 offen offset:0 sc1
  v_mfma_f32_16x16x32_bf16 v[32:35], v[216:219], v[152:155], v[32:35]
  ds_read_b128 v[212:215], v5 offset:19456
  v_mfma_f32_16x16x32_bf16 v[36:39], v[216:219], v[156:159], v[36:39]
  buffer_load_dwordx4 v[196:199], v4, s[12:15], s20 offen offset:256 sc1
  s_waitcnt lgkmcnt(5)
  v_mfma_f32_16x16x32_bf16 v[40:43], v[220:223], v[152:155], v[40:43]
  ds_read_b128 v[216:219], v5 offset:20480
  v_mfma_f32_16x16x32_bf16 v[44:47], v[220:223], v[156:159], v[44:47]
  s_add_u32 s20, s20, 131072
  v_mfma_f32_16x16x32_bf16 v[48:51], v[224:227], v[152:155], v[48:51]
  ds_read_b128 v[220:223], v5 offset:21504
  v_mfma_f32_16x16x32_bf16 v[52:55], v[224:227], v[156:159], v[52:55]
  v_mfma_f32_16x16x32_bf16 v[56:59], v[228:231], v[152:155], v[56:59]
  ds_read_b128 v[224:227], v5 offset:22528
  v_mfma_f32_16x16x32_bf16 v[60:63], v[228:231], v[156:159], v[60:63]
  s_waitcnt lgkmcnt(5)
  v_mfma_f32_16x16x32_bf16 v[64:67], v[232:235], v[152:155], v[64:67]
  ds_read_b128 v[228:231], v5 offset:23552
  v_mfma_f32_16x16x32_bf16 v[68:71], v[232:235], v[156:159], v[68:71]
  v_mfma_f32_16x16x32_bf16 v[72:75], v[236:239], v[152:155], v[72:75]
  ds_read_b128 v[232:235], v5 offset:24576
  v_mfma_f32_16x16x32_bf16 v[76:79], v[236:239], v[156:159], v[76:79]
  v_mfma_f32_16x16x32_bf16 v[80:83], v[240:243], v[152:155], v[80:83]
  ds_read_b128 v[236:239], v5 offset:25600
  v_mfma_f32_16x16x32_bf16 v[84:87], v[240:243], v[156:159], v[84:87]
  s_waitcnt vmcnt(8) lgkmcnt(5)
  v_mfma_f32_16x16x32_bf16 v[16:19], v[208:211], v[160:163], v[16:19]
  ds_read_b128 v[240:243], v5 offset:26624
  v_mfma_f32_16x16x32_bf16 v[20:23], v[208:211], v[164:167], v[20:23]
  v_mfma_f32_16x16x32_bf16 v[24:27], v[212:215], v[160:163], v[24:27]
  ds_read_b128 v[208:211], v5 offset:27648
  v_mfma_f32_16x16x32_bf16 v[28:31], v[212:215], v[164:167], v[28:31]
  buffer_load_dwordx4 v[200:203], v4, s[12:15], s20 offen offset:0 sc1
  v_mfma_f32_16x16x32_bf16 v[32:35], v[216:219], v[160:163], v[32:35]
  ds_read_b128 v[212:215], v5 offset:28672
  v_mfma_f32_16x16x32_bf16 v[36:39], v[216:219], v[164:167], v[36:39]
  buffer_load_dwordx4 v[204:207], v4, s[12:15], s20 offen offset:256 sc1
  s_waitcnt lgkmcnt(5)
  v_mfma_f32_16x16x32_bf16 v[40:43], v[220:223], v[160:163], v[40:43]
  ds_read_b128 v[216:219], v5 offset:29696
  v_mfma_f32_16x16x32_bf16 v[44:47], v[220:223], v[164:167], v[44:47]
  s_add_u32 s20, s20, 131072
  v_mfma_f32_16x16x32_bf16 v[48:51], v[224:227], v[160:163], v[48:51]
  ds_read_b128 v[220:223], v5 offset:30720
  v_mfma_f32_16x16x32_bf16 v[52:55], v[224:227], v[164:167], v[52:55]
  v_mfma_f32_16x16x32_bf16 v[56:59], v[228:231], v[160:163], v[56:59]
  ds_read_b128 v[224:227], v5 offset:31744
  v_mfma_f32_16x16x32_bf16 v[60:63], v[228:231], v[164:167], v[60:63]
  s_waitcnt lgkmcnt(5)
  v_mfma_f32_16x16x32_bf16 v[64:67], v[232:235], v[160:163], v[64:67]
  ds_read_b128 v[228:231], v5 offset:32768
  v_mfma_f32_16x16x32_bf16 v[68:71], v[232:235], v[164:167], v[68:71]
  v_mfma_f32_16x16x32_bf16 v[72:75], v[236:239], v[160:163], v[72:75]
  ds_read_b128 v[232:235], v5 offset:33792
  v_mfma_f32_16x16x32_bf16 v[76:79], v[236:239], v[164:167], v[76:79]
  v_mfma_f32_16x16x32_bf16 v[80:83], v[240:243], v[160:163], v[80:83]
  ds_read_b128 v[236:239], v5 offset:34816
  v_mfma_f32_16x16x32_bf16 v[84:87], v[240:243], v[164:167], v[84:87]
  s_waitcnt vmcnt(8) lgkmcnt(5)
  s_barrier
  v_mfma_f32_16x16x32_bf16 v[16:19], v[208:211], v[168:171], v[16:19]
  ds_read_b128 v[240:243], v5 offset:35840
  v_mfma_f32_16x16x32_bf16 v[20:23], v[208:211], v[172:175], v[20:23]
  v_mfma_f32_16x16x32_bf16 v[24:27], v[212:215], v[168:171], v[24:27]
  ds_read_b128 v[208:211], v6 offset:0
  v_mfma_f32_16x16x32_bf16 v[28:31], v[212:215], v[172:175], v[28:31]
  s_add_u32 s27, s27, 1
  s_cmp_ge_u32 s27, 3
  v_mfma_f32_16x16x32_bf16 v[32:35], v[216:219], v[168:171], v[32:35]
  ds_read_b128 v[212:215], v6 offset:1024
  v_mfma_f32_16x16x32_bf16 v[36:39], v[216:219], v[172:175], v[36:39]
  s_cselect_b32 s20, 1073741824, s20
  s_waitcnt lgkmcnt(5)
  v_mfma_f32_16x16x32_bf16 v[40:43], v[220:223], v[168:171], v[40:43]
  ds_read_b128 v[216:219], v6 offset:2048
  v_mfma_f32_16x16x32_bf16 v[44:47], v[220:223], v[172:175], v[44:47]
  buffer_load_dwordx4 v[112:115], v4, s[12:15], s20 offen offset:0 sc1
  v_mfma_f32_16x16x32_bf16 v[48:51], v[224:227], v[168:171], v[48:51]
  ds_read_b128 v[220:223], v6 offset:3072
  v_mfma_f32_16x16x32_bf16 v[52:55], v[224:227], v[172:175], v[52:55]
  buffer_load_dwordx4 v[116:119], v4, s[12:15], s20 offen offset:256 sc1
  v_mfma_f32_16x16x32_bf16 v[56:59], v[228:231], v[168:171], v[56:59]
  ds_read_b128 v[224:227], v6 offset:4096
  v_mfma_f32_16x16x32_bf16 v[60:63], v[228:231], v[172:175], v[60:63]
  s_add_u32 s20, s20, 131072
  s_waitcnt lgkmcnt(5)
  v_mfma_f32_16x16x32_bf16 v[64:67], v[232:235], v[168:171], v[64:67]
  ds_read_b128 v[228:231], v6 offset:5120
  v_mfma_f32_16x16x32_bf16 v[68:71], v[232:235], v[172:175], v[68:71]
  s_add_u32 s26, s26, 36864
  s_cmp_ge_u32 s26, 147456
  v_mfma_f32_16x16x32_bf16 v[72:75], v[236:239], v[168:171], v[72:75]
  ds_read_b128 v[232:235], v6 offset:6144
  v_mfma_f32_16x16x32_bf16 v[76:79], v[236:239], v[172:175], v[76:79]
  s_cselect_b32 s26, 0, s26
  v_mfma_f32_16x16x32_bf16 v[80:83], v[240:243], v[168:171], v[80:83]
  ds_read_b128 v[236:239], v6 offset:7168
  v_mfma_f32_16x16x32_bf16 v[84:87], v[240:243], v[172:175], v[84:87]
  v_mov_b32 v5, v6
  v_add_u32 v6, s26, v1
  s_waitcnt vmcnt(8) lgkmcnt(5)
  v_mfma_f32_16x16x32_bf16 v[16:19], v[208:211], v[176:179], v[16:19]
  ds_read_b128 v[240:243], v5 offset:8192
  v_mfma_f32_16x16x32_bf16 v[20:23], v[208:211], v[180:183], v[20:23]
  v_mfma_f32_16x16x32_bf16 v[24:27], v[212:215], v[176:179], v[24:27]
  ds_read_b128 v[208:211], v5 offset:9216
  v_mfma_f32_16x16x32_bf16 v[28:31], v[212:215], v[180:183], v[28:31]
  buffer_load_dwordx4 v[120:123], v4, s[12:15], s20 offen offset:0 sc1
  v_mfma_f32_16x16x32_bf16 v[32:35], v[216:219], v[176:179], v[32:35]
  ds_read_b128 v[212:215], v5 offset:10240
  v_mfma_f32_16x16x32_bf16 v[36:39], v[216:219], v[180:183], v[36:39]
  buffer_load_dwordx4 v[124:127], v4, s[12:15], s20 offen offset:256 sc1
  s_waitcnt lgkmcnt(5)
  v_mfma_f32_16x16x32_bf16 v[40:43], v[220:223], v[176:179], v[40:43]
  ds_read_b128 v[216:219], v5 offset:11264
  v_mfma_f32_16x16x32_bf16 v[44:47], v[220:223], v[180:183], v[44:47]
  s_add_u32 s20, s20, 131072
  v_mfma_f32_16x16x32_bf16 v[48:51], v[224:227], v[176:179], v[48:51]
  ds_read_b128 v[220:223], v5 offset:12288
  v_mfma_f32_16x16x32_bf16 v[52:55], v[224:227], v[180:183], v[52:55]
  v_mfma_f32_16x16x32_bf16 v[56:59], v[228:231], v[176:179], v[56:59]
  ds_read_b128 v[224:227], v5 offset:13312
  v_mfma_f32_16x16x32_bf16 v[60:63], v[228:231], v[180:183], v[60:63]
  s_waitcnt lgkmcnt(5)
  v_mfma_f32_16x16x32_bf16 v[64:67], v[232:235], v[176:179], v[64:67]
  ds_read_b128 v[228:231], v5 offset:14336
  v_mfma_f32_16x16x32_bf16 v[68:71], v[232:235], v[180:183], v[68:71]
  v_mfma_f32_16x16x32_bf16 v[72:75], v[236:239], v[176:179], v[72:75]
  ds_read_b128 v[232:235], v5 offset:15360
  v_mfma_f32_16x16x32_bf16 v[76:79], v[236:239], v[180:183], v[76:79]
  v_mfma_f32_16x16x32_bf16 v[80:83], v[240:243], v[176:179], v[80:83]
  ds_read_b128 v[236:239], v5 offset:16384
  v_mfma_f32_16x16x32_bf16 v[84:87], v[240:243], v[180:183], v[84:87]
  s_waitcnt vmcnt(8) lgkmcnt(5)
  v_mfma_f32_16x16x32_bf16 v[16:19], v[208:211], v[184:187], v[16:19]
  ds_read_b128 v[240:243], v5 offset:17408
  v_mfma_f32_16x16x32_bf16 v[20:23], v[208:211], v[188:191], v[20:23]
  v_mfma_f32_16x16x32_bf16 v[24:27], v[212:215], v[184:187], v[24:27]
  ds_read_b128 v[208:211], v5 offset:18432
  v_mfma_f32_16x16x32_bf16 v[28:31], v[212:215], v[188:191], v[28:31]
  buffer_load_dwordx4 v[128:131], v4, s[12:15], s20 offen offset:0 sc1
  v_mfma_f32_16x16x32_bf16 v[32:35], v[216:219], v[184:187], v[32:35]
  ds_read_b128 v[212:215], v5 offset:19456
  v_mfma_f32_16x16x32_bf16 v[36:39], v[216:219], v[188:191], v[36:39]
  buffer_load_dwordx4 v[132:135], v4, s[12:15], s20 offen offset:256 sc1
  s_waitcnt lgkmcnt(5)
  v_mfma_f32_16x16x32_bf16 v[40:43], v[220:223], v[184:187], v[40:43]
  ds_read_b128 v[216:219], v5 offset:20480
  v_mfma_f32_16x16x32_bf16 v[44:47], v[220:223], v[188:191], v[44:47]
  s_add_u32 s20, s20, 131072
  v_mfma_f32_16x16x32_bf16 v[48:51], v[224:227], v[184:187], v[48:51]
  ds_read_b128 v[220:223], v5 offset:21504
  v_mfma_f32_16x16x32_bf16 v[52:55], v[224:227], v[188:191], v[52:55]
  v_mfma_f32_16x16x32_bf16 v[56:59], v[228:231], v[184:187], v[56:59]
  ds_read_b128 v[224:227], v5 offset:22528
  v_mfma_f32_16x16x32_bf16 v[60:63], v[228:231], v[188:191], v[60:63]
  s_waitcnt lgkmcnt(5)
  v_mfma_f32_16x16x32_bf16 v[64:67], v[232:235], v[184:187], v[64:67]
  ds_read_b128 v[228:231], v5 offset:23552
  v_mfma_f32_16x16x32_bf16 v[68:71], v[232:235], v[188:191], v[68:71]
  v_mfma_f32_16x16x32_bf16 v[72:75], v[236:239], v[184:187], v[72:75]
  ds_read_b128 v[232:235], v5 offset:24576
  v_mfma_f32_16x16x32_bf16 v[76:79], v[236:239], v[188:191], v[76:79]
  v_mfma_f32_16x16x32_bf16 v[80:83], v[240:243], v[184:187], v[80:83]
  ds_read_b128 v[236:239], v5 offset:25600
  v_mfma_f32_16x16x32_bf16 v[84:87], v[240:243], v[188:191], v[84:87]
  s_waitcnt vmcnt(8) lgkmcnt(5)
  v_mfma_f32_16x16x32_bf16 v[16:19], v[208:211], v[192:195], v[16:19]
  ds_read_b128 v[240:243], v5 offset:26624
  v_mfma_f32_16x16x32_bf16 v[20:23], v[208:211], v[196:199], v[20:23]
  v_mfma_f32_16x16x32_bf16 v[24:27], v[212:215], v[192:195], v[24:27]
  ds_read_b128 v[208:211], v5 offset:27648
  v_mfma_f32_16x16x32_bf16 v[28:31], v[212:215], v[196:199], v[28:31]
  buffer_load_dwordx4 v[136:139], v4, s[12:15], s20 offen offset:0 sc1
  v_mfma_f32_16x16x32_bf16 v[32:35], v[216:219], v[192:195], v[32:35]
  ds_read_b128 v[212:215], v5 offset:28672
  v_mfma_f32_16x16x32_bf16 v[36:39], v[216:219], v[196:199], v[36:39]
  buffer_load_dwordx4 v[140:143], v4, s[12:15], s20 offen offset:256 sc1
  s_waitcnt lgkmcnt(5)
  v_mfma_f32_16x16x32_bf16 v[40:43], v[220:223], v[192:195], v[40:43]
  ds_read_b128 v[216:219], v5 offset:29696
  v_mfma_f32_16x16x32_bf16 v[44:47], v[220:223], v[196:199], v[44:47]
  s_add_u32 s20, s20, 131072
  v_mfma_f32_16x16x32_bf16 v[48:51], v[224:227], v[192:195], v[48:51]
  ds_read_b128 v[220:223], v5 offset:30720
  v_mfma_f32_16x16x32_bf16 v[52:55], v[224:227], v[196:199], v[52:55]
  v_mfma_f32_16x16x32_bf16 v[56:59], v[228:231], v[192:195], v[56:59]
  ds_read_b128 v[224:227], v5 offset:31744
  v_mfma_f32_16x16x32_bf16 v[60:63], v[228:231], v[196:199], v[60:63]
  s_waitcnt lgkmcnt(5)
  v_mfma_f32_16x16x32_bf16 v[64:67], v[232:235], v[192:195], v[64:67]
  ds_read_b128 v[228:231], v5 offset:32768
  v_mfma_f32_16x16x32_bf16 v[68:71], v[232:235], v[196:199], v[68:71]
  v_mfma_f32_16x16x32_bf16 v[72:75], v[236:239], v[192:195], v[72:75]
  ds_read_b128 v[232:235], v5 offset:33792
  v_mfma_f32_16x16x32_bf16 v[76:79], v[236:239], v[196:199], v[76:79]
  v_mfma_f32_16x16x32_bf16 v[80:83], v[240:243], v[192:195], v[80:83]
  ds_read_b128 v[236:239], v5 offset:34816
  v_mfma_f32_16x16x32_bf16 v[84:87], v[240:243], v[196:199], v[84:87]
  s_waitcnt vmcnt(8) lgkmcnt(5)
  s_barrier
  v_mfma_f32_16x16x32_bf16 v[16:19], v[208:211], v[200:203], v[16:19]
  ds_read_b128 v[240:243], v5 offset:35840
  v_mfma_f32_16x16x32_bf16 v[20:23], v[208:211], v[204:207], v[20:23]
  v_mfma_f32_16x16x32_bf16 v[24:27], v[212:215], v[200:203], v[24:27]
  ds_read_b128 v[208:211], v6 offset:0
  v_mfma_f32_16x16x32_bf16 v[28:31], v[212:215], v[204:207], v[28:31]
  buffer_load_dwordx4 v[144:147], v4, s[12:15], s20 offen offset:0 sc1
  v_mfma_f32_16x16x32_bf16 v[32:35], v[216:219], v[200:203], v[32:35]
  ds_read_b128 v[212:215], v6 offset:1024
  v_mfma_f32_16x16x32_bf16 v[36:39], v[216:219], v[204:207], v[36:39]
  buffer_load_dwordx4 v[148:151], v4, s[12:15], s20 offen offset:256 sc1
  s_waitcnt lgkmcnt(5)
  v_mfma_f32_16x16x32_bf16 v[40:43], v[220:223], v[200:203], v[40:43]
  ds_read_b128 v[216:219], v6 offset:2048
  v_mfma_f32_16x16x32_bf16 v[44:47], v[220:223], v[204:207], v[44:47]
  s_add_u32 s20, s20, 131072
  v_mfma_f32_16x16x32_bf16 v[48:51], v[224:227], v[200:203], v[48:51]
  ds_read_b128 v[220:223], v6 offset:3072
  v_mfma_f32_16x16x32_bf16 v[52:55], v[224:227], v[204:207], v[52:55]
  s_add_u32 s26, s26, 36864
  s_cmp_ge_u32 s26, 147456
  v_mfma_f32_16x16x32_bf16 v[56:59], v[228:231], v[200:203], v[56:59]
  ds_read_b128 v[224:227], v6 offset:4096
  v_mfma_f32_16x16x32_bf16 v[60:63], v[228:231], v[204:207], v[60:63]
  s_cselect_b32 s26, 0, s26
  s_waitcnt lgkmcnt(5)
  v_mfma_f32_16x16x32_bf16 v[64:67], v[232:235], v[200:203], v[64:67]
  ds_read_b128 v[228:231], v6 offset:5120
  v_mfma_f32_16x16x32_bf16 v[68:71], v[232:235], v[204:207], v[68:71]
  v_mfma_f32_16x16x32_bf16 v[72:75], v[236:239], v[200:203], v[72:75]
  ds_read_b128 v[232:235], v6 offset:6144
  v_mfma_f32_16x16x32_bf16 v[76:79], v[236:239], v[204:207], v[76:79]
  v_mfma_f32_16x16x32_bf16 v[80:83], v[240:243], v[200:203], v[80:83]
  ds_read_b128 v[236:239], v6 offset:7168
  v_mfma_f32_16x16x32_bf16 v[84:87], v[240:243], v[204:207], v[84:87]
  v_mov_b32 v5, v6
  v_add_u32 v6, s26, v1
  s_cmp_lt_u32 s27, 2
  s_cbranch_scc1 Lse_eloop
Lse_elast:
  v_add_u32 v7, 36864, v1
  s_cmp_eq_u32 s19, s33
  s_cselect_b32 s52, 1073741824, s52
  s_waitcnt vmcnt(8) lgkmcnt(7)
  v_mfma_f32_16x16x32_bf16 v[16:19], v[208:211], v[112:115], v[16:19]
  ds_read_b128 v[240:243], v5 offset:8192
  v_mfma_f32_16x16x32_bf16 v[20:23], v[208:211], v[116:119], v[20:23]
  buffer_load_dwordx4 v[152:155], v4, s[12:15], s20 offen offset:0 sc1
  s_waitcnt lgkmcnt(7)
  v_mfma_f32_16x16x32_bf16 v[24:27], v[212:215], v[112:115], v[24:27]
  ds_read_b128 v[208:211], v5 offset:10240
  v_mfma_f32_16x16x32_bf16 v[28:31], v[212:215], v[116:119], v[28:31]
  buffer_load_dwordx4 v[156:159], v4, s[12:15], s20 offen offset:256 sc1
  s_waitcnt lgkmcnt(7)
  v_mfma_f32_16x16x32_bf16 v[32:35], v[216:219], v[112:115], v[32:35]
  ds_read_b128 v[212:215], v5 offset:11264
  v_mfma_f32_16x16x32_bf16 v[36:39], v[216:219], v[116:119], v[36:39]
  s_add_u32 s20, s20, 131072
  s_waitcnt lgkmcnt(7)
  v_mfma_f32_16x16x32_bf16 v[40:43], v[220:223], v[112:115], v[40:43]
  ds_read_b128 v[216:219], v5 offset:12288
  v_mfma_f32_16x16x32_bf16 v[44:47], v[220:223], v[116:119], v[44:47]
  s_waitcnt lgkmcnt(7)
  v_mfma_f32_16x16x32_bf16 v[48:51], v[224:227], v[112:115], v[48:51]
  ds_read_b128 v[220:223], v5 offset:14336
  v_mfma_f32_16x16x32_bf16 v[52:55], v[224:227], v[116:119], v[52:55]
  s_waitcnt lgkmcnt(7)
  v_mfma_f32_16x16x32_bf16 v[56:59], v[228:231], v[112:115], v[56:59]
  ds_read_b128 v[224:227], v5 offset:15360
  v_mfma_f32_16x16x32_bf16 v[60:63], v[228:231], v[116:119], v[60:63]
  s_waitcnt lgkmcnt(7)
  v_mfma_f32_16x16x32_bf16 v[64:67], v[232:235], v[112:115], v[64:67]
  ds_read_b128 v[228:231], v5 offset:16384
  v_mfma_f32_16x16x32_bf16 v[68:71], v[232:235], v[116:119], v[68:71]
  s_waitcnt lgkmcnt(7)
  v_mfma_f32_16x16x32_bf16 v[72:75], v[236:239], v[112:115], v[72:75]
  ds_read_b128 v[232:235], v5 offset:17408
  v_mfma_f32_16x16x32_bf16 v[76:79], v[236:239], v[116:119], v[76:79]
  s_waitcnt lgkmcnt(7)
  v_mfma_f32_16x16x32_bf16 v[80:83], v[240:243], v[112:115], v[80:83]
  ds_read_b128 v[236:239], v5 offset:19456
  v_mfma_f32_16x16x32_bf16 v[84:87], v[240:243], v[116:119], v[84:87]
  s_waitcnt vmcnt(8) lgkmcnt(7)
  v_mfma_f32_16x16x32_bf16 v[24:27], v[208:211], v[120:123], v[24:27]
  ds_read_b128 v[240:243], v5 offset:20480
  v_mfma_f32_16x16x32_bf16 v[28:31], v[208:211], v[124:127], v[28:31]
  buffer_load_dwordx4 v[160:163], v4, s[12:15], s20 offen offset:0 sc1
  s_waitcnt lgkmcnt(7)
  v_mfma_f32_16x16x32_bf16 v[32:35], v[212:215], v[120:123], v[32:35]
  ds_read_b128 v[208:211], v5 offset:21504
  v_mfma_f32_16x16x32_bf16 v[36:39], v[212:215], v[124:127], v[36:39]
  buffer_load_dwordx4 v[164:167], v4, s[12:15], s20 offen offset:256 sc1
  s_waitcnt lgkmcnt(7)
  v_mfma_f32_16x16x32_bf16 v[40:43], v[216:219], v[120:123], v[40:43]
  ds_read_b128 v[212:215], v5 offset:23552
  v_mfma_f32_16x16x32_bf16 v[44:47], v[216:219], v[124:127], v[44:47]
  s_add_u32 s20, s20, 131072
  s_waitcnt lgkmcnt(7)
  v_mfma_f32_16x16x32_bf16 v[56:59], v[220:223], v[120:123], v[56:59]
  ds_read_b128 v[216:219], v5 offset:24576
  v_mfma_f32_16x16x32_bf16 v[60:63], v[220:223], v[124:127], v[60:63]
  s_waitcnt lgkmcnt(7)
  v_mfma_f32_16x16x32_bf16 v[64:67], v[224:227], v[120:123], v[64:67]
  ds_read_b128 v[220:223], v5 offset:25600
  v_mfma_f32_16x16x32_bf16 v[68:71], v[224:227], v[124:127], v[68:71]
  s_waitcnt lgkmcnt(7)
  v_mfma_f32_16x16x32_bf16 v[72:75], v[228:231], v[120:123], v[72:75]
  ds_read_b128 v[224:227], v5 offset:26624
  v_mfma_f32_16x16x32_bf16 v[76:79], v[228:231], v[124:127], v[76:79]
  s_waitcnt lgkmcnt(7)
  v_mfma_f32_16x16x32_bf16 v[80:83], v[232:235], v[120:123], v[80:83]
  ds_read_b128 v[228:231], v5 offset:28672
  v_mfma_f32_16x16x32_bf16 v[84:87], v[232:235], v[124:127], v[84:87]
  s_waitcnt vmcnt(8) lgkmcnt(7)
  v_mfma_f32_16x16x32_bf16 v[24:27], v[236:239], v[128:131], v[24:27]
  ds_read_b128 v[232:235], v5 offset:29696
  v_mfma_f32_16x16x32_bf16 v[28:31], v[236:239], v[132:135], v[28:31]
  buffer_load_dwordx4 v[168:171], v4, s[12:15], s20 offen offset:0 sc1
  s_waitcnt lgkmcnt(7)
  v_mfma_f32_16x16x32_bf16 v[32:35], v[240:243], v[128:131], v[32:35]
  ds_read_b128 v[236:239], v5 offset:30720
  v_mfma_f32_16x16x32_bf16 v[36:39], v[240:243], v[132:135], v[36:39]
  buffer_load_dwordx4 v[172:175], v4, s[12:15], s20 offen offset:256 sc1
  s_waitcnt lgkmcnt(7)
  v_mfma_f32_16x16x32_bf16 v[40:43], v[208:211], v[128:131], v[40:43]
  ds_read_b128 v[240:243], v5 offset:32768
  v_mfma_f32_16x16x32_bf16 v[44:47], v[208:211], v[132:135], v[44:47]
  s_add_u32 s20, s20, 131072
  s_waitcnt lgkmcnt(7)
  v_mfma_f32_16x16x32_bf16 v[56:59], v[212:215], v[128:131], v[56:59]
  ds_read_b128 v[208:211], v5 offset:33792
  v_mfma_f32_16x16x32_bf16 v[60:63], v[212:215], v[132:135], v[60:63]
  s_waitcnt lgkmcnt(7)
  v_mfma_f32_16x16x32_bf16 v[64:67], v[216:219], v[128:131], v[64:67]
  ds_read_b128 v[212:215], v5 offset:34816
  v_mfma_f32_16x16x32_bf16 v[68:71], v[216:219], v[132:135], v[68:71]
  s_waitcnt lgkmcnt(7)
  v_mfma_f32_16x16x32_bf16 v[72:75], v[220:223], v[128:131], v[72:75]
  ds_read_b128 v[216:219], v5 offset:35840
  v_mfma_f32_16x16x32_bf16 v[76:79], v[220:223], v[132:135], v[76:79]
  s_waitcnt lgkmcnt(7)
  s_barrier
  v_mfma_f32_16x16x32_bf16 v[80:83], v[224:227], v[128:131], v[80:83]
  ds_read_b128 v[220:223], v6 offset:1024
  v_mfma_f32_16x16x32_bf16 v[84:87], v[224:227], v[132:135], v[84:87]
  s_waitcnt vmcnt(8) lgkmcnt(7)
  v_mfma_f32_16x16x32_bf16 v[24:27], v[228:231], v[136:139], v[24:27]
  ds_read_b128 v[224:227], v6 offset:2048
  v_mfma_f32_16x16x32_bf16 v[28:31], v[228:231], v[140:143], v[28:31]
  buffer_load_dwordx4 v[176:179], v4, s[12:15], s20 offen offset:0 sc1
  s_waitcnt lgkmcnt(7)
  v_mfma_f32_16x16x32_bf16 v[32:35], v[232:235], v[136:139], v[32:35]
  ds_read_b128 v[228:231], v6 offset:3072
  v_mfma_f32_16x16x32_bf16 v[36:39], v[232:235], v[140:143], v[36:39]
  buffer_load_dwordx4 v[180:183], v4, s[12:15], s20 offen offset:256 sc1
  s_waitcnt lgkmcnt(7)
  v_mfma_f32_16x16x32_bf16 v[40:43], v[236:239], v[136:139], v[40:43]
  ds_read_b128 v[232:235], v6 offset:5120
  v_mfma_f32_16x16x32_bf16 v[44:47], v[236:239], v[140:143], v[44:47]
  s_add_u32 s20, s20, 131072
  s_waitcnt lgkmcnt(7)
  v_mfma_f32_16x16x32_bf16 v[56:59], v[240:243], v[136:139], v[56:59]
  ds_read_b128 v[236:239], v6 offset:6144
  v_mfma_f32_16x16x32_bf16 v[60:63], v[240:243], v[140:143], v[60:63]
  s_waitcnt lgkmcnt(7)
  v_mfma_f32_16x16x32_bf16 v[64:67], v[208:211], v[136:139], v[64:67]
  ds_read_b128 v[240:243], v6 offset:7168
  v_mfma_f32_16x16x32_bf16 v[68:71], v[208:211], v[140:143], v[68:71]
  s_waitcnt lgkmcnt(7)
  v_mfma_f32_16x16x32_bf16 v[72:75], v[212:215], v[136:139], v[72:75]
  ds_read_b128 v[208:211], v6 offset:8192
  v_mfma_f32_16x16x32_bf16 v[76:79], v[212:215], v[140:143], v[76:79]
  s_waitcnt lgkmcnt(7)
  v_mfma_f32_16x16x32_bf16 v[80:83], v[216:219], v[136:139], v[80:83]
  ds_read_b128 v[212:215], v6 offset:10240
  v_mfma_f32_16x16x32_bf16 v[84:87], v[216:219], v[140:143], v[84:87]
  s_waitcnt vmcnt(8) lgkmcnt(7)
  v_mfma_f32_16x16x32_bf16 v[24:27], v[220:223], v[144:147], v[24:27]
  ds_read_b128 v[216:219], v6 offset:11264
  v_mfma_f32_16x16x32_bf16 v[28:31], v[220:223], v[148:151], v[28:31]
  buffer_load_dwordx4 v[184:187], v4, s[12:15], s20 offen offset:0 sc1
  s_waitcnt lgkmcnt(7)
  v_mfma_f32_16x16x32_bf16 v[32:35], v[224:227], v[144:147], v[32:35]
  ds_read_b128 v[220:223], v6 offset:12288
  v_mfma_f32_16x16x32_bf16 v[36:39], v[224:227], v[148:151], v[36:39]
  buffer_load_dwordx4 v[188:191], v4, s[12:15], s20 offen offset:256 sc1
  s_waitcnt lgkmcnt(7)
  v_mfma_f32_16x16x32_bf16 v[40:43], v[228:231], v[144:147], v[40:43]
  ds_read_b128 v[224:227], v6 offset:14336
  v_mfma_f32_16x16x32_bf16 v[44:47], v[228:231], v[148:151], v[44:47]
  s_add_u32 s20, s20, 131072
  s_waitcnt lgkmcnt(7)
  v_mfma_f32_16x16x32_bf16 v[56:59], v[232:235], v[144:147], v[56:59]
  ds_read_b128 v[228:231], v6 offset:15360
  v_mfma_f32_16x16x32_bf16 v[60:63], v[232:235], v[148:151], v[60:63]
  s_waitcnt lgkmcnt(7)
  v_mfma_f32_16x16x32_bf16 v[64:67], v[236:239], v[144:147], v[64:67]
  ds_read_b128 v[232:235], v6 offset:16384
  v_mfma_f32_16x16x32_bf16 v[68:71], v[236:239], v[148:151], v[68:71]
  s_waitcnt lgkmcnt(7)
  v_mfma_f32_16x16x32_bf16 v[72:75], v[240:243], v[144:147], v[72:75]
  ds_read_b128 v[236:239], v6 offset:17408
  v_mfma_f32_16x16x32_bf16 v[76:79], v[240:243], v[148:151], v[76:79]
  s_waitcnt lgkmcnt(7)
  v_mfma_f32_16x16x32_bf16 v[80:83], v[208:211], v[144:147], v[80:83]
  ds_read_b128 v[240:243], v6 offset:19456
  v_mfma_f32_16x16x32_bf16 v[84:87], v[208:211], v[148:151], v[84:87]
  s_waitcnt vmcnt(8) lgkmcnt(7)
  v_mfma_f32_16x16x32_bf16 v[24:27], v[212:215], v[152:155], v[24:27]
  ds_read_b128 v[208:211], v6 offset:20480
  v_mfma_f32_16x16x32_bf16 v[28:31], v[212:215], v[156:159], v[28:31]
  buffer_load_dwordx4 v[192:195], v4, s[12:15], s20 offen offset:0 sc1
  s_waitcnt lgkmcnt(7)
  v_mfma_f32_16x16x32_bf16 v[32:35], v[216:219], v[152:155], v[32:35]
  ds_read_b128 v[212:215], v6 offset:21504
  v_mfma_f32_16x16x32_bf16 v[36:39], v[216:219], v[156:159], v[36:39]
  buffer_load_dwordx4 v[196:199], v4, s[12:15], s20 offen offset:256 sc1
  s_waitcnt lgkmcnt(7)
  v_mfma_f32_16x16x32_bf16 v[40:43], v[220:223], v[152:155], v[40:43]
  ds_read_b128 v[216:219], v6 offset:23552
  v_mfma_f32_16x16x32_bf16 v[44:47], v[220:223], v[156:159], v[44:47]
  s_add_u32 s20, s20, 131072
  s_waitcnt lgkmcnt(7)
  v_mfma_f32_16x16x32_bf16 v[56:59], v[224:227], v[152:155], v[56:59]
  ds_read_b128 v[220:223], v6 offset:24576
  v_mfma_f32_16x16x32_bf16 v[60:63], v[224:227], v[156:159], v[60:63]
  s_waitcnt lgkmcnt(7)
  v_mfma_f32_16x16x32_bf16 v[64:67], v[228:231], v[152:155], v[64:67]
  ds_read_b128 v[224:227], v6 offset:25600
  v_mfma_f32_16x16x32_bf16 v[68:71], v[228:231], v[156:159], v[68:71]
  s_waitcnt lgkmcnt(7)
  v_mfma_f32_16x16x32_bf16 v[72:75], v[232:235], v[152:155], v[72:75]
  ds_read_b128 v[228:231], v6 offset:26624
  v_mfma_f32_16x16x32_bf16 v[76:79], v[232:235], v[156:159], v[76:79]
  s_waitcnt lgkmcnt(7)
  v_mfma_f32_16x16x32_bf16 v[80:83], v[236:239], v[152:155], v[80:83]
  ds_read_b128 v[232:235], v6 offset:28672
  v_mfma_f32_16x16x32_bf16 v[84:87], v[236:239], v[156:159], v[84:87]
  s_waitcnt vmcnt(8) lgkmcnt(7)
  v_mfma_f32_16x16x32_bf16 v[24:27], v[240:243], v[160:163], v[24:27]
  ds_read_b128 v[236:239], v6 offset:29696
  v_mfma_f32_16x16x32_bf16 v[28:31], v[240:243], v[164:167], v[28:31]
  buffer_load_dwordx4 v[200:203], v4, s[12:15], s20 offen offset:0 sc1
  s_waitcnt lgkmcnt(7)
  v_mfma_f32_16x16x32_bf16 v[32:35], v[208:211], v[160:163], v[32:35]
  ds_read_b128 v[240:243], v6 offset:30720
  v_mfma_f32_16x16x32_bf16 v[36:39], v[208:211], v[164:167], v[36:39]
  buffer_load_dwordx4 v[204:207], v4, s[12:15], s20 offen offset:256 sc1
  s_waitcnt lgkmcnt(7)
  v_mfma_f32_16x16x32_bf16 v[40:43], v[212:215], v[160:163], v[40:43]
  ds_read_b128 v[208:211], v6 offset:32768
  v_mfma_f32_16x16x32_bf16 v[44:47], v[212:215], v[164:167], v[44:47]
  s_add_u32 s20, s20, 131072
  s_waitcnt lgkmcnt(7)
  v_mfma_f32_16x16x32_bf16 v[56:59], v[216:219], v[160:163], v[56:59]
  ds_read_b128 v[212:215], v6 offset:33792
  v_mfma_f32_16x16x32_bf16 v[60:63], v[216:219], v[164:167], v[60:63]
  s_waitcnt lgkmcnt(7)
  v_mfma_f32_16x16x32_bf16 v[64:67], v[220:223], v[160:163], v[64:67]
  ds_read_b128 v[216:219], v6 offset:34816
  v_mfma_f32_16x16x32_bf16 v[68:71], v[220:223], v[164:167], v[68:71]
  s_waitcnt lgkmcnt(7)
  v_mfma_f32_16x16x32_bf16 v[72:75], v[224:227], v[160:163], v[72:75]
  ds_read_b128 v[220:223], v6 offset:35840
  v_mfma_f32_16x16x32_bf16 v[76:79], v[224:227], v[164:167], v[76:79]
  s_waitcnt lgkmcnt(7)
  s_barrier
  v_mfma_f32_16x16x32_bf16 v[80:83], v[228:231], v[160:163], v[80:83]
  ds_read_b128 v[224:227], v7 offset:1024
  v_mfma_f32_16x16x32_bf16 v[84:87], v[228:231], v[164:167], v[84:87]
  s_waitcnt vmcnt(8) lgkmcnt(7)
  v_mfma_f32_16x16x32_bf16 v[24:27], v[232:235], v[168:171], v[24:27]
  ds_read_b128 v[228:231], v7 offset:10240
  v_mfma_f32_16x16x32_bf16 v[28:31], v[232:235], v[172:175], v[28:31]
  s_waitcnt lgkmcnt(7)
  v_mfma_f32_16x16x32_bf16 v[32:35], v[236:239], v[168:171], v[32:35]
  ds_read_b128 v[232:235], v7 offset:19456
  v_mfma_f32_16x16x32_bf16 v[36:39], v[236:239], v[172:175], v[36:39]
  s_waitcnt lgkmcnt(7)
  v_mfma_f32_16x16x32_bf16 v[40:43], v[240:243], v[168:171], v[40:43]
  ds_read_b128 v[236:239], v7 offset:28672
  v_mfma_f32_16x16x32_bf16 v[44:47], v[240:243], v[172:175], v[44:47]
  s_waitcnt lgkmcnt(7)
  v_mfma_f32_16x16x32_bf16 v[56:59], v[208:211], v[168:171], v[56:59]
  ds_read_b128 v[240:243], v7 offset:2048
  v_mfma_f32_16x16x32_bf16 v[60:63], v[208:211], v[172:175], v[60:63]
  s_waitcnt lgkmcnt(7)
  v_mfma_f32_16x16x32_bf16 v[64:67], v[212:215], v[168:171], v[64:67]
  ds_read_b128 v[208:211], v7 offset:11264
  v_mfma_f32_16x16x32_bf16 v[68:71], v[212:215], v[172:175], v[68:71]
  s_waitcnt lgkmcnt(7)
  v_mfma_f32_16x16x32_bf16 v[72:75], v[216:219], v[168:171], v[72:75]
  ds_read_b128 v[212:215], v7 offset:20480
  v_mfma_f32_16x16x32_bf16 v[76:79], v[216:219], v[172:175], v[76:79]
  s_waitcnt lgkmcnt(7)
  v_mfma_f32_16x16x32_bf16 v[80:83], v[220:223], v[168:171], v[80:83]
  ds_read_b128 v[216:219], v7 offset:29696
  v_mfma_f32_16x16x32_bf16 v[84:87], v[220:223], v[172:175], v[84:87]
  s_waitcnt vmcnt(6) lgkmcnt(7)
  v_mfma_f32_16x16x32_bf16 v[24:27], v[224:227], v[176:179], v[24:27]
  ds_read_b128 v[220:223], v7 offset:3072
  v_mfma_f32_16x16x32_bf16 v[28:31], v[224:227], v[180:183], v[28:31]
  s_waitcnt vmcnt(4) lgkmcnt(7)
  v_mfma_f32_16x16x32_bf16 v[24:27], v[228:231], v[184:187], v[24:27]
  ds_read_b128 v[224:227], v7 offset:12288
  v_mfma_f32_16x16x32_bf16 v[28:31], v[228:231], v[188:191], v[28:31]
  s_waitcnt vmcnt(2) lgkmcnt(7)
  v_mfma_f32_16x16x32_bf16 v[24:27], v[232:235], v[192:195], v[24:27]
  ds_read_b128 v[228:231], v7 offset:21504
  v_mfma_f32_16x16x32_bf16 v[28:31], v[232:235], v[196:199], v[28:31]
  s_waitcnt vmcnt(0) lgkmcnt(7)
  v_mfma_f32_16x16x32_bf16 v[24:27], v[236:239], v[200:203], v[24:27]
  ds_read_b128 v[232:235], v7 offset:30720
  v_mfma_f32_16x16x32_bf16 v[28:31], v[236:239], v[204:207], v[28:31]
  s_waitcnt lgkmcnt(7)
  v_mfma_f32_16x16x32_bf16 v[32:35], v[240:243], v[176:179], v[32:35]
  ds_read_b128 v[236:239], v7 offset:5120
  v_mfma_f32_16x16x32_bf16 v[36:39], v[240:243], v[180:183], v[36:39]
  s_waitcnt lgkmcnt(7)
  v_mfma_f32_16x16x32_bf16 v[32:35], v[208:211], v[184:187], v[32:35]
  ds_read_b128 v[240:243], v7 offset:14336
  s_mul_i32 s29, s41, 3072
  s_add_u32 s29, s29, s62
  s_nop 0
  v_cvt_pk_bf16_f32 v88, v24, v25
  v_cvt_pk_bf16_f32 v90, v28, v29
  v_mfma_f32_16x16x32_bf16 v[36:39], v[208:211], v[188:191], v[36:39]
  v_cvt_pk_bf16_f32 v89, v26, v27
  v_cvt_pk_bf16_f32 v91, v30, v31
  s_waitcnt lgkmcnt(7)
  v_mfma_f32_16x16x32_bf16 v[32:35], v[212:215], v[192:195], v[32:35]
  ds_read_b128 v[208:211], v7 offset:23552
  v_min_u32 v88, s53, v88
  v_min_u32 v90, s53, v90
  v_mfma_f32_16x16x32_bf16 v[36:39], v[212:215], v[196:199], v[36:39]
  v_min_u32 v89, s53, v89
  v_min_u32 v91, s53, v91
  s_waitcnt lgkmcnt(7)
  v_mfma_f32_16x16x32_bf16 v[32:35], v[216:219], v[200:203], v[32:35]
  ds_read_b128 v[212:215], v7 offset:32768
  v_permlane16_swap_b32 v88, v90
  v_mfma_f32_16x16x32_bf16 v[36:39], v[216:219], v[204:207], v[36:39]
  v_permlane16_swap_b32 v89, v91
  buffer_store_dwordx4 v[88:91], v1, s[12:15], s29 offen offset:0 sc1
  s_waitcnt lgkmcnt(7)
  v_mfma_f32_16x16x32_bf16 v[40:43], v[220:223], v[176:179], v[40:43]
  ds_read_b128 v[216:219], v7 offset:6144
  v_mfma_f32_16x16x32_bf16 v[44:47], v[220:223], v[180:183], v[44:47]
  s_waitcnt lgkmcnt(7)
  v_mfma_f32_16x16x32_bf16 v[40:43], v[224:227], v[184:187], v[40:43]
  ds_read_b128 v[220:223], v7 offset:15360
  s_mul_i32 s29, s42, 3072
  s_add_u32 s29, s29, s62
  s_nop 0
  v_cvt_pk_bf16_f32 v92, v32, v33
  v_cvt_pk_bf16_f32 v94, v36, v37
  v_mfma_f32_16x16x32_bf16 v[44:47], v[224:227], v[188:191], v[44:47]
  v_cvt_pk_bf16_f32 v93, v34, v35
  v_cvt_pk_bf16_f32 v95, v38, v39
  s_waitcnt lgkmcnt(7)
  v_mfma_f32_16x16x32_bf16 v[40:43], v[228:231], v[192:195], v[40:43]
  ds_read_b128 v[224:227], v7 offset:24576
  v_min_u32 v92, s53, v92
  v_min_u32 v94, s53, v94
  v_mfma_f32_16x16x32_bf16 v[44:47], v[228:231], v[196:199], v[44:47]
  v_min_u32 v93, s53, v93
  v_min_u32 v95, s53, v95
  s_waitcnt lgkmcnt(7)
  v_mfma_f32_16x16x32_bf16 v[40:43], v[232:235], v[200:203], v[40:43]
  ds_read_b128 v[228:231], v7 offset:33792
  v_permlane16_swap_b32 v92, v94
  v_mfma_f32_16x16x32_bf16 v[44:47], v[232:235], v[204:207], v[44:47]
  v_permlane16_swap_b32 v93, v95
  buffer_store_dwordx4 v[92:95], v1, s[12:15], s29 offen offset:1024 sc1
  s_waitcnt lgkmcnt(7)
  v_mfma_f32_16x16x32_bf16 v[56:59], v[236:239], v[176:179], v[56:59]
  ds_read_b128 v[232:235], v7 offset:7168
  v_mfma_f32_16x16x32_bf16 v[60:63], v[236:239], v[180:183], v[60:63]
  s_waitcnt lgkmcnt(7)
  v_mfma_f32_16x16x32_bf16 v[56:59], v[240:243], v[184:187], v[56:59]
  ds_read_b128 v[236:239], v7 offset:16384
  s_mul_i32 s29, s43, 3072
  s_add_u32 s29, s29, s62
  s_nop 0
  v_cvt_pk_bf16_f32 v96, v40, v41
  v_cvt_pk_bf16_f32 v98, v44, v45
  v_mfma_f32_16x16x32_bf16 v[60:63], v[240:243], v[188:191], v[60:63]
  v_cvt_pk_bf16_f32 v97, v42, v43
  v_cvt_pk_bf16_f32 v99, v46, v47
  s_waitcnt lgkmcnt(7)
  v_mfma_f32_16x16x32_bf16 v[56:59], v[208:211], v[192:195], v[56:59]
  ds_read_b128 v[240:243], v7 offset:25600
  v_min_u32 v96, s53, v96
  v_min_u32 v98, s53, v98
  v_mfma_f32_16x16x32_bf16 v[60:63], v[208:211], v[196:199], v[60:63]
  v_min_u32 v97, s53, v97
  v_min_u32 v99, s53, v99
  s_waitcnt lgkmcnt(7)
  v_mfma_f32_16x16x32_bf16 v[56:59], v[212:215], v[200:203], v[56:59]
  ds_read_b128 v[208:211], v7 offset:34816
  v_permlane16_swap_b32 v96, v98
  v_mfma_f32_16x16x32_bf16 v[60:63], v[212:215], v[204:207], v[60:63]
  v_permlane16_swap_b32 v97, v99
  buffer_store_dwordx4 v[96:99], v1, s[12:15], s29 offen offset:2048 sc1
  s_waitcnt lgkmcnt(7)
  v_mfma_f32_16x16x32_bf16 v[64:67], v[216:219], v[176:179], v[64:67]
  ds_read_b128 v[212:215], v7 offset:8192
  v_mfma_f32_16x16x32_bf16 v[68:71], v[216:219], v[180:183], v[68:71]
  s_waitcnt lgkmcnt(7)
  v_mfma_f32_16x16x32_bf16 v[64:67], v[220:223], v[184:187], v[64:67]
  ds_read_b128 v[216:219], v7 offset:17408
  s_mul_i32 s29, s41, 3072
  s_add_u32 s29, s29, s62
  s_add_u32 s29, s29, 12288
  v_cvt_pk_bf16_f32 v100, v56, v57
  v_cvt_pk_bf16_f32 v102, v60, v61
  v_mfma_f32_16x16x32_bf16 v[68:71], v[220:223], v[188:191], v[68:71]
  v_cvt_pk_bf16_f32 v101, v58, v59
  v_cvt_pk_bf16_f32 v103, v62, v63
  s_waitcnt lgkmcnt(7)
  v_mfma_f32_16x16x32_bf16 v[64:67], v[224:227], v[192:195], v[64:67]
  ds_read_b128 v[220:223], v7 offset:26624
  v_min_u32 v100, s53, v100
  v_min_u32 v102, s53, v102
  v_mfma_f32_16x16x32_bf16 v[68:71], v[224:227], v[196:199], v[68:71]
  v_min_u32 v101, s53, v101
  v_min_u32 v103, s53, v103
  s_waitcnt lgkmcnt(7)
  v_mfma_f32_16x16x32_bf16 v[64:67], v[228:231], v[200:203], v[64:67]
  ds_read_b128 v[224:227], v7 offset:35840
  v_permlane16_swap_b32 v100, v102
  v_mfma_f32_16x16x32_bf16 v[68:71], v[228:231], v[204:207], v[68:71]
  v_permlane16_swap_b32 v101, v103
  buffer_store_dwordx4 v[100:103], v1, s[12:15], s29 offen offset:0 sc1
  s_waitcnt lgkmcnt(7)
  v_mfma_f32_16x16x32_bf16 v[72:75], v[232:235], v[176:179], v[72:75]
  ds_read_b128 v[228:231], v5 offset:9216
  v_mfma_f32_16x16x32_bf16 v[76:79], v[232:235], v[180:183], v[76:79]
  s_waitcnt lgkmcnt(7)
  v_mfma_f32_16x16x32_bf16 v[72:75], v[236:239], v[184:187], v[72:75]
  ds_read_b128 v[232:235], v5 offset:13312
  s_mul_i32 s29, s42, 3072
  s_add_u32 s29, s29, s62
  s_add_u32 s29, s29, 12288
  v_cvt_pk_bf16_f32 v104, v64, v65
  v_cvt_pk_bf16_f32 v106, v68, v69
  v_mfma_f32_16x16x32_bf16 v[76:79], v[236:239], v[188:191], v[76:79]
  v_cvt_pk_bf16_f32 v105, v66, v67
  v_cvt_pk_bf16_f32 v107, v70, v71
  s_waitcnt lgkmcnt(7)
  v_mfma_f32_16x16x32_bf16 v[72:75], v[240:243], v[192:195], v[72:75]
  ds_read_b128 v[236:239], v5 offset:18432
  v_min_u32 v104, s53, v104
  v_min_u32 v106, s53, v106
  v_mfma_f32_16x16x32_bf16 v[76:79], v[240:243], v[196:199], v[76:79]
  v_min_u32 v105, s53, v105
  v_min_u32 v107, s53, v107
  s_waitcnt lgkmcnt(7)
  v_mfma_f32_16x16x32_bf16 v[72:75], v[208:211], v[200:203], v[72:75]
  ds_read_b128 v[240:243], v5 offset:22528
  v_permlane16_swap_b32 v104, v106
  v_mfma_f32_16x16x32_bf16 v[76:79], v[208:211], v[204:207], v[76:79]
  v_permlane16_swap_b32 v105, v107
  buffer_store_dwordx4 v[104:107], v1, s[12:15], s29 offen offset:1024 sc1
  s_waitcnt lgkmcnt(7)
  v_mfma_f32_16x16x32_bf16 v[80:83], v[212:215], v[176:179], v[80:83]
  ds_read_b128 v[208:211], v5 offset:27648
  v_mfma_f32_16x16x32_bf16 v[84:87], v[212:215], v[180:183], v[84:87]
  s_waitcnt lgkmcnt(7)
  v_mfma_f32_16x16x32_bf16 v[80:83], v[216:219], v[184:187], v[80:83]
  ds_read_b128 v[212:215], v5 offset:31744
  s_mul_i32 s29, s43, 3072
  s_add_u32 s29, s29, s62
  s_add_u32 s29, s29, 12288
  v_cvt_pk_bf16_f32 v108, v72, v73
  v_cvt_pk_bf16_f32 v110, v76, v77
  v_mfma_f32_16x16x32_bf16 v[84:87], v[216:219], v[188:191], v[84:87]
  v_cvt_pk_bf16_f32 v109, v74, v75
  v_cvt_pk_bf16_f32 v111, v78, v79
  s_waitcnt lgkmcnt(7)
  v_mfma_f32_16x16x32_bf16 v[80:83], v[220:223], v[192:195], v[80:83]
  ds_read_b128 v[216:219], v6 offset:0
  v_min_u32 v108, s53, v108
  v_min_u32 v110, s53, v110
  v_mfma_f32_16x16x32_bf16 v[84:87], v[220:223], v[196:199], v[84:87]
  v_min_u32 v109, s53, v109
  v_min_u32 v111, s53, v111
  s_waitcnt lgkmcnt(7)
  v_mfma_f32_16x16x32_bf16 v[80:83], v[224:227], v[200:203], v[80:83]
  ds_read_b128 v[220:223], v6 offset:4096
  v_permlane16_swap_b32 v108, v110
  v_mfma_f32_16x16x32_bf16 v[84:87], v[224:227], v[204:207], v[84:87]
  v_permlane16_swap_b32 v109, v111
  buffer_store_dwordx4 v[108:111], v1, s[12:15], s29 offen offset:2048 sc1
  s_waitcnt lgkmcnt(7)
  v_mfma_f32_16x16x32_bf16 v[16:19], v[228:231], v[120:123], v[16:19]
  ds_read_b128 v[224:227], v6 offset:9216
  v_mfma_f32_16x16x32_bf16 v[20:23], v[228:231], v[124:127], v[20:23]
  s_waitcnt lgkmcnt(7)
  v_mfma_f32_16x16x32_bf16 v[48:51], v[232:235], v[120:123], v[48:51]
  ds_read_b128 v[228:231], v6 offset:13312
  s_nop 2
  v_cvt_pk_bf16_f32 v244, v80, v81
  v_cvt_pk_bf16_f32 v246, v84, v85
  v_mfma_f32_16x16x32_bf16 v[52:55], v[232:235], v[124:127], v[52:55]
  v_cvt_pk_bf16_f32 v245, v82, v83
  v_cvt_pk_bf16_f32 v247, v86, v87
  s_waitcnt lgkmcnt(7)
  v_mfma_f32_16x16x32_bf16 v[16:19], v[236:239], v[128:131], v[16:19]
  ds_read_b128 v[232:235], v6 offset:18432
  v_min_u32 v244, s53, v244
  v_min_u32 v246, s53, v246
  v_mfma_f32_16x16x32_bf16 v[20:23], v[236:239], v[132:135], v[20:23]
  v_min_u32 v245, s53, v245
  v_min_u32 v247, s53, v247
  s_waitcnt lgkmcnt(7)
  v_mfma_f32_16x16x32_bf16 v[48:51], v[240:243], v[128:131], v[48:51]
  ds_read_b128 v[236:239], v6 offset:22528
  v_permlane16_swap_b32 v244, v246
  v_mfma_f32_16x16x32_bf16 v[52:55], v[240:243], v[132:135], v[52:55]
  v_permlane16_swap_b32 v245, v247
  buffer_store_dwordx4 v[244:247], v1, s[12:15], s52 offen sc1
  s_waitcnt lgkmcnt(7)
  v_mfma_f32_16x16x32_bf16 v[16:19], v[208:211], v[136:139], v[16:19]
  ds_read_b128 v[240:243], v6 offset:27648
  v_mfma_f32_16x16x32_bf16 v[20:23], v[208:211], v[140:143], v[20:23]
  s_waitcnt lgkmcnt(7)
  v_mfma_f32_16x16x32_bf16 v[48:51], v[212:215], v[136:139], v[48:51]
  ds_read_b128 v[208:211], v6 offset:31744
  v_mfma_f32_16x16x32_bf16 v[52:55], v[212:215], v[140:143], v[52:55]
  s_waitcnt lgkmcnt(7)
  v_mfma_f32_16x16x32_bf16 v[16:19], v[216:219], v[144:147], v[16:19]
  ds_read_b128 v[212:215], v7 offset:0
  v_mfma_f32_16x16x32_bf16 v[20:23], v[216:219], v[148:151], v[20:23]
  s_waitcnt lgkmcnt(7)
  v_mfma_f32_16x16x32_bf16 v[48:51], v[220:223], v[144:147], v[48:51]
  ds_read_b128 v[216:219], v7 offset:4096
  v_mfma_f32_16x16x32_bf16 v[52:55], v[220:223], v[148:151], v[52:55]
  s_waitcnt lgkmcnt(7)
  v_mfma_f32_16x16x32_bf16 v[16:19], v[224:227], v[152:155], v[16:19]
  ds_read_b128 v[220:223], v7 offset:9216
  v_mfma_f32_16x16x32_bf16 v[20:23], v[224:227], v[156:159], v[20:23]
  s_waitcnt lgkmcnt(7)
  v_mfma_f32_16x16x32_bf16 v[48:51], v[228:231], v[152:155], v[48:51]
  ds_read_b128 v[224:227], v7 offset:13312
  v_mfma_f32_16x16x32_bf16 v[52:55], v[228:231], v[156:159], v[52:55]
  s_waitcnt lgkmcnt(7)
  v_mfma_f32_16x16x32_bf16 v[16:19], v[232:235], v[160:163], v[16:19]
  ds_read_b128 v[228:231], v7 offset:18432
  v_mfma_f32_16x16x32_bf16 v[20:23], v[232:235], v[164:167], v[20:23]
  s_waitcnt lgkmcnt(7)
  s_barrier
  v_mfma_f32_16x16x32_bf16 v[48:51], v[236:239], v[160:163], v[48:51]
  ds_read_b128 v[232:235], v7 offset:22528
  v_mfma_f32_16x16x32_bf16 v[52:55], v[236:239], v[164:167], v[52:55]
  s_waitcnt lgkmcnt(7)
  v_mfma_f32_16x16x32_bf16 v[16:19], v[240:243], v[168:171], v[16:19]
  ds_read_b128 v[236:239], v7 offset:27648
  v_mfma_f32_16x16x32_bf16 v[20:23], v[240:243], v[172:175], v[20:23]
  s_waitcnt lgkmcnt(7)
  v_mfma_f32_16x16x32_bf16 v[48:51], v[208:211], v[168:171], v[48:51]
  ds_read_b128 v[240:243], v7 offset:31744
  v_mfma_f32_16x16x32_bf16 v[52:55], v[208:211], v[172:175], v[52:55]
  s_waitcnt lgkmcnt(7)
  v_mfma_f32_16x16x32_bf16 v[16:19], v[212:215], v[176:179], v[16:19]
  v_mfma_f32_16x16x32_bf16 v[20:23], v[212:215], v[180:183], v[20:23]
  s_waitcnt lgkmcnt(6)
  v_mfma_f32_16x16x32_bf16 v[48:51], v[216:219], v[176:179], v[48:51]
  v_mfma_f32_16x16x32_bf16 v[52:55], v[216:219], v[180:183], v[52:55]
  s_waitcnt lgkmcnt(5)
  v_mfma_f32_16x16x32_bf16 v[16:19], v[220:223], v[184:187], v[16:19]
  v_mfma_f32_16x16x32_bf16 v[20:23], v[220:223], v[188:191], v[20:23]
  s_waitcnt lgkmcnt(4)
  v_mfma_f32_16x16x32_bf16 v[48:51], v[224:227], v[184:187], v[48:51]
  v_mfma_f32_16x16x32_bf16 v[52:55], v[224:227], v[188:191], v[52:55]
  s_waitcnt lgkmcnt(3)
  v_mfma_f32_16x16x32_bf16 v[16:19], v[228:231], v[192:195], v[16:19]
  v_mfma_f32_16x16x32_bf16 v[20:23], v[228:231], v[196:199], v[20:23]
  s_waitcnt lgkmcnt(2)
  v_mfma_f32_16x16x32_bf16 v[48:51], v[232:235], v[192:195], v[48:51]
  v_mfma_f32_16x16x32_bf16 v[52:55], v[232:235], v[196:199], v[52:55]
  s_waitcnt lgkmcnt(1)
  v_mfma_f32_16x16x32_bf16 v[16:19], v[236:239], v[200:203], v[16:19]
  v_mfma_f32_16x16x32_bf16 v[20:23], v[236:239], v[204:207], v[20:23]
  s_waitcnt lgkmcnt(0)
  v_mfma_f32_16x16x32_bf16 v[48:51], v[240:243], v[200:203], v[48:51]
  v_mfma_f32_16x16x32_bf16 v[52:55], v[240:243], v[204:207], v[52:55]
  s_nop 5
  ds_write_b128 v11, v[80:83] offset:4096
  ds_write_b128 v11, v[84:87] offset:5120
  ds_write_b128 v11, v[16:19] offset:0
  ds_write_b128 v11, v[20:23] offset:1024
  ds_write_b128 v11, v[48:51] offset:2048
  ds_write_b128 v11, v[52:55] offset:3072
  s_waitcnt lgkmcnt(0)
  s_barrier
  s_branch Lse_fin
Lse_dside:
  s_cmp_eq_u32 s27, 6
  s_cbranch_scc1 Lse_ds6
  s_cmp_eq_u32 s27, 7
  s_cbranch_scc1 Lse_ds7
  s_cmp_eq_u32 s27, 4
  s_cbranch_scc1 Lse_dback
  v_mov_b32 v12, 1
  v_mov_b32 v13, s1
  v_add_u32 v12, s0, v12
  v_lshlrev_b32 v14, 3, v0
  s_mov_b64 exec, 65535
  buffer_store_dwordx2 v[12:13], v14, s[12:15], s30 offen sc1
  s_mov_b64 exec, -1
  s_add_u32 s30, s30, 262144
  s_cmp_lg_u32 s27, 8
  s_cbranch_scc1 Lse_dback
  s_waitcnt vmcnt(6)
  v_subrev_u32 v32, s0, v32
  v_xor_b32 v33, s1, v33
  v_subrev_u32 v32, 1, v32
  v_and_or_b32 v32, v32, -4, v33
  v_cmp_ne_u32 vcc, 0, v32
  s_nop 0
  s_cbranch_vccz Lse_pgx
  s_mov_b32 s60, 0
Lse_pg:
  buffer_load_dwordx2 v[32:33], v2, s[12:15], s32 offen sc1
  s_add_u32 s60, s60, 1
  s_waitcnt vmcnt(0)
  v_subrev_u32 v32, s0, v32
  v_xor_b32 v33, s1, v33
  v_subrev_u32 v32, 1, v32
  v_and_or_b32 v32, v32, -4, v33
  v_cmp_ne_u32 vcc, 0, v32
  s_cmp_ge_u32 s60, 400000
  s_cbranch_scc1 Lse_pgx
  s_cbranch_vccz Lse_pgx
  s_sleep 2
  s_branch Lse_pg
Lse_pgx:
  v_and_b32 v60, 31, v0
  v_lshrrev_b32 v61, 5, v0
  v_mul_u32_u24 v61, 81920, v61
  v_lshlrev_b32 v60, 2, v60
  v_add_u32 v61, v61, v60
  s_mul_i32 s22, s18, 9
  s_add_u32 s23, s22, s19
  s_lshl_b32 s23, s23, 16
  s_lshl_b32 s29, s28, 9
  s_add_u32 s29, s29, 11534336
  s_add_u32 s23, s23, s29
  buffer_load_dwordx4 v[36:39], v3, s[12:15], s23 offen sc1
  s_add_u32 s23, s23, 262144
  buffer_load_dwordx4 v[40:43], v3, s[12:15], s23 offen sc1
  s_add_u32 s22, s22, 8
  s_lshl_b32 s23, s22, 16
  s_add_u32 s23, s23, s29
  buffer_load_dwordx4 v[44:47], v3, s[12:15], s23 offen sc1
  s_lshl_b32 s23, s28, 7
  s_add_u32 s29, s23, 14688256
  s_add_u32 s23, s23, 14696448
  buffer_load_dword v58, v60, s[12:15], s29 offen sc1
  buffer_load_dword v48, v61, s[12:15], s23 offen sc1
  s_add_u32 s23, s23, 8192
  buffer_load_dword v49, v61, s[12:15], s23 offen sc1
  s_add_u32 s23, s23, 8192
  buffer_load_dword v50, v61, s[12:15], s23 offen sc1
  s_add_u32 s23, s23, 8192
  buffer_load_dword v51, v61, s[12:15], s23 offen sc1
  s_add_u32 s23, s23, 8192
  buffer_load_dword v52, v61, s[12:15], s23 offen sc1
  s_add_u32 s23, s23, 8192
  buffer_load_dword v53, v61, s[12:15], s23 offen sc1
  s_add_u32 s23, s23, 8192
  buffer_load_dword v54, v61, s[12:15], s23 offen sc1
  s_add_u32 s23, s23, 8192
  buffer_load_dword v55, v61, s[12:15], s23 offen sc1
  s_add_u32 s23, s23, 8192
  buffer_load_dword v56, v61, s[12:15], s23 offen sc1
  s_add_u32 s23, s23, 8192
  buffer_load_dword v57, v61, s[12:15], s23 offen sc1
  s_add_u32 s23, s23, 8192
  s_branch Lse_dback
Lse_ds6:
  s_mov_b32 s52, s63
  s_branch Lse_dback
Lse_ds7:
  s_add_u32 s21, s21, 1376256
  s_mov_b32 s51, s53
  s_mov_b32 s50, 147456
  s_mov_b64 s[54:55], s[38:39]
  s_mov_b64 s[56:57], s[40:41]
  s_mov_b32 s58, s42
  buffer_load_dwordx2 v[32:33], v2, s[12:15], s32 offen sc1
  s_branch Lse_dback
Lse_stub:
  s_cmp_eq_u32 s21, 1
  s_cbranch_scc1 Lse_stubx
  s_cmp_eq_u32 s21, 2
  s_cbranch_scc1 Lse_stub0
  s_cmp_eq_u32 s21, 5
  s_cbranch_scc1 Lse_stub2
  s_cmp_eq_u32 s21, 8
  s_cbranch_scc1 Lse_stub3
  s_cmp_eq_u32 s21, 9
  s_cbranch_scc1 Lse_stub4
  s_mov_b32 s21, 5
  buffer_load_dwordx4 v[160:163], v240, s[4:7], s40 offen
  buffer_load_dwordx4 v[164:167], v240, s[4:7], s41 offen
  s_add_u32 s59, s40, s58
  buffer_load_dwordx4 v[168:171], v240, s[4:7], s59 offen
  s_add_u32 s59, s41, s58
  buffer_load_dwordx4 v[172:175], v240, s[4:7], s59 offen
  buffer_load_dwordx4 v[176:179], v240, s[4:7], s42 offen
  buffer_load_dwordx4 v[180:183], v240, s[4:7], s43 offen
  s_add_u32 s59, s42, s58
  buffer_load_dwordx4 v[184:187], v240, s[4:7], s59 offen
  s_add_u32 s59, s43, s58
  buffer_load_dwordx4 v[188:191], v240, s[4:7], s59 offen
  s_branch Lse_loop
Lse_stub2:
  s_mov_b32 s21, 8
  buffer_load_dwordx4 v[192:195], v240, s[4:7], s44 offen
  buffer_load_dwordx4 v[196:199], v240, s[4:7], s45 offen
  s_add_u32 s59, s44, s58
  buffer_load_dwordx4 v[200:203], v240, s[4:7], s59 offen
  s_add_u32 s59, s45, s58
  buffer_load_dwordx4 v[204:207], v240, s[4:7], s59 offen
  buffer_load_dwordx4 v[208:211], v240, s[4:7], s46 offen
  buffer_load_dwordx4 v[212:215], v240, s[4:7], s47 offen
  s_add_u32 s59, s46, s58
  buffer_load_dwordx4 v[216:219], v240, s[4:7], s59 offen
  s_add_u32 s59, s47, s58
  buffer_load_dwordx4 v[220:223], v240, s[4:7], s59 offen
  s_branch Lse_mid
Lse_stub3:
  s_mov_b32 s21, 9
  s_waitcnt vmcnt(14)
  ds_write_b128 v241, v[160:163] offset:0
  ds_write_b128 v241, v[164:167] offset:1024
  ds_read_b64_tr_b16 v[224:225], v242 offset:0
  ds_read_b64_tr_b16 v[228:229], v242 offset:32
  ds_read_b64_tr_b16 v[232:233], v242 offset:64
  ds_read_b64_tr_b16 v[236:237], v242 offset:96
  s_waitcnt vmcnt(12)
  ds_write_b128 v241, v[168:171] offset:0
  ds_write_b128 v241, v[172:175] offset:1024
  ds_read_b64_tr_b16 v[226:227], v242 offset:0
  ds_read_b64_tr_b16 v[230:231], v242 offset:32
  ds_read_b64_tr_b16 v[234:235], v242 offset:64
  ds_read_b64_tr_b16 v[238:239], v242 offset:96
  s_waitcnt lgkmcnt(0)
  s_mov_b32 s59, s53
  buffer_store_dwordx4 v[224:227], v1, s[12:15], s59 offen sc1
  s_add_u32 s59, s59, s55
  buffer_store_dwordx4 v[228:231], v1, s[12:15], s59 offen sc1
  s_add_u32 s59, s59, s55
  buffer_store_dwordx4 v[232:235], v1, s[12:15], s59 offen sc1
  s_add_u32 s59, s59, s55
  buffer_store_dwordx4 v[236:239], v1, s[12:15], s59 offen sc1
  s_add_u32 s53, s53, s54
  s_waitcnt vmcnt(14)
  ds_write_b128 v241, v[176:179] offset:0
  ds_write_b128 v241, v[180:183] offset:1024
  ds_read_b64_tr_b16 v[224:225], v242 offset:0
  ds_read_b64_tr_b16 v[228:229], v242 offset:32
  ds_read_b64_tr_b16 v[232:233], v242 offset:64
  ds_read_b64_tr_b16 v[236:237], v242 offset:96
  s_waitcnt vmcnt(12)
  ds_write_b128 v241, v[184:187] offset:0
  ds_write_b128 v241, v[188:191] offset:1024
  ds_read_b64_tr_b16 v[226:227], v242 offset:0
  ds_read_b64_tr_b16 v[230:231], v242 offset:32
  ds_read_b64_tr_b16 v[234:235], v242 offset:64
  ds_read_b64_tr_b16 v[238:239], v242 offset:96
  s_waitcnt lgkmcnt(0)
  s_mov_b32 s59, s53
  buffer_store_dwordx4 v[224:227], v1, s[12:15], s59 offen sc1
  s_add_u32 s59, s59, s55
  buffer_store_dwordx4 v[228:231], v1, s[12:15], s59 offen sc1
  s_add_u32 s59, s59, s55
  buffer_store_dwordx4 v[232:235], v1, s[12:15], s59 offen sc1
  s_add_u32 s59, s59, s55
  buffer_store_dwordx4 v[236:239], v1, s[12:15], s59 offen sc1
  s_add_u32 s53, s53, s54
  s_branch Lse_loop
Lse_stub4:
  s_mov_b32 s21, 98
  s_waitcnt vmcnt(14)
  ds_write_b128 v241, v[192:195] offset:0
  ds_write_b128 v241, v[196:199] offset:1024
  ds_read_b64_tr_b16 v[224:225], v242 offset:0
  ds_read_b64_tr_b16 v[228:229], v242 offset:32
  ds_read_b64_tr_b16 v[232:233], v242 offset:64
  ds_read_b64_tr_b16 v[236:237], v242 offset:96
  s_waitcnt vmcnt(12)
  ds_write_b128 v241, v[200:203] offset:0
  ds_write_b128 v241, v[204:207] offset:1024
  ds_read_b64_tr_b16 v[226:227], v242 offset:0
  ds_read_b64_tr_b16 v[230:231], v242 offset:32
  ds_read_b64_tr_b16 v[234:235], v242 offset:64
  ds_read_b64_tr_b16 v[238:239], v242 offset:96
  s_waitcnt lgkmcnt(0)
  s_mov_b32 s59, s53
  buffer_store_dwordx4 v[224:227], v1, s[12:15], s59 offen sc1
  s_add_u32 s59, s59, s55
  buffer_store_dwordx4 v[228:231], v1, s[12:15], s59 offen sc1
  s_add_u32 s59, s59, s55
  buffer_store_dwordx4 v[232:235], v1, s[12:15], s59 offen sc1
  s_add_u32 s59, s59, s55
  buffer_store_dwordx4 v[236:239], v1, s[12:15], s59 offen sc1
  s_add_u32 s53, s53, s54
  s_waitcnt vmcnt(14)
  ds_write_b128 v241, v[208:211] offset:0
  ds_write_b128 v241, v[212:215] offset:1024
  ds_read_b64_tr_b16 v[224:225], v242 offset:0
  ds_read_b64_tr_b16 v[228:229], v242 offset:32
  ds_read_b64_tr_b16 v[232:233], v242 offset:64
  ds_read_b64_tr_b16 v[236:237], v242 offset:96
  s_waitcnt vmcnt(12)
  ds_write_b128 v241, v[216:219] offset:0
  ds_write_b128 v241, v[220:223] offset:1024
  ds_read_b64_tr_b16 v[226:227], v242 offset:0
  ds_read_b64_tr_b16 v[230:231], v242 offset:32
  ds_read_b64_tr_b16 v[234:235], v242 offset:64
  ds_read_b64_tr_b16 v[238:239], v242 offset:96
  s_waitcnt lgkmcnt(0)
  s_mov_b32 s59, s53
  buffer_store_dwordx4 v[224:227], v1, s[12:15], s59 offen sc1
  s_add_u32 s59, s59, s55
  buffer_store_dwordx4 v[228:231], v1, s[12:15], s59 offen sc1
  s_add_u32 s59, s59, s55
  buffer_store_dwordx4 v[232:235], v1, s[12:15], s59 offen sc1
  s_add_u32 s59, s59, s55
  buffer_store_dwordx4 v[236:239], v1, s[12:15], s59 offen sc1
  s_add_u32 s53, s53, s54
  s_branch Lse_mid
Lse_stubx:
  s_barrier
  s_mov_b32 s21, 2
  s_branch Lse_mid
Lse_stub0:
  s_barrier
  s_cmp_ge_u32 s61, 972
  s_cselect_b32 s21, 98, 4
  s_branch Lse_loop
Lse_fallback:
  s_waitcnt vmcnt(0)
  s_barrier
  s_mov_b32 s48, 64
  s_mul_i32 s22, s17, 155648
  s_lshl_b32 s23, s16, 10
  v_mov_b32 v68, 0
  v_pk_mul_f32 v[48:49], v[68:69], v[68:69] op_sel_hi:[0,0]
  v_pk_mul_f32 v[50:51], v[68:69], v[68:69] op_sel_hi:[0,0]
  v_pk_mul_f32 v[52:53], v[68:69], v[68:69] op_sel_hi:[0,0]
  v_pk_mul_f32 v[54:55], v[68:69], v[68:69] op_sel_hi:[0,0]
  v_pk_mul_f32 v[56:57], v[68:69], v[68:69] op_sel_hi:[0,0]
  v_pk_mul_f32 v[58:59], v[68:69], v[68:69] op_sel_hi:[0,0]
  v_pk_mul_f32 v[60:61], v[68:69], v[68:69] op_sel_hi:[0,0]
  v_pk_mul_f32 v[62:63], v[68:69], v[68:69] op_sel_hi:[0,0]
  v_pk_mul_f32 v[96:97], v[68:69], v[68:69] op_sel_hi:[0,0]
  v_pk_mul_f32 v[98:99], v[68:69], v[68:69] op_sel_hi:[0,0]
  v_pk_mul_f32 v[100:101], v[68:69], v[68:69] op_sel_hi:[0,0]
  v_pk_mul_f32 v[102:103], v[68:69], v[68:69] op_sel_hi:[0,0]
  v_pk_mul_f32 v[104:105], v[68:69], v[68:69] op_sel_hi:[0,0]
  v_pk_mul_f32 v[106:107], v[68:69], v[68:69] op_sel_hi:[0,0]
  v_pk_mul_f32 v[108:109], v[68:69], v[68:69] op_sel_hi:[0,0]
  v_pk_mul_f32 v[110:111], v[68:69], v[68:69] op_sel_hi:[0,0]
  v_pk_mul_f32 v[68:69], v[68:69], v[68:69] op_sel_hi:[0,0]
  v_pk_mul_f32 v[70:71], v[68:69], v[68:69] op_sel_hi:[0,0]
  v_pk_mul_f32 v[84:85], v[68:69], v[68:69] op_sel_hi:[0,0]
  v_pk_mul_f32 v[86:87], v[68:69], v[68:69] op_sel_hi:[0,0]
Lse_fb1:
  s_add_u32 m0, s23, 0
  s_add_u32 s24, s22, m0
  buffer_load_dwordx4 v1, s[12:15], s24 offen sc1 lds
  s_add_u32 s23, s23, 8192
  s_cmp_lt_u32 s23, 155648
  s_cbranch_scc1 Lse_fb1
  s_waitcnt vmcnt(0)
  s_barrier
  s_branch Lse_restart
Lse_fin:
Lse_end:
  s_endpgm
.section .rodata,"a"
.p2align 6
Ldesc_sequential_preLN__softmax_full_mha__glu_gated_bilinear__prompt_kernel:
.amdhsa_kernel sequential_preLN__softmax_full_mha__glu_gated_bilinear__prompt_kernel
  .amdhsa_next_free_vgpr 256
  .amdhsa_next_free_sgpr 96
  .amdhsa_accum_offset 256
  .amdhsa_group_segment_fixed_size 0
  .amdhsa_kernarg_size 80
  .amdhsa_user_sgpr_count 2
  .amdhsa_user_sgpr_kernarg_segment_ptr 1
  .amdhsa_system_sgpr_workgroup_id_x 1
.end_amdhsa_kernel
.text
```
